```python
import torch

def _softmax(x, axis=-1):
    return torch.softmax(x, dim=axis)
def _gelu(x):
    return torch.nn.functional.gelu(x, approximate="tanh")
def _silu(x):
    return torch.nn.functional.silu(x)
def _sigmoid(x):
    return torch.sigmoid(x)
def _layernorm(x, axis=-1, eps=1e-5):
    m = x.mean(dim=axis, keepdim=True)
    v = x.var(dim=axis, keepdim=True, unbiased=False)
    return (x - m) / torch.sqrt(v + eps)
def _scatter_add(tgt, idx, src, axis=0):
    return tgt.clone().index_add_(axis, idx, src)
def _segment_sum(src, seg, n):
    out = torch.zeros((n,) + src.shape[1:], dtype=src.dtype)
    return out.index_add_(0, seg, src)
def _pad(x, pw):
    flat = tuple(v for pair in reversed(pw) for v in pair)
    return torch.nn.functional.pad(x, flat)

kernel_name = 'sequential_preLN__ssm_conv_s4d__mixer_s_mlp__prompt'

def setup_inputs():

    _w = (lambda a: (lambda t: t.to(torch.bfloat16) if t.is_floating_point() else t)(torch.as_tensor(a)))
    def _A_setup():
        Bsz, L, D, N = 1, 2048, 512, 128
        return {
            "u": _w((lambda *s: torch.randn(*s, dtype=torch.bfloat16) * 0.05)(Bsz, L, D)),
            "log_A_real": _w((lambda *s: torch.randn(*s, dtype=torch.bfloat16) * 6.4)(D, N) * 0.5),
            "A_imag": _w((lambda *s: torch.randn(*s, dtype=torch.bfloat16) * 0.05)(D, N) * 3.14),
            "C_real": _w((lambda *s: torch.randn(*s, dtype=torch.bfloat16) * 0.05)(D, N) / N ** 0.5),
            "C_imag": _w((lambda *s: torch.randn(*s, dtype=torch.bfloat16) * 0.05)(D, N) / N ** 0.5),
            "log_dt": _w((lambda *s: torch.randn(*s, dtype=torch.bfloat16) * 0.05)(D) * 0.5 - 4.0),
            "D_skip": _w((lambda *s: torch.randn(*s, dtype=torch.bfloat16) * 0.05)(D)),
        }
    _A_in = _A_setup()

    def _B_setup():
        B, S, D, F = 1, 2048, 512, 1792
        return {
            "x":  _w((lambda *s: torch.randn(*s, dtype=torch.bfloat16) * 0.05)(B, S, D)),
            "w1": _w((lambda *s: torch.randn(*s, dtype=torch.bfloat16) * 6.4)(D, D) * (D ** -0.5)),
            "w2": _w((lambda *s: torch.randn(*s, dtype=torch.bfloat16) * 6.4)(D, D) * (D ** -0.5)),
            "w3": _w((lambda *s: torch.randn(*s, dtype=torch.bfloat16) * 6.4)(D, F) * (D ** -0.5)),
            "w4": _w((lambda *s: torch.randn(*s, dtype=torch.bfloat16) * 6.4)(F, D) * (F ** -0.5)),
        }
    _B_in = _B_setup()

    return {
        "A_u": _A_in["u"],
        "A_log_A_real": _A_in["log_A_real"],
        "A_A_imag": _A_in["A_imag"],
        "A_C_real": _A_in["C_real"],
        "A_C_imag": _A_in["C_imag"],
        "A_log_dt": _A_in["log_dt"],
        "A_D_skip": _A_in["D_skip"],
        "B_x": _B_in["x"],
        "B_w1": _B_in["w1"],
        "B_w2": _B_in["w2"],
        "B_w3": _B_in["w3"],
        "B_w4": _B_in["w4"],
    }

def reference(A_u, A_log_A_real, A_A_imag, A_C_real, A_C_imag, A_log_dt, A_D_skip, B_x, B_w1, B_w2, B_w3, B_w4):
    def _A_ref(u, log_A_real, A_imag, C_real, C_imag, log_dt, D_skip):
        L = u.shape[1]
        dt = torch.exp(log_dt)
        A = -torch.exp(log_A_real) + 1j * A_imag
        C = (C_real + 1j * C_imag) * dt[:, None]
        pos = (lambda x, dt: x.to(dt))(torch.arange(L), log_dt.dtype)
        P = torch.exp((A * dt[:, None])[:, :, None] * pos[None, None, :])
        K = 2.0 * torch.einsum("dn,dnl->dl", C, P).real
        L2 = 2 * L
        u_t = (lambda x, *d: x.permute(*d))(u, 0, 2, 1)
        Kf = (lambda x, *a, **k: torch.fft.rfft(x.float(), *a, **k))(K, L2)
        Uf = (lambda x, *a, **k: torch.fft.rfft(x.float(), *a, **k))(u_t, L2)
        y = (lambda x, *a, **k: torch.fft.irfft(x, *a, **k).to(torch.bfloat16))(Uf * Kf[None, :, :], L2)[:, :, :L]
        y = (lambda x, *d: x.permute(*d))(y, 0, 2, 1)
        return y + u * D_skip[None, None, :]

    def _B_ref(x, w1, w2, w3, w4):
        B, S, D = x.shape
        h = _gelu(_layernorm(x, axis=-1) @ w1)
        c = D // 4
        g0 = _pad(h[:, :, 0*c:1*c], ((0, 0), (1, 0), (0, 0)))[:, :S, :]
        g1 = _pad(h[:, :, 1*c:2*c], ((0, 0), (0, 1), (0, 0)))[:, 1:, :]
        g2 = _pad(h[:, :, 2*c:3*c], ((0, 0), (2, 0), (0, 0)))[:, :S, :]
        g3 = _pad(h[:, :, 3*c:   ], ((0, 0), (0, 2), (0, 0)))[:, 2:, :]
        hs = torch.concatenate([g0, g1, g2, g3], axis=-1) @ w2
        x1 = x + hs
        h2 = _gelu(_layernorm(x1, axis=-1) @ w3) @ w4
        return x1 + h2

    x = A_u
    h = x + _A_ref(_layernorm(x, axis=-1), A_log_A_real, A_A_imag, A_C_real, A_C_imag, A_log_dt, A_D_skip)
    h2 = h + _B_ref(_layernorm(h, axis=-1), B_w1, B_w2, B_w3, B_w4)
    return h2
```

```asm
; @launch grid=(256,1,1) block=(512,1,1) lds=163840
.amdgcn_target "amdgcn-amd-amdhsa--gfx950"
.text
.globl sequential_preLN__ssm_conv_s4d__mixer_s_mlp__prompt_kernel
.type sequential_preLN__ssm_conv_s4d__mixer_s_mlp__prompt_kernel,@function
.p2align 8
sequential_preLN__ssm_conv_s4d__mixer_s_mlp__prompt_kernel:
  s_load_dwordx2 s[36:37], s[0:1], 0
  s_load_dwordx2 s[52:53], s[0:1], 112
  s_cmp_ge_u32 s2, 256
  s_cbranch_scc1 L_end
  v_lshrrev_b32 v1, 6, v0
  v_and_b32 v0, 63, v0
  v_readfirstlane_b32 s5, v1
  s_and_b32 s3, s2, 7
  s_lshr_b32 s4, s2, 3
  s_cmp_lt_u32 s5, 4
  s_cbranch_scc1 L_compute
  s_load_dwordx8 s[40:47], s[0:1], 64
  s_load_dwordx2 s[50:51], s[0:1], 104
  s_setprio 3
  s_and_b32 s7, s5, 1
  s_lshl_b32 s26, s7, 12
  s_cmp_ge_u32 s5, 6
  s_cbranch_scc1 L_aload
  v_lshlrev_b32 v3, 4, v0
  s_lshl_b32 s16, s2, 13
  s_add_u32 s16, s16, s26
  s_memrealtime s[60:61]
  s_waitcnt lgkmcnt(0)
  s_mov_b32 s8, s36
  s_and_b32 s9, s37, 0xffff
  s_mov_b32 s10, 0x200000
  s_mov_b32 s11, 0x20000
  buffer_load_dwordx4 v[16:19], v3, s[8:11], s16 offen offset:0
  buffer_load_dwordx4 v[20:23], v3, s[8:11], s16 offen offset:1024
  buffer_load_dwordx4 v[24:27], v3, s[8:11], s16 offen offset:2048
  buffer_load_dwordx4 v[28:31], v3, s[8:11], s16 offen offset:3072
  s_branch L_bcont
L_aload:
  s_getpc_b64 s[58:59]
L_pc:
  s_lshl_b32 s18, s4, 1
  s_add_u32 s18, s18, s7
  s_mul_i32 s18, s18, 768
  s_sub_u32 s58, s58, L_pc-sequential_preLN__ssm_conv_s4d__mixer_s_mlp__prompt_kernel
  s_subb_u32 s59, s59, 0
  s_min_u32 s18, s18, L_codeend-sequential_preLN__ssm_conv_s4d__mixer_s_mlp__prompt_kernel-768
  s_load_dword s80, s[58:59], s18 offset:0
  s_load_dword s81, s[58:59], s18 offset:64
  s_load_dword s82, s[58:59], s18 offset:128
  s_load_dword s83, s[58:59], s18 offset:192
  s_load_dword s84, s[58:59], s18 offset:256
  s_load_dword s85, s[58:59], s18 offset:320
  s_load_dword s86, s[58:59], s18 offset:384
  s_load_dword s87, s[58:59], s18 offset:448
  s_load_dword s88, s[58:59], s18 offset:512
  s_load_dword s89, s[58:59], s18 offset:576
  s_load_dword s90, s[58:59], s18 offset:640
  s_load_dword s91, s[58:59], s18 offset:704
  s_branch L_aload2
L_bcont:
  s_getreg_b32 s59, hwreg(HW_REG_XCC_ID, 0, 4)
  s_lshl_b32 s17, s3, 2
  s_add_u32 s17, s17, 4
  s_add_u32 s59, s59, 1
  v_mul_u32_u24 v6, s17, v0
  v_lshlrev_b32 v5, 2, v0
  s_mov_b32 s32, s50
  s_and_b32 s33, s51, 0xffff
  s_mov_b32 s34, 0x100
  s_mov_b32 s35, 0x20000
  s_or_b32 s60, s60, 2
  s_and_b32 s60, s60, -2
  s_add_u32 s31, s4, s7
  s_cmp_lg_u32 s31, 0
  s_cbranch_scc1 L_notok
  v_mov_b32 v104, s59
  v_writelane_b32 v104, s60, 0
  s_cmp_eq_u32 s2, 0
  s_cselect_b32 exec_lo, 3, 2
  s_mov_b32 exec_hi, 0
  buffer_store_dword v104, v6, s[32:35], 0 offen sc1
  s_mov_b64 exec, -1
L_notok:
  s_lshr_b32 s19, s4, 3
  s_lshl_b32 s18, s3, 2
  s_add_u32 s19, s19, s18
  s_and_b32 s20, s4, 7
  s_cmp_ge_u32 s4, 14
  s_cselect_b32 s22, 14, 0
  s_sub_u32 s22, s4, s22
  s_mov_b32 s12, s52
  s_and_b32 s13, s53, 0xffff
  s_mov_b32 s14, 0x1200000
  s_mov_b32 s15, 0x20000
  s_mov_b32 s24, 0x3f803f80
  s_mov_b32 s90, 0x3b000000
  s_mul_i32 s18, s7, 8320
  s_add_u32 s18, s18, 65536
  v_lshl_add_u32 v8, v0, 5, s18
  v_bfe_u32 v9, v0, 2, 2
  v_mul_u32_u24 v9, 2080, v9
  v_and_b32 v10, 3, v0
  v_lshl_add_u32 v9, v10, 3, v9
  v_lshrrev_b32 v11, 4, v0
  v_lshl_add_u32 v9, v11, 5, v9
  s_lshl_b32 s18, s7, 10
  s_add_u32 s18, s18, 65536
  v_add_u32 v9, s18, v9
  v_lshrrev_b32 v11, 2, v0
  v_lshlrev_b32 v11, 14, v11
  v_lshl_add_u32 v10, v10, 4, v11
  s_lshl_b32 s16, s7, 21
  s_lshl_b32 s18, s2, 6
  s_add_u32 s16, s16, s18
  s_add_u32 s16, s16, 14680064
  s_lshl_b32 s18, s7, 2
  s_add_u32 s18, s18, 95072
  v_mov_b32 v12, s18
  v_xor_b32 v13, 4, v12
  s_barrier
  v_mov_b32 v96, 0
  v_mov_b32 v97, 0
  v_mov_b32 v98, 0
  v_mov_b32 v99, 0
  v_mov_b32 v100, 0
  v_mov_b32 v101, 0
  v_mov_b32 v102, 0
  v_mov_b32 v103, 0
  s_waitcnt vmcnt(0)
  s_mov_b32 s8, s40
  s_and_b32 s9, s41, 0xffff
  s_mov_b32 s10, 0x80000
  s_mov_b32 s11, 0x20000
  s_lshl_b32 s18, s4, 1
  s_add_u32 s18, s18, s7
  s_lshl_b32 s18, s18, 13
  v_lshlrev_b32 v7, 7, v0
  buffer_load_dword v105, v7, s[8:11], s18 offen
  v_dot2_f32_bf16 v96, v16, s24, v96
  v_dot2_f32_bf16 v100, v16, v16, v100
  v_dot2_f32_bf16 v97, v20, s24, v97
  v_dot2_f32_bf16 v101, v20, v20, v101
  v_dot2_f32_bf16 v98, v24, s24, v98
  v_dot2_f32_bf16 v102, v24, v24, v102
  v_dot2_f32_bf16 v99, v28, s24, v99
  v_dot2_f32_bf16 v103, v28, v28, v103
  v_dot2_f32_bf16 v96, v17, s24, v96
  v_dot2_f32_bf16 v100, v17, v17, v100
  v_dot2_f32_bf16 v97, v21, s24, v97
  v_dot2_f32_bf16 v101, v21, v21, v101
  v_dot2_f32_bf16 v98, v25, s24, v98
  v_dot2_f32_bf16 v102, v25, v25, v102
  v_dot2_f32_bf16 v99, v29, s24, v99
  v_dot2_f32_bf16 v103, v29, v29, v103
  v_dot2_f32_bf16 v96, v18, s24, v96
  v_dot2_f32_bf16 v100, v18, v18, v100
  v_dot2_f32_bf16 v97, v22, s24, v97
  v_dot2_f32_bf16 v101, v22, v22, v101
  v_dot2_f32_bf16 v98, v26, s24, v98
  v_dot2_f32_bf16 v102, v26, v26, v102
  v_dot2_f32_bf16 v99, v30, s24, v99
  v_dot2_f32_bf16 v103, v30, v30, v103
  v_dot2_f32_bf16 v96, v19, s24, v96
  v_dot2_f32_bf16 v100, v19, v19, v100
  v_dot2_f32_bf16 v97, v23, s24, v97
  v_dot2_f32_bf16 v101, v23, v23, v101
  v_dot2_f32_bf16 v98, v27, s24, v98
  v_dot2_f32_bf16 v102, v27, v27, v102
  v_dot2_f32_bf16 v99, v31, s24, v99
  v_dot2_f32_bf16 v103, v31, v31, v103
  v_permlane32_swap_b32 v96, v97
  s_nop 0
  v_permlane32_swap_b32 v98, v99
  v_permlane32_swap_b32 v100, v101
  v_permlane32_swap_b32 v102, v103
  v_add_f32 v96, v96, v97
  v_add_f32 v98, v98, v99
  v_add_f32 v100, v100, v101
  v_add_f32 v102, v102, v103
  v_permlane16_swap_b32 v96, v98
  s_nop 0
  v_permlane16_swap_b32 v100, v102
  v_add_f32 v96, v96, v98
  v_add_f32 v100, v100, v102
  s_nop 0
  v_add_f32_dpp v96, v96, v96 row_ror:8 row_mask:0xf bank_mask:0xf
  v_add_f32_dpp v100, v100, v100 row_ror:8 row_mask:0xf bank_mask:0xf
  s_nop 0
  v_add_f32_dpp v96, v96, v96 row_ror:4 row_mask:0xf bank_mask:0xf
  v_add_f32_dpp v100, v100, v100 row_ror:4 row_mask:0xf bank_mask:0xf
  s_nop 0
  v_add_f32_dpp v96, v96, v96 row_ror:2 row_mask:0xf bank_mask:0xf
  v_add_f32_dpp v100, v100, v100 row_ror:2 row_mask:0xf bank_mask:0xf
  s_nop 0
  v_add_f32_dpp v96, v96, v96 row_ror:1 row_mask:0xf bank_mask:0xf
  v_add_f32_dpp v100, v100, v100 row_ror:1 row_mask:0xf bank_mask:0xf
  v_lshlrev_b32 v32, 16, v16
  v_and_b32 v33, 0xffff0000, v16
  v_mov_b32 v65, v16
  v_lshlrev_b32 v34, 16, v17
  v_and_b32 v35, 0xffff0000, v17
  v_mov_b32 v67, v17
  v_lshlrev_b32 v36, 16, v18
  v_and_b32 v37, 0xffff0000, v18
  v_mov_b32 v69, v18
  v_lshlrev_b32 v38, 16, v19
  v_and_b32 v39, 0xffff0000, v19
  v_mov_b32 v71, v19
  v_lshlrev_b32 v40, 16, v20
  v_and_b32 v41, 0xffff0000, v20
  v_mov_b32 v73, v20
  v_lshlrev_b32 v42, 16, v21
  v_and_b32 v43, 0xffff0000, v21
  v_mov_b32 v75, v21
  v_lshlrev_b32 v44, 16, v22
  v_and_b32 v45, 0xffff0000, v22
  v_mov_b32 v77, v22
  v_lshlrev_b32 v46, 16, v23
  v_and_b32 v47, 0xffff0000, v23
  v_mov_b32 v79, v23
  v_lshlrev_b32 v48, 16, v24
  v_and_b32 v49, 0xffff0000, v24
  v_mov_b32 v81, v24
  v_lshlrev_b32 v50, 16, v25
  v_and_b32 v51, 0xffff0000, v25
  v_mov_b32 v83, v25
  v_lshlrev_b32 v52, 16, v26
  v_and_b32 v53, 0xffff0000, v26
  v_mov_b32 v85, v26
  v_lshlrev_b32 v54, 16, v27
  v_and_b32 v55, 0xffff0000, v27
  v_mov_b32 v87, v27
  v_lshlrev_b32 v56, 16, v28
  v_and_b32 v57, 0xffff0000, v28
  v_mov_b32 v89, v28
  v_lshlrev_b32 v58, 16, v29
  v_and_b32 v59, 0xffff0000, v29
  v_mov_b32 v91, v29
  v_lshlrev_b32 v60, 16, v30
  v_and_b32 v61, 0xffff0000, v30
  v_mov_b32 v93, v30
  v_lshlrev_b32 v62, 16, v31
  v_and_b32 v63, 0xffff0000, v31
  v_mov_b32 v95, v31
  v_mul_f32 v96, 0x3b000000, v96
  v_mul_f32 v97, v96, v96
  v_fma_f32 v100, v100, s90, -v97
  v_max_f32 v100, 0, v100
  v_cvt_pk_bf16_f32 v98, v96, v96
  v_and_b32 v98, 0xffff0000, v98
  v_cvt_pk_bf16_f32 v97, v100, v100
  v_and_b32 v97, 0xffff0000, v97
  v_add_f32 v97, 0x3727c5ac, v97
  v_cvt_pk_bf16_f32 v97, v97, v97
  v_and_b32 v97, 0xffff0000, v97
  v_sqrt_f32 v97, v97
  s_nop 0
  v_cvt_pk_bf16_f32 v97, v97, v97
  v_and_b32 v97, 0xffff0000, v97
  v_rcp_f32 v99, v97
  s_nop 0
  v_mul_f32 v98, -v98, v99
  s_nop 0
  v_readlane_b32 s80, v98, 0
  v_readlane_b32 s81, v99, 0
  v_readlane_b32 s82, v98, 32
  v_readlane_b32 s83, v99, 32
  v_readlane_b32 s84, v98, 16
  v_readlane_b32 s85, v99, 16
  v_readlane_b32 s86, v98, 48
  v_readlane_b32 s87, v99, 48
  v_pk_fma_f32 v[32:33], v[32:33], s[80:81], s[80:81] op_sel:[0,1,0] op_sel_hi:[1,1,0]
  v_pk_fma_f32 v[34:35], v[34:35], s[80:81], s[80:81] op_sel:[0,1,0] op_sel_hi:[1,1,0]
  v_pk_fma_f32 v[36:37], v[36:37], s[80:81], s[80:81] op_sel:[0,1,0] op_sel_hi:[1,1,0]
  v_pk_fma_f32 v[38:39], v[38:39], s[80:81], s[80:81] op_sel:[0,1,0] op_sel_hi:[1,1,0]
  v_cvt_pk_f16_f32 v64, v32, v33
  v_cvt_pk_f16_f32 v66, v34, v35
  v_cvt_pk_f16_f32 v68, v36, v37
  v_cvt_pk_f16_f32 v70, v38, v39
  ds_write_b128 v8, v[64:67] offset:0
  ds_write_b128 v8, v[68:71] offset:16
  v_pk_fma_f32 v[40:41], v[40:41], s[82:83], s[82:83] op_sel:[0,1,0] op_sel_hi:[1,1,0]
  v_pk_fma_f32 v[42:43], v[42:43], s[82:83], s[82:83] op_sel:[0,1,0] op_sel_hi:[1,1,0]
  v_pk_fma_f32 v[44:45], v[44:45], s[82:83], s[82:83] op_sel:[0,1,0] op_sel_hi:[1,1,0]
  v_pk_fma_f32 v[46:47], v[46:47], s[82:83], s[82:83] op_sel:[0,1,0] op_sel_hi:[1,1,0]
  v_cvt_pk_f16_f32 v72, v40, v41
  v_cvt_pk_f16_f32 v74, v42, v43
  v_cvt_pk_f16_f32 v76, v44, v45
  v_cvt_pk_f16_f32 v78, v46, v47
  ds_write_b128 v8, v[72:75] offset:2080
  ds_write_b128 v8, v[76:79] offset:2096
  v_pk_fma_f32 v[48:49], v[48:49], s[84:85], s[84:85] op_sel:[0,1,0] op_sel_hi:[1,1,0]
  v_pk_fma_f32 v[50:51], v[50:51], s[84:85], s[84:85] op_sel:[0,1,0] op_sel_hi:[1,1,0]
  v_pk_fma_f32 v[52:53], v[52:53], s[84:85], s[84:85] op_sel:[0,1,0] op_sel_hi:[1,1,0]
  v_pk_fma_f32 v[54:55], v[54:55], s[84:85], s[84:85] op_sel:[0,1,0] op_sel_hi:[1,1,0]
  v_cvt_pk_f16_f32 v80, v48, v49
  v_cvt_pk_f16_f32 v82, v50, v51
  v_cvt_pk_f16_f32 v84, v52, v53
  v_cvt_pk_f16_f32 v86, v54, v55
  ds_write_b128 v8, v[80:83] offset:4160
  ds_write_b128 v8, v[84:87] offset:4176
  v_pk_fma_f32 v[56:57], v[56:57], s[86:87], s[86:87] op_sel:[0,1,0] op_sel_hi:[1,1,0]
  v_pk_fma_f32 v[58:59], v[58:59], s[86:87], s[86:87] op_sel:[0,1,0] op_sel_hi:[1,1,0]
  v_pk_fma_f32 v[60:61], v[60:61], s[86:87], s[86:87] op_sel:[0,1,0] op_sel_hi:[1,1,0]
  v_pk_fma_f32 v[62:63], v[62:63], s[86:87], s[86:87] op_sel:[0,1,0] op_sel_hi:[1,1,0]
  v_cvt_pk_f16_f32 v88, v56, v57
  v_cvt_pk_f16_f32 v90, v58, v59
  v_cvt_pk_f16_f32 v92, v60, v61
  v_cvt_pk_f16_f32 v94, v62, v63
  ds_write_b128 v8, v[88:91] offset:6240
  ds_write_b128 v8, v[92:95] offset:6256
  buffer_load_dword v104, v5, s[32:35], 0 offen sc1
  v_mov_b32 v14, 1
  s_waitcnt lgkmcnt(0)
  ds_write_b32 v12, v14
  s_mov_b32 s30, 0
L_ps_1:
  ds_read_b32 v14, v13
  s_add_u32 s30, s30, 1
  s_waitcnt lgkmcnt(0)
  v_readfirstlane_b32 s31, v14
  s_cmp_ge_u32 s31, 1
  s_cbranch_scc1 L_psd_2
  s_cmp_lt_u32 s30, 0x186a00
  s_cbranch_scc1 L_ps_1
L_psd_2:
  ds_read_b64_tr_b16 v[16:17], v9 offset:0
  ds_read_b64_tr_b16 v[18:19], v9 offset:8320
  ds_read_b64_tr_b16 v[20:21], v9 offset:128
  ds_read_b64_tr_b16 v[22:23], v9 offset:8448
  ds_read_b64_tr_b16 v[24:25], v9 offset:256
  ds_read_b64_tr_b16 v[26:27], v9 offset:8576
  ds_read_b64_tr_b16 v[28:29], v9 offset:384
  ds_read_b64_tr_b16 v[30:31], v9 offset:8704
  ds_read_b64_tr_b16 v[32:33], v9 offset:512
  ds_read_b64_tr_b16 v[34:35], v9 offset:8832
  ds_read_b64_tr_b16 v[36:37], v9 offset:640
  ds_read_b64_tr_b16 v[38:39], v9 offset:8960
  ds_read_b64_tr_b16 v[40:41], v9 offset:768
  ds_read_b64_tr_b16 v[42:43], v9 offset:9088
  ds_read_b64_tr_b16 v[44:45], v9 offset:896
  ds_read_b64_tr_b16 v[46:47], v9 offset:9216
  s_waitcnt lgkmcnt(14)
  buffer_store_dwordx4 v[16:19], v10, s[12:15], s16 offen offset:0 sc1
  s_add_u32 s16, s16, 0x40000
  s_waitcnt lgkmcnt(12)
  buffer_store_dwordx4 v[20:23], v10, s[12:15], s16 offen offset:0 sc1
  s_add_u32 s16, s16, 0x40000
  s_waitcnt lgkmcnt(10)
  buffer_store_dwordx4 v[24:27], v10, s[12:15], s16 offen offset:0 sc1
  s_add_u32 s16, s16, 0x40000
  s_waitcnt lgkmcnt(8)
  buffer_store_dwordx4 v[28:31], v10, s[12:15], s16 offen offset:0 sc1
  s_add_u32 s16, s16, 0x40000
  s_waitcnt lgkmcnt(6)
  buffer_store_dwordx4 v[32:35], v10, s[12:15], s16 offen offset:0 sc1
  s_add_u32 s16, s16, 0x40000
  s_waitcnt lgkmcnt(4)
  buffer_store_dwordx4 v[36:39], v10, s[12:15], s16 offen offset:0 sc1
  s_add_u32 s16, s16, 0x40000
  s_waitcnt lgkmcnt(2)
  buffer_store_dwordx4 v[40:43], v10, s[12:15], s16 offen offset:0 sc1
  s_add_u32 s16, s16, 0x40000
  s_waitcnt lgkmcnt(0)
  buffer_store_dwordx4 v[44:47], v10, s[12:15], s16 offen offset:0 sc1
  s_cmp_lg_u32 s7, 0
  s_cbranch_scc1 L_tokd
  s_mov_b32 s30, 0
  s_add_u32 s17, s3, 1
  s_waitcnt vmcnt(8)
L_tok:
  v_readlane_b32 s93, v104, 0
  v_readlane_b32 s91, v104, s17
  s_min_u32 s31, s93, s91
  s_cmp_lg_u32 s31, 0
  s_cbranch_scc1 L_tokx
  buffer_load_dword v104, v5, s[32:35], 0 offen sc1
  s_add_u32 s30, s30, 1
  s_waitcnt vmcnt(0)
  s_cmp_lt_u32 s30, 100000
  s_cbranch_scc1 L_tok
L_tokx:
  s_cmp_lg_u32 s91, s59
  s_cselect_b32 s91, 1, 0
  s_or_b32 s31, s91, s93
  v_mov_b32 v104, s31
  v_mov_b32 v7, 94544
  ds_write_b32 v7, v104
L_tokd:
  s_waitcnt vmcnt(0)
  v_mov_b32 v14, 2
  s_waitcnt lgkmcnt(0)
  ds_write_b32 v12, v14
  s_mov_b32 s30, 0
L_ps_3:
  ds_read_b32 v14, v13
  s_add_u32 s30, s30, 1
  s_waitcnt lgkmcnt(0)
  v_readfirstlane_b32 s31, v14
  s_cmp_ge_u32 s31, 2
  s_cbranch_scc1 L_psd_4
  s_cmp_lt_u32 s30, 0x186a00
  s_cbranch_scc1 L_ps_3
L_psd_4:
  s_cmp_lg_u32 s7, 0
  s_cbranch_scc1 L_nof1
  s_lshl_b32 s18, s2, 4
  v_mov_b32 v7, 14024704
  s_mov_b64 exec, 1
  buffer_store_dword v104, v7, s[12:15], s18 offen sc1
  s_mov_b64 exec, -1
L_nof1:
  v_mov_b32 v7, 94544
  ds_read_b32 v104, v7
  v_mov_b32 v8, 0
  v_mov_b32 v9, 0
  s_mul_i32 s18, s7, 8704
  s_add_u32 s18, s18, 65536
  v_lshl_add_u32 v7, v0, 3, s18
  ds_write_b64 v7, v[8:9]
  v_lshlrev_b32 v8, 6, v0
  s_lshl_b32 s16, s3, 5
  s_add_u32 s16, s16, s4
  s_lshl_b32 s16, s16, 14
  s_lshl_b32 s18, s7, 13
  s_add_u32 s16, s16, s18
  s_add_u32 s16, s16, 14680064
  s_add_u32 s17, s16, 3072
  s_lshl_b32 s23, s7, 11
  s_waitcnt lgkmcnt(1)
  v_readfirstlane_b32 s31, v104
  s_and_b32 s91, s31, 1
  s_and_b32 s93, s31, -2
  s_lshl_b32 s18, s3, 8
  s_add_u32 s18, s18, 0
  s_mov_b32 s30, 0
  s_add_u32 s31, s4, s7
  s_cmp_lg_u32 s31, 0
  s_cbranch_scc1 L_fol_5
  v_lshlrev_b32 v7, 4, v0
  v_add_u32 v7, 14024704, v7
L_pa_7:
  buffer_load_dword v24, v7, s[12:15], 0 offen offset:0 sc1
  buffer_load_dword v25, v7, s[12:15], 0 offen offset:1024 sc1
  buffer_load_dword v26, v7, s[12:15], 0 offen offset:2048 sc1
  buffer_load_dword v27, v7, s[12:15], 0 offen offset:3072 sc1
  s_add_u32 s30, s30, 1
  s_waitcnt vmcnt(0)
  v_xor_b32 v24, s93, v24
  v_xor_b32 v25, s93, v25
  v_xor_b32 v26, s93, v26
  v_xor_b32 v27, s93, v27
  v_or3_b32 v24, v24, v26, v27
  v_or_b32 v24, v24, v25
  v_cmp_lt_u32 vcc, 1, v24
  s_cbranch_vccz L_pax_9
  s_cmp_lt_u32 s30, 100000
  s_cbranch_scc1 L_pa_7
L_pax_9:
  v_cmp_eq_u32 vcc, 1, v24
  s_cmp_lg_u64 vcc, 0
  s_cselect_b32 s92, 1, 0
  s_or_b32 s92, s92, s93
  v_mov_b32 v24, s92
  v_lshlrev_b32 v7, 2, v0
  v_add_u32 v25, 14032896, v7
  v_add_u32 v7, 14036992, v7
  s_mov_b32 exec_hi, 0
  buffer_store_dword v24, v25, s[12:15], s18 offen
  s_mov_b64 exec, 1
  buffer_store_dword v24, v7, s[12:15], s18 offen sc1
  s_branch L_asd_6
L_fol_5:
  s_lshl_b32 s31, s91, 12
  s_add_u32 s31, s31, 14032896
  v_mov_b32 v7, s31
  s_mov_b64 exec, 1
L_pb_8:
  buffer_load_dword v24, v7, s[12:15], s18 offen sc1
  s_add_u32 s30, s30, 1
  s_waitcnt vmcnt(0)
  v_readfirstlane_b32 s92, v24
  s_xor_b32 s31, s92, s93
  s_cmp_le_u32 s31, 1
  s_cbranch_scc1 L_asd_6
  s_cmp_lt_u32 s30, 100000
  s_cbranch_scc1 L_pb_8
L_asd_6:
  s_mov_b64 exec, -1
  s_add_u32 m0, s23, 66048
  s_nop 0
  buffer_load_dwordx4 v8, s[12:15], s16 offen lds
  buffer_load_dwordx4 v8, s[12:15], s17 offen offset:1024 lds
  s_add_u32 s16, s16, 16
  s_add_u32 s17, s17, 16
  s_add_u32 m0, s23, 74752
  s_nop 0
  buffer_load_dwordx4 v8, s[12:15], s16 offen lds
  buffer_load_dwordx4 v8, s[12:15], s17 offen offset:1024 lds
  s_add_u32 s16, s16, 16
  s_add_u32 s17, s17, 16
  s_add_u32 m0, s23, 70144
  s_nop 0
  buffer_load_dwordx4 v8, s[12:15], s16 offen lds
  buffer_load_dwordx4 v8, s[12:15], s17 offen offset:1024 lds
  s_add_u32 s16, s16, 16
  s_add_u32 s17, s17, 16
  s_add_u32 m0, s23, 78848
  s_nop 0
  buffer_load_dwordx4 v8, s[12:15], s16 offen lds
  buffer_load_dwordx4 v8, s[12:15], s17 offen offset:1024 lds
  s_lshl_b32 s31, s2, 1
  s_add_u32 s31, s31, s7
  s_cmp_lg_u32 s31, 0
  s_cbranch_scc1 L_nozd
  v_mov_b32 v9, 0
  s_mov_b64 exec, 0xffff
  buffer_store_dword v9, v5, s[32:35], 0 offen sc1
  s_mov_b64 exec, -1
L_nozd:
  s_and_b32 s1, s92, 1
  v_mov_b32 v9, s1
  v_mov_b32 v7, 94548
  ds_write_b32 v7, v9
  v_lshrrev_b32 v1, 3, v0
  v_and_b32 v2, 6, v1
  v_and_b32 v3, 7, v0
  v_xor_b32 v2, v2, v3
  v_lshlrev_b32 v2, 4, v2
  s_waitcnt vmcnt(0) lgkmcnt(0)
  s_barrier
  s_setprio 0
  v_mul_u32_u24 v8, 4096, v1
  v_add_u32 v8, v8, v2
  v_add_u32 v9, 31744, v8
  v_add_u32 v10, 63488, v8
  v_add_u32 v11, 95232, v8
  s_lshl_b32 s54, s7, 15
  s_lshl_b32 s18, s20, 7
  s_add_u32 s54, s54, s18
  s_lshl_b32 s56, s7, 7
  s_lshl_b32 s18, s22, 8
  s_add_u32 s56, s56, s18
  v_lshl_add_u32 v28, v0, 4, s26
  v_add_u32 v29, 0x10000, v28
  v_add_u32 v30, 0x20000, v28
  v_mul_u32_u24 v16, 1024, v1
  v_add_u32 v16, v16, v2
  v_add_u32 v17, 7168, v16
  v_add_u32 v18, 14336, v16
  v_add_u32 v19, 21504, v16
  v_mul_u32_u24 v20, 3584, v1
  v_add_u32 v20, v20, v2
  v_add_u32 v21, 27648, v20
  v_add_u32 v22, 55296, v20
  v_add_u32 v23, 82944, v20
  s_lshl_b32 s25, s7, 17
  s_lshl_b32 s18, s19, 7
  s_add_u32 s25, s25, s18
  s_barrier
  s_lshl_b32 s18, s3, 8
  s_add_u32 s18, s18, 2048
  s_mov_b32 s30, 0
  s_add_u32 s31, s4, s7
  s_cmp_lg_u32 s31, 0
  s_cbranch_scc1 L_fol_10
  v_lshlrev_b32 v7, 4, v0
  v_add_u32 v7, 14028800, v7
L_pa_12:
  buffer_load_dword v24, v7, s[12:15], 0 offen offset:0 sc1
  buffer_load_dword v25, v7, s[12:15], 0 offen offset:1024 sc1
  buffer_load_dword v26, v7, s[12:15], 0 offen offset:2048 sc1
  buffer_load_dword v27, v7, s[12:15], 0 offen offset:3072 sc1
  s_add_u32 s30, s30, 1
  s_waitcnt vmcnt(0)
  v_xor_b32 v24, s93, v24
  v_xor_b32 v25, s93, v25
  v_xor_b32 v26, s93, v26
  v_xor_b32 v27, s93, v27
  v_or3_b32 v24, v24, v26, v27
  v_or_b32 v24, v24, v25
  v_cmp_lt_u32 vcc, 1, v24
  s_cbranch_vccz L_pax_14
  s_cmp_lt_u32 s30, 100000
  s_cbranch_scc1 L_pa_12
L_pax_14:
  v_cmp_eq_u32 vcc, 1, v24
  s_cmp_lg_u64 vcc, 0
  s_cselect_b32 s92, 1, 0
  s_or_b32 s92, s92, s93
  v_mov_b32 v24, s92
  v_lshlrev_b32 v7, 2, v0
  v_add_u32 v25, 14032896, v7
  v_add_u32 v7, 14036992, v7
  s_mov_b32 exec_hi, 0
  buffer_store_dword v24, v25, s[12:15], s18 offen
  s_mov_b64 exec, 1
  buffer_store_dword v24, v7, s[12:15], s18 offen sc1
  s_branch L_asd_11
L_fol_10:
  s_lshl_b32 s31, s91, 12
  s_add_u32 s31, s31, 14032896
  v_mov_b32 v7, s31
  s_mov_b64 exec, 1
L_pb_13:
  buffer_load_dword v24, v7, s[12:15], s18 offen sc1
  s_add_u32 s30, s30, 1
  s_waitcnt vmcnt(0)
  v_readfirstlane_b32 s92, v24
  s_xor_b32 s31, s92, s93
  s_cmp_le_u32 s31, 1
  s_cbranch_scc1 L_asd_11
  s_cmp_lt_u32 s30, 100000
  s_cbranch_scc1 L_pb_13
L_asd_11:
  s_mov_b64 exec, -1
  s_add_u32 m0, s26, 65536
  s_nop 0
  buffer_load_dwordx4 v8, s[12:15], s25 offen offset:0 lds
  buffer_load_dwordx4 v9, s[12:15], s25 offen offset:1024 lds
  buffer_load_dwordx4 v10, s[12:15], s25 offen offset:2048 lds
  buffer_load_dwordx4 v11, s[12:15], s25 offen offset:3072 lds
  s_add_u32 s25, s25, 262144
  s_add_u32 m0, s26, 73728
  s_nop 0
  buffer_load_dwordx4 v8, s[12:15], s25 offen offset:0 lds
  buffer_load_dwordx4 v9, s[12:15], s25 offen offset:1024 lds
  buffer_load_dwordx4 v10, s[12:15], s25 offen offset:2048 lds
  buffer_load_dwordx4 v11, s[12:15], s25 offen offset:3072 lds
  s_add_u32 s25, s25, 262144
  s_add_u32 m0, s26, 81920
  s_nop 0
  buffer_load_dwordx4 v8, s[12:15], s25 offen offset:0 lds
  buffer_load_dwordx4 v9, s[12:15], s25 offen offset:1024 lds
  buffer_load_dwordx4 v10, s[12:15], s25 offen offset:2048 lds
  buffer_load_dwordx4 v11, s[12:15], s25 offen offset:3072 lds
  s_add_u32 s25, s25, 262144
  s_add_u32 m0, s26, 90112
  s_nop 0
  buffer_load_dwordx4 v8, s[12:15], s25 offen offset:0 lds
  buffer_load_dwordx4 v9, s[12:15], s25 offen offset:1024 lds
  buffer_load_dwordx4 v10, s[12:15], s25 offen offset:2048 lds
  buffer_load_dwordx4 v11, s[12:15], s25 offen offset:3072 lds
  s_add_u32 s25, s25, 262144
  s_add_u32 m0, s26, 98304
  s_nop 0
  buffer_load_dwordx4 v8, s[12:15], s25 offen offset:0 lds
  buffer_load_dwordx4 v9, s[12:15], s25 offen offset:1024 lds
  buffer_load_dwordx4 v10, s[12:15], s25 offen offset:2048 lds
  buffer_load_dwordx4 v11, s[12:15], s25 offen offset:3072 lds
  s_add_u32 s25, s25, 262144
  s_add_u32 m0, s26, 106496
  s_nop 0
  buffer_load_dwordx4 v8, s[12:15], s25 offen offset:0 lds
  buffer_load_dwordx4 v9, s[12:15], s25 offen offset:1024 lds
  buffer_load_dwordx4 v10, s[12:15], s25 offen offset:2048 lds
  buffer_load_dwordx4 v11, s[12:15], s25 offen offset:3072 lds
  s_add_u32 s25, s25, 262144
  s_add_u32 m0, s26, 114688
  s_nop 0
  buffer_load_dwordx4 v8, s[12:15], s25 offen offset:0 lds
  buffer_load_dwordx4 v9, s[12:15], s25 offen offset:1024 lds
  buffer_load_dwordx4 v10, s[12:15], s25 offen offset:2048 lds
  buffer_load_dwordx4 v11, s[12:15], s25 offen offset:3072 lds
  s_add_u32 s25, s25, 262144
  s_add_u32 m0, s26, 122880
  s_nop 0
  buffer_load_dwordx4 v8, s[12:15], s25 offen offset:0 lds
  buffer_load_dwordx4 v9, s[12:15], s25 offen offset:1024 lds
  buffer_load_dwordx4 v10, s[12:15], s25 offen offset:2048 lds
  buffer_load_dwordx4 v11, s[12:15], s25 offen offset:3072 lds
  s_add_u32 s25, s25, 262144
  s_waitcnt vmcnt(28)
  s_barrier
  s_waitcnt vmcnt(24)
  s_barrier
  s_waitcnt vmcnt(20)
  s_barrier
  s_waitcnt vmcnt(16)
  s_barrier
  s_waitcnt vmcnt(12)
  s_barrier
  s_waitcnt vmcnt(8)
  s_barrier
  s_waitcnt vmcnt(4)
  s_barrier
  s_waitcnt vmcnt(0)
  s_barrier
  s_barrier
  s_barrier
  s_mov_b32 s8, s44
  s_and_b32 s9, s45, 0xffff
  s_mov_b32 s10, 0x1c0000
  s_mov_b32 s11, 0x20000
  s_add_u32 s18, s56, 1376256
  buffer_load_dwordx4 v[32:35], v20, s[8:11], s18 offen offset:0
  buffer_load_dwordx4 v[36:39], v21, s[8:11], s18 offen offset:1024
  buffer_load_dwordx4 v[40:43], v22, s[8:11], s18 offen offset:2048
  buffer_load_dwordx4 v[44:47], v23, s[8:11], s18 offen offset:3072
  s_add_u32 s18, s56, 1490944
  buffer_load_dwordx4 v[48:51], v20, s[8:11], s18 offen offset:0
  buffer_load_dwordx4 v[52:55], v21, s[8:11], s18 offen offset:1024
  buffer_load_dwordx4 v[56:59], v22, s[8:11], s18 offen offset:2048
  buffer_load_dwordx4 v[60:63], v23, s[8:11], s18 offen offset:3072
  s_add_u32 s18, s56, 1605632
  buffer_load_dwordx4 v[64:67], v20, s[8:11], s18 offen offset:0
  buffer_load_dwordx4 v[68:71], v21, s[8:11], s18 offen offset:1024
  buffer_load_dwordx4 v[72:75], v22, s[8:11], s18 offen offset:2048
  buffer_load_dwordx4 v[76:79], v23, s[8:11], s18 offen offset:3072
  s_add_u32 s18, s56, 1720320
  buffer_load_dwordx4 v[80:83], v20, s[8:11], s18 offen offset:0
  buffer_load_dwordx4 v[84:87], v21, s[8:11], s18 offen offset:1024
  buffer_load_dwordx4 v[88:91], v22, s[8:11], s18 offen offset:2048
  buffer_load_dwordx4 v[92:95], v23, s[8:11], s18 offen offset:3072
  s_barrier
  s_barrier
  s_cmp_lt_u32 s4, 28
  s_cbranch_scc1 L_B_g3
  s_barrier
  s_mov_b32 s8, s46
  s_and_b32 s9, s47, 0xffff
  s_mov_b32 s10, 0x1c0000
  s_mov_b32 s11, 0x20000
  s_add_u32 s18, s54, 1376256
  buffer_load_dwordx4 v[96:99], v16, s[8:11], s18 offen offset:0
  buffer_load_dwordx4 v[100:103], v17, s[8:11], s18 offen offset:1024
  buffer_load_dwordx4 v[104:107], v18, s[8:11], s18 offen offset:2048
  buffer_load_dwordx4 v[108:111], v19, s[8:11], s18 offen offset:3072
  s_add_u32 s18, s54, 1441792
  buffer_load_dwordx4 v[112:115], v16, s[8:11], s18 offen offset:0
  buffer_load_dwordx4 v[116:119], v17, s[8:11], s18 offen offset:1024
  buffer_load_dwordx4 v[120:123], v18, s[8:11], s18 offen offset:2048
  buffer_load_dwordx4 v[124:127], v19, s[8:11], s18 offen offset:3072
  s_add_u32 s18, s54, 196608
  buffer_load_dwordx4 v[128:131], v16, s[8:11], s18 offen offset:0
  buffer_load_dwordx4 v[132:135], v17, s[8:11], s18 offen offset:1024
  buffer_load_dwordx4 v[136:139], v18, s[8:11], s18 offen offset:2048
  buffer_load_dwordx4 v[140:143], v19, s[8:11], s18 offen offset:3072
  s_add_u32 s18, s54, 1048576
  buffer_load_dwordx4 v[144:147], v16, s[8:11], s18 offen offset:0
  buffer_load_dwordx4 v[148:151], v17, s[8:11], s18 offen offset:1024
  buffer_load_dwordx4 v[152:155], v18, s[8:11], s18 offen offset:2048
  buffer_load_dwordx4 v[156:159], v19, s[8:11], s18 offen offset:3072
  s_add_u32 s18, s54, 1507328
  buffer_load_dwordx4 v[160:163], v16, s[8:11], s18 offen offset:0
  buffer_load_dwordx4 v[164:167], v17, s[8:11], s18 offen offset:1024
  buffer_load_dwordx4 v[168:171], v18, s[8:11], s18 offen offset:2048
  buffer_load_dwordx4 v[172:175], v19, s[8:11], s18 offen offset:3072
  s_waitcnt vmcnt(16)
  ds_write_b128 v29, v[96:99] offset:57344
  ds_write_b128 v29, v[100:103] offset:58368
  ds_write_b128 v29, v[104:107] offset:59392
  ds_write_b128 v29, v[108:111] offset:60416
  s_waitcnt vmcnt(12)
  ds_write_b128 v30, v[112:115] offset:0
  ds_write_b128 v30, v[116:119] offset:1024
  ds_write_b128 v30, v[120:123] offset:2048
  ds_write_b128 v30, v[124:127] offset:3072
  s_waitcnt vmcnt(8)
  ds_write_b128 v28, v[128:131] offset:24576
  ds_write_b128 v28, v[132:135] offset:25600
  ds_write_b128 v28, v[136:139] offset:26624
  ds_write_b128 v28, v[140:143] offset:27648
  s_waitcnt vmcnt(4)
  ds_write_b128 v29, v[144:147] offset:32768
  ds_write_b128 v29, v[148:151] offset:33792
  ds_write_b128 v29, v[152:155] offset:34816
  ds_write_b128 v29, v[156:159] offset:35840
  s_waitcnt vmcnt(0)
  ds_write_b128 v30, v[160:163] offset:8192
  ds_write_b128 v30, v[164:167] offset:9216
  ds_write_b128 v30, v[168:171] offset:10240
  ds_write_b128 v30, v[172:175] offset:11264
  s_branch L_B_g4
L_B_g3:
  s_barrier
  s_waitcnt vmcnt(12)
  ds_write_b128 v30, v[32:35] offset:0
  ds_write_b128 v30, v[36:39] offset:1024
  ds_write_b128 v30, v[40:43] offset:2048
  ds_write_b128 v30, v[44:47] offset:3072
  s_waitcnt vmcnt(8)
  ds_write_b128 v30, v[48:51] offset:8192
  ds_write_b128 v30, v[52:55] offset:9216
  ds_write_b128 v30, v[56:59] offset:10240
  ds_write_b128 v30, v[60:63] offset:11264
  s_waitcnt vmcnt(4)
  ds_write_b128 v30, v[64:67] offset:16384
  ds_write_b128 v30, v[68:71] offset:17408
  ds_write_b128 v30, v[72:75] offset:18432
  ds_write_b128 v30, v[76:79] offset:19456
  s_waitcnt vmcnt(0)
  ds_write_b128 v30, v[80:83] offset:24576
  ds_write_b128 v30, v[84:87] offset:25600
  ds_write_b128 v30, v[88:91] offset:26624
  ds_write_b128 v30, v[92:95] offset:27648
  v_lshrrev_b32 v1, 2, v0
  v_lshlrev_b32 v1, 7, v1
  v_and_b32 v2, 3, v0
  v_lshl_add_u32 v1, v2, 3, v1
  v_bfe_u32 v2, v0, 3, 2
  v_add_u32 v1, s26, v1
  v_lshl_add_u32 v116, v2, 5, v1
  v_xor_b32 v117, 32, v116
  v_xor_b32 v118, 64, v116
  v_xor_b32 v119, 96, v116
  v_add_u32 v120, 0x10000, v116
  v_add_u32 v121, 0x10000, v117
  v_add_u32 v122, 0x10000, v118
  v_add_u32 v123, 0x10000, v119
  v_add_u32 v124, 0x20000, v116
  v_add_u32 v125, 0x20000, v117
  v_add_u32 v126, 0x20000, v118
  v_add_u32 v127, 0x20000, v119
  v_mov_b32 v112, 0x3f803f80
  v_mov_b32 v113, 0x3f803f80
  v_mov_b32 v114, 0x3f803f80
  v_mov_b32 v115, 0x3f803f80
  ds_read_b64_tr_b16 v[32:33], v116 offset:32768
  ds_read_b64_tr_b16 v[34:35], v116 offset:34816
  ds_read_b64_tr_b16 v[36:37], v117 offset:32768
  ds_read_b64_tr_b16 v[38:39], v117 offset:34816
  ds_read_b64_tr_b16 v[40:41], v118 offset:32768
  ds_read_b64_tr_b16 v[42:43], v118 offset:34816
  ds_read_b64_tr_b16 v[44:45], v119 offset:32768
  ds_read_b64_tr_b16 v[46:47], v119 offset:34816
  ds_read_b64_tr_b16 v[48:49], v116 offset:40960
  ds_read_b64_tr_b16 v[50:51], v116 offset:43008
  ds_read_b64_tr_b16 v[52:53], v117 offset:40960
  ds_read_b64_tr_b16 v[54:55], v117 offset:43008
  ds_read_b64_tr_b16 v[56:57], v118 offset:40960
  ds_read_b64_tr_b16 v[58:59], v118 offset:43008
  ds_read_b64_tr_b16 v[60:61], v119 offset:40960
  ds_read_b64_tr_b16 v[62:63], v119 offset:43008
  s_waitcnt lgkmcnt(14)
  v_mfma_f32_16x16x32_bf16 v[96:99], v[32:35], v[112:115], 0
  s_waitcnt lgkmcnt(12)
  v_mfma_f32_16x16x32_bf16 v[100:103], v[36:39], v[112:115], 0
  s_waitcnt lgkmcnt(10)
  v_mfma_f32_16x16x32_bf16 v[104:107], v[40:43], v[112:115], 0
  s_waitcnt lgkmcnt(8)
  v_mfma_f32_16x16x32_bf16 v[108:111], v[44:47], v[112:115], 0
  ds_read_b64_tr_b16 v[32:33], v116 offset:49152
  ds_read_b64_tr_b16 v[34:35], v116 offset:51200
  ds_read_b64_tr_b16 v[36:37], v117 offset:49152
  ds_read_b64_tr_b16 v[38:39], v117 offset:51200
  ds_read_b64_tr_b16 v[40:41], v118 offset:49152
  ds_read_b64_tr_b16 v[42:43], v118 offset:51200
  ds_read_b64_tr_b16 v[44:45], v119 offset:49152
  ds_read_b64_tr_b16 v[46:47], v119 offset:51200
  s_waitcnt lgkmcnt(14)
  v_mfma_f32_16x16x32_bf16 v[96:99], v[48:51], v[112:115], v[96:99]
  s_waitcnt lgkmcnt(12)
  v_mfma_f32_16x16x32_bf16 v[100:103], v[52:55], v[112:115], v[100:103]
  s_waitcnt lgkmcnt(10)
  v_mfma_f32_16x16x32_bf16 v[104:107], v[56:59], v[112:115], v[104:107]
  s_waitcnt lgkmcnt(8)
  v_mfma_f32_16x16x32_bf16 v[108:111], v[60:63], v[112:115], v[108:111]
  ds_read_b64_tr_b16 v[48:49], v116 offset:57344
  ds_read_b64_tr_b16 v[50:51], v116 offset:59392
  ds_read_b64_tr_b16 v[52:53], v117 offset:57344
  ds_read_b64_tr_b16 v[54:55], v117 offset:59392
  ds_read_b64_tr_b16 v[56:57], v118 offset:57344
  ds_read_b64_tr_b16 v[58:59], v118 offset:59392
  ds_read_b64_tr_b16 v[60:61], v119 offset:57344
  ds_read_b64_tr_b16 v[62:63], v119 offset:59392
  s_waitcnt lgkmcnt(14)
  v_mfma_f32_16x16x32_bf16 v[96:99], v[32:35], v[112:115], v[96:99]
  s_waitcnt lgkmcnt(12)
  v_mfma_f32_16x16x32_bf16 v[100:103], v[36:39], v[112:115], v[100:103]
  s_waitcnt lgkmcnt(10)
  v_mfma_f32_16x16x32_bf16 v[104:107], v[40:43], v[112:115], v[104:107]
  s_waitcnt lgkmcnt(8)
  v_mfma_f32_16x16x32_bf16 v[108:111], v[44:47], v[112:115], v[108:111]
  ds_read_b64_tr_b16 v[32:33], v120 offset:0
  ds_read_b64_tr_b16 v[34:35], v120 offset:2048
  ds_read_b64_tr_b16 v[36:37], v121 offset:0
  ds_read_b64_tr_b16 v[38:39], v121 offset:2048
  ds_read_b64_tr_b16 v[40:41], v122 offset:0
  ds_read_b64_tr_b16 v[42:43], v122 offset:2048
  ds_read_b64_tr_b16 v[44:45], v123 offset:0
  ds_read_b64_tr_b16 v[46:47], v123 offset:2048
  s_waitcnt lgkmcnt(14)
  v_mfma_f32_16x16x32_bf16 v[96:99], v[48:51], v[112:115], v[96:99]
  s_waitcnt lgkmcnt(12)
  v_mfma_f32_16x16x32_bf16 v[100:103], v[52:55], v[112:115], v[100:103]
  s_waitcnt lgkmcnt(10)
  v_mfma_f32_16x16x32_bf16 v[104:107], v[56:59], v[112:115], v[104:107]
  s_waitcnt lgkmcnt(8)
  v_mfma_f32_16x16x32_bf16 v[108:111], v[60:63], v[112:115], v[108:111]
  ds_read_b64_tr_b16 v[48:49], v120 offset:8192
  ds_read_b64_tr_b16 v[50:51], v120 offset:10240
  ds_read_b64_tr_b16 v[52:53], v121 offset:8192
  ds_read_b64_tr_b16 v[54:55], v121 offset:10240
  ds_read_b64_tr_b16 v[56:57], v122 offset:8192
  ds_read_b64_tr_b16 v[58:59], v122 offset:10240
  ds_read_b64_tr_b16 v[60:61], v123 offset:8192
  ds_read_b64_tr_b16 v[62:63], v123 offset:10240
  s_waitcnt lgkmcnt(14)
  v_mfma_f32_16x16x32_bf16 v[96:99], v[32:35], v[112:115], v[96:99]
  s_waitcnt lgkmcnt(12)
  v_mfma_f32_16x16x32_bf16 v[100:103], v[36:39], v[112:115], v[100:103]
  s_waitcnt lgkmcnt(10)
  v_mfma_f32_16x16x32_bf16 v[104:107], v[40:43], v[112:115], v[104:107]
  s_waitcnt lgkmcnt(8)
  v_mfma_f32_16x16x32_bf16 v[108:111], v[44:47], v[112:115], v[108:111]
  ds_read_b64_tr_b16 v[32:33], v120 offset:16384
  ds_read_b64_tr_b16 v[34:35], v120 offset:18432
  ds_read_b64_tr_b16 v[36:37], v121 offset:16384
  ds_read_b64_tr_b16 v[38:39], v121 offset:18432
  ds_read_b64_tr_b16 v[40:41], v122 offset:16384
  ds_read_b64_tr_b16 v[42:43], v122 offset:18432
  ds_read_b64_tr_b16 v[44:45], v123 offset:16384
  ds_read_b64_tr_b16 v[46:47], v123 offset:18432
  s_waitcnt lgkmcnt(14)
  v_mfma_f32_16x16x32_bf16 v[96:99], v[48:51], v[112:115], v[96:99]
  s_waitcnt lgkmcnt(12)
  v_mfma_f32_16x16x32_bf16 v[100:103], v[52:55], v[112:115], v[100:103]
  s_waitcnt lgkmcnt(10)
  v_mfma_f32_16x16x32_bf16 v[104:107], v[56:59], v[112:115], v[104:107]
  s_waitcnt lgkmcnt(8)
  v_mfma_f32_16x16x32_bf16 v[108:111], v[60:63], v[112:115], v[108:111]
  ds_read_b64_tr_b16 v[48:49], v120 offset:24576
  ds_read_b64_tr_b16 v[50:51], v120 offset:26624
  ds_read_b64_tr_b16 v[52:53], v121 offset:24576
  ds_read_b64_tr_b16 v[54:55], v121 offset:26624
  ds_read_b64_tr_b16 v[56:57], v122 offset:24576
  ds_read_b64_tr_b16 v[58:59], v122 offset:26624
  ds_read_b64_tr_b16 v[60:61], v123 offset:24576
  ds_read_b64_tr_b16 v[62:63], v123 offset:26624
  s_waitcnt lgkmcnt(14)
  v_mfma_f32_16x16x32_bf16 v[96:99], v[32:35], v[112:115], v[96:99]
  s_waitcnt lgkmcnt(12)
  v_mfma_f32_16x16x32_bf16 v[100:103], v[36:39], v[112:115], v[100:103]
  s_waitcnt lgkmcnt(10)
  v_mfma_f32_16x16x32_bf16 v[104:107], v[40:43], v[112:115], v[104:107]
  s_waitcnt lgkmcnt(8)
  v_mfma_f32_16x16x32_bf16 v[108:111], v[44:47], v[112:115], v[108:111]
  ds_read_b64_tr_b16 v[32:33], v120 offset:32768
  ds_read_b64_tr_b16 v[34:35], v120 offset:34816
  ds_read_b64_tr_b16 v[36:37], v121 offset:32768
  ds_read_b64_tr_b16 v[38:39], v121 offset:34816
  ds_read_b64_tr_b16 v[40:41], v122 offset:32768
  ds_read_b64_tr_b16 v[42:43], v122 offset:34816
  ds_read_b64_tr_b16 v[44:45], v123 offset:32768
  ds_read_b64_tr_b16 v[46:47], v123 offset:34816
  s_waitcnt lgkmcnt(14)
  v_mfma_f32_16x16x32_bf16 v[96:99], v[48:51], v[112:115], v[96:99]
  s_waitcnt lgkmcnt(12)
  v_mfma_f32_16x16x32_bf16 v[100:103], v[52:55], v[112:115], v[100:103]
  s_waitcnt lgkmcnt(10)
  v_mfma_f32_16x16x32_bf16 v[104:107], v[56:59], v[112:115], v[104:107]
  s_waitcnt lgkmcnt(8)
  v_mfma_f32_16x16x32_bf16 v[108:111], v[60:63], v[112:115], v[108:111]
  ds_read_b64_tr_b16 v[48:49], v120 offset:40960
  ds_read_b64_tr_b16 v[50:51], v120 offset:43008
  ds_read_b64_tr_b16 v[52:53], v121 offset:40960
  ds_read_b64_tr_b16 v[54:55], v121 offset:43008
  ds_read_b64_tr_b16 v[56:57], v122 offset:40960
  ds_read_b64_tr_b16 v[58:59], v122 offset:43008
  ds_read_b64_tr_b16 v[60:61], v123 offset:40960
  ds_read_b64_tr_b16 v[62:63], v123 offset:43008
  s_waitcnt lgkmcnt(14)
  v_mfma_f32_16x16x32_bf16 v[96:99], v[32:35], v[112:115], v[96:99]
  s_waitcnt lgkmcnt(12)
  v_mfma_f32_16x16x32_bf16 v[100:103], v[36:39], v[112:115], v[100:103]
  s_waitcnt lgkmcnt(10)
  v_mfma_f32_16x16x32_bf16 v[104:107], v[40:43], v[112:115], v[104:107]
  s_waitcnt lgkmcnt(8)
  v_mfma_f32_16x16x32_bf16 v[108:111], v[44:47], v[112:115], v[108:111]
  ds_read_b64_tr_b16 v[32:33], v120 offset:49152
  ds_read_b64_tr_b16 v[34:35], v120 offset:51200
  ds_read_b64_tr_b16 v[36:37], v121 offset:49152
  ds_read_b64_tr_b16 v[38:39], v121 offset:51200
  ds_read_b64_tr_b16 v[40:41], v122 offset:49152
  ds_read_b64_tr_b16 v[42:43], v122 offset:51200
  ds_read_b64_tr_b16 v[44:45], v123 offset:49152
  ds_read_b64_tr_b16 v[46:47], v123 offset:51200
  s_waitcnt lgkmcnt(14)
  v_mfma_f32_16x16x32_bf16 v[96:99], v[48:51], v[112:115], v[96:99]
  s_waitcnt lgkmcnt(12)
  v_mfma_f32_16x16x32_bf16 v[100:103], v[52:55], v[112:115], v[100:103]
  s_waitcnt lgkmcnt(10)
  v_mfma_f32_16x16x32_bf16 v[104:107], v[56:59], v[112:115], v[104:107]
  s_waitcnt lgkmcnt(8)
  v_mfma_f32_16x16x32_bf16 v[108:111], v[60:63], v[112:115], v[108:111]
  ds_read_b64_tr_b16 v[48:49], v120 offset:57344
  ds_read_b64_tr_b16 v[50:51], v120 offset:59392
  ds_read_b64_tr_b16 v[52:53], v121 offset:57344
  ds_read_b64_tr_b16 v[54:55], v121 offset:59392
  ds_read_b64_tr_b16 v[56:57], v122 offset:57344
  ds_read_b64_tr_b16 v[58:59], v122 offset:59392
  ds_read_b64_tr_b16 v[60:61], v123 offset:57344
  ds_read_b64_tr_b16 v[62:63], v123 offset:59392
  s_waitcnt lgkmcnt(14)
  v_mfma_f32_16x16x32_bf16 v[96:99], v[32:35], v[112:115], v[96:99]
  s_waitcnt lgkmcnt(12)
  v_mfma_f32_16x16x32_bf16 v[100:103], v[36:39], v[112:115], v[100:103]
  s_waitcnt lgkmcnt(10)
  v_mfma_f32_16x16x32_bf16 v[104:107], v[40:43], v[112:115], v[104:107]
  s_waitcnt lgkmcnt(8)
  v_mfma_f32_16x16x32_bf16 v[108:111], v[44:47], v[112:115], v[108:111]
  ds_read_b64_tr_b16 v[32:33], v124 offset:0
  ds_read_b64_tr_b16 v[34:35], v124 offset:2048
  ds_read_b64_tr_b16 v[36:37], v125 offset:0
  ds_read_b64_tr_b16 v[38:39], v125 offset:2048
  ds_read_b64_tr_b16 v[40:41], v126 offset:0
  ds_read_b64_tr_b16 v[42:43], v126 offset:2048
  ds_read_b64_tr_b16 v[44:45], v127 offset:0
  ds_read_b64_tr_b16 v[46:47], v127 offset:2048
  s_waitcnt lgkmcnt(14)
  v_mfma_f32_16x16x32_bf16 v[96:99], v[48:51], v[112:115], v[96:99]
  s_waitcnt lgkmcnt(12)
  v_mfma_f32_16x16x32_bf16 v[100:103], v[52:55], v[112:115], v[100:103]
  s_waitcnt lgkmcnt(10)
  v_mfma_f32_16x16x32_bf16 v[104:107], v[56:59], v[112:115], v[104:107]
  s_waitcnt lgkmcnt(8)
  v_mfma_f32_16x16x32_bf16 v[108:111], v[60:63], v[112:115], v[108:111]
  ds_read_b64_tr_b16 v[48:49], v124 offset:8192
  ds_read_b64_tr_b16 v[50:51], v124 offset:10240
  ds_read_b64_tr_b16 v[52:53], v125 offset:8192
  ds_read_b64_tr_b16 v[54:55], v125 offset:10240
  ds_read_b64_tr_b16 v[56:57], v126 offset:8192
  ds_read_b64_tr_b16 v[58:59], v126 offset:10240
  ds_read_b64_tr_b16 v[60:61], v127 offset:8192
  ds_read_b64_tr_b16 v[62:63], v127 offset:10240
  s_waitcnt lgkmcnt(14)
  v_mfma_f32_16x16x32_bf16 v[96:99], v[32:35], v[112:115], v[96:99]
  s_waitcnt lgkmcnt(12)
  v_mfma_f32_16x16x32_bf16 v[100:103], v[36:39], v[112:115], v[100:103]
  s_waitcnt lgkmcnt(10)
  v_mfma_f32_16x16x32_bf16 v[104:107], v[40:43], v[112:115], v[104:107]
  s_waitcnt lgkmcnt(8)
  v_mfma_f32_16x16x32_bf16 v[108:111], v[44:47], v[112:115], v[108:111]
  ds_read_b64_tr_b16 v[32:33], v124 offset:16384
  ds_read_b64_tr_b16 v[34:35], v124 offset:18432
  ds_read_b64_tr_b16 v[36:37], v125 offset:16384
  ds_read_b64_tr_b16 v[38:39], v125 offset:18432
  ds_read_b64_tr_b16 v[40:41], v126 offset:16384
  ds_read_b64_tr_b16 v[42:43], v126 offset:18432
  ds_read_b64_tr_b16 v[44:45], v127 offset:16384
  ds_read_b64_tr_b16 v[46:47], v127 offset:18432
  s_waitcnt lgkmcnt(14)
  v_mfma_f32_16x16x32_bf16 v[96:99], v[48:51], v[112:115], v[96:99]
  s_waitcnt lgkmcnt(12)
  v_mfma_f32_16x16x32_bf16 v[100:103], v[52:55], v[112:115], v[100:103]
  s_waitcnt lgkmcnt(10)
  v_mfma_f32_16x16x32_bf16 v[104:107], v[56:59], v[112:115], v[104:107]
  s_waitcnt lgkmcnt(8)
  v_mfma_f32_16x16x32_bf16 v[108:111], v[60:63], v[112:115], v[108:111]
  ds_read_b64_tr_b16 v[48:49], v124 offset:24576
  ds_read_b64_tr_b16 v[50:51], v124 offset:26624
  ds_read_b64_tr_b16 v[52:53], v125 offset:24576
  ds_read_b64_tr_b16 v[54:55], v125 offset:26624
  ds_read_b64_tr_b16 v[56:57], v126 offset:24576
  ds_read_b64_tr_b16 v[58:59], v126 offset:26624
  ds_read_b64_tr_b16 v[60:61], v127 offset:24576
  ds_read_b64_tr_b16 v[62:63], v127 offset:26624
  s_waitcnt lgkmcnt(14)
  v_mfma_f32_16x16x32_bf16 v[96:99], v[32:35], v[112:115], v[96:99]
  s_waitcnt lgkmcnt(12)
  v_mfma_f32_16x16x32_bf16 v[100:103], v[36:39], v[112:115], v[100:103]
  s_waitcnt lgkmcnt(10)
  v_mfma_f32_16x16x32_bf16 v[104:107], v[40:43], v[112:115], v[104:107]
  s_waitcnt lgkmcnt(8)
  v_mfma_f32_16x16x32_bf16 v[108:111], v[44:47], v[112:115], v[108:111]
  s_waitcnt lgkmcnt(6)
  v_mfma_f32_16x16x32_bf16 v[96:99], v[48:51], v[112:115], v[96:99]
  s_waitcnt lgkmcnt(4)
  v_mfma_f32_16x16x32_bf16 v[100:103], v[52:55], v[112:115], v[100:103]
  s_waitcnt lgkmcnt(2)
  v_mfma_f32_16x16x32_bf16 v[104:107], v[56:59], v[112:115], v[104:107]
  s_waitcnt lgkmcnt(0)
  v_mfma_f32_16x16x32_bf16 v[108:111], v[60:63], v[112:115], v[108:111]
  s_nop 7
  s_nop 7
  ds_write_b128 v28, v[96:99] offset:24576
  ds_write_b128 v28, v[100:103] offset:25600
  ds_write_b128 v28, v[104:107] offset:26624
  ds_write_b128 v28, v[108:111] offset:27648
  s_waitcnt lgkmcnt(0)
  s_waitcnt lgkmcnt(0)
  s_barrier
  s_mov_b32 s8, s46
  s_and_b32 s9, s47, 0xffff
  s_mov_b32 s10, 0x1c0000
  s_mov_b32 s11, 0x20000
  s_add_u32 s18, s54, 1376256
  buffer_load_dwordx4 v[96:99], v16, s[8:11], s18 offen offset:0
  buffer_load_dwordx4 v[100:103], v17, s[8:11], s18 offen offset:1024
  buffer_load_dwordx4 v[104:107], v18, s[8:11], s18 offen offset:2048
  buffer_load_dwordx4 v[108:111], v19, s[8:11], s18 offen offset:3072
  s_add_u32 s18, s54, 1441792
  buffer_load_dwordx4 v[112:115], v16, s[8:11], s18 offen offset:0
  buffer_load_dwordx4 v[116:119], v17, s[8:11], s18 offen offset:1024
  buffer_load_dwordx4 v[120:123], v18, s[8:11], s18 offen offset:2048
  buffer_load_dwordx4 v[124:127], v19, s[8:11], s18 offen offset:3072
  s_add_u32 s18, s54, 196608
  buffer_load_dwordx4 v[128:131], v16, s[8:11], s18 offen offset:0
  buffer_load_dwordx4 v[132:135], v17, s[8:11], s18 offen offset:1024
  buffer_load_dwordx4 v[136:139], v18, s[8:11], s18 offen offset:2048
  buffer_load_dwordx4 v[140:143], v19, s[8:11], s18 offen offset:3072
  s_add_u32 s18, s54, 1048576
  buffer_load_dwordx4 v[144:147], v16, s[8:11], s18 offen offset:0
  buffer_load_dwordx4 v[148:151], v17, s[8:11], s18 offen offset:1024
  buffer_load_dwordx4 v[152:155], v18, s[8:11], s18 offen offset:2048
  buffer_load_dwordx4 v[156:159], v19, s[8:11], s18 offen offset:3072
  s_add_u32 s18, s54, 1507328
  buffer_load_dwordx4 v[160:163], v16, s[8:11], s18 offen offset:0
  buffer_load_dwordx4 v[164:167], v17, s[8:11], s18 offen offset:1024
  buffer_load_dwordx4 v[168:171], v18, s[8:11], s18 offen offset:2048
  buffer_load_dwordx4 v[172:175], v19, s[8:11], s18 offen offset:3072
  s_barrier
  s_waitcnt vmcnt(16)
  ds_write_b128 v29, v[96:99] offset:57344
  ds_write_b128 v29, v[100:103] offset:58368
  ds_write_b128 v29, v[104:107] offset:59392
  ds_write_b128 v29, v[108:111] offset:60416
  s_waitcnt vmcnt(12)
  ds_write_b128 v30, v[112:115] offset:0
  ds_write_b128 v30, v[116:119] offset:1024
  ds_write_b128 v30, v[120:123] offset:2048
  ds_write_b128 v30, v[124:127] offset:3072
  s_waitcnt vmcnt(8)
  ds_write_b128 v28, v[128:131] offset:24576
  ds_write_b128 v28, v[132:135] offset:25600
  ds_write_b128 v28, v[136:139] offset:26624
  ds_write_b128 v28, v[140:143] offset:27648
  s_waitcnt vmcnt(4)
  ds_write_b128 v29, v[144:147] offset:32768
  ds_write_b128 v29, v[148:151] offset:33792
  ds_write_b128 v29, v[152:155] offset:34816
  ds_write_b128 v29, v[156:159] offset:35840
  s_waitcnt vmcnt(0)
  ds_write_b128 v30, v[160:163] offset:8192
  ds_write_b128 v30, v[164:167] offset:9216
  ds_write_b128 v30, v[168:171] offset:10240
  ds_write_b128 v30, v[172:175] offset:11264
L_B_g4:
  s_waitcnt vmcnt(0) lgkmcnt(0)
  s_barrier
  s_endpgm
L_aload2:
  s_lshr_b32 s19, s4, 3
  s_lshl_b32 s18, s3, 2
  s_add_u32 s19, s19, s18
  s_and_b32 s20, s4, 7
  s_cmp_ge_u32 s4, 14
  s_cselect_b32 s22, 14, 0
  s_sub_u32 s22, s4, s22
  s_barrier
  v_lshrrev_b32 v1, 3, v0
  v_and_b32 v2, 6, v1
  v_and_b32 v3, 7, v0
  v_xor_b32 v2, v2, v3
  v_lshlrev_b32 v2, 4, v2
  s_lshl_b32 s54, s7, 15
  s_lshl_b32 s18, s20, 7
  s_add_u32 s54, s54, s18
  s_lshl_b32 s56, s7, 7
  s_lshl_b32 s18, s22, 8
  s_add_u32 s56, s56, s18
  v_lshl_add_u32 v28, v0, 4, s26
  v_add_u32 v29, 0x10000, v28
  v_add_u32 v30, 0x20000, v28
  v_mul_u32_u24 v16, 1024, v1
  v_add_u32 v16, v16, v2
  v_add_u32 v17, 7168, v16
  v_add_u32 v18, 14336, v16
  v_add_u32 v19, 21504, v16
  v_mul_u32_u24 v20, 3584, v1
  v_add_u32 v20, v20, v2
  v_add_u32 v21, 27648, v20
  v_add_u32 v22, 55296, v20
  v_add_u32 v23, 82944, v20
  s_waitcnt lgkmcnt(0)
  s_mov_b32 s12, s52
  s_and_b32 s13, s53, 0xffff
  s_mov_b32 s14, 0x1200000
  s_mov_b32 s15, 0x20000
  s_barrier
  s_setprio 0
  s_mov_b32 s8, s42
  s_and_b32 s9, s43, 0xffff
  s_mov_b32 s10, 0x80000
  s_mov_b32 s11, 0x20000
  s_lshl_b32 s18, s4, 1
  s_add_u32 s18, s18, s7
  s_mul_i32 s18, s18, 8192
  s_add_u32 s18, s18, 0
  v_lshlrev_b32 v7, 7, v0
  buffer_load_dword v24, v7, s[8:11], s18 offen
  s_mov_b32 s8, s44
  s_and_b32 s9, s45, 0xffff
  s_mov_b32 s10, 0x1c0000
  s_mov_b32 s11, 0x20000
  s_lshl_b32 s18, s4, 1
  s_add_u32 s18, s18, s7
  s_mul_i32 s18, s18, 28672
  s_add_u32 s18, s18, 0
  v_lshlrev_b32 v7, 7, v0
  buffer_load_dword v24, v7, s[8:11], s18 offen
  s_mov_b32 s8, s40
  s_and_b32 s9, s41, 0xffff
  s_mov_b32 s10, 0x80000
  s_mov_b32 s11, 0x20000
  s_add_u32 s18, s54, 0
  s_add_u32 m0, s26, 0
  s_nop 0
  buffer_load_dwordx4 v16, s[8:11], s18 offen offset:0 lds
  buffer_load_dwordx4 v17, s[8:11], s18 offen offset:1024 lds
  buffer_load_dwordx4 v18, s[8:11], s18 offen offset:2048 lds
  buffer_load_dwordx4 v19, s[8:11], s18 offen offset:3072 lds
  s_add_u32 s18, s54, 65536
  s_add_u32 m0, s26, 8192
  s_nop 0
  buffer_load_dwordx4 v16, s[8:11], s18 offen offset:0 lds
  buffer_load_dwordx4 v17, s[8:11], s18 offen offset:1024 lds
  buffer_load_dwordx4 v18, s[8:11], s18 offen offset:2048 lds
  buffer_load_dwordx4 v19, s[8:11], s18 offen offset:3072 lds
  s_add_u32 s18, s54, 131072
  s_add_u32 m0, s26, 16384
  s_nop 0
  buffer_load_dwordx4 v16, s[8:11], s18 offen offset:0 lds
  buffer_load_dwordx4 v17, s[8:11], s18 offen offset:1024 lds
  buffer_load_dwordx4 v18, s[8:11], s18 offen offset:2048 lds
  buffer_load_dwordx4 v19, s[8:11], s18 offen offset:3072 lds
  s_add_u32 s18, s54, 196608
  s_add_u32 m0, s26, 24576
  s_nop 0
  buffer_load_dwordx4 v16, s[8:11], s18 offen offset:0 lds
  buffer_load_dwordx4 v17, s[8:11], s18 offen offset:1024 lds
  buffer_load_dwordx4 v18, s[8:11], s18 offen offset:2048 lds
  buffer_load_dwordx4 v19, s[8:11], s18 offen offset:3072 lds
  s_add_u32 s18, s54, 262144
  s_add_u32 m0, s26, 32768
  s_nop 0
  buffer_load_dwordx4 v16, s[8:11], s18 offen offset:0 lds
  buffer_load_dwordx4 v17, s[8:11], s18 offen offset:1024 lds
  buffer_load_dwordx4 v18, s[8:11], s18 offen offset:2048 lds
  buffer_load_dwordx4 v19, s[8:11], s18 offen offset:3072 lds
  s_add_u32 s18, s54, 327680
  s_add_u32 m0, s26, 40960
  s_nop 0
  buffer_load_dwordx4 v16, s[8:11], s18 offen offset:0 lds
  buffer_load_dwordx4 v17, s[8:11], s18 offen offset:1024 lds
  buffer_load_dwordx4 v18, s[8:11], s18 offen offset:2048 lds
  buffer_load_dwordx4 v19, s[8:11], s18 offen offset:3072 lds
  s_add_u32 s18, s54, 393216
  s_add_u32 m0, s26, 49152
  s_nop 0
  buffer_load_dwordx4 v16, s[8:11], s18 offen offset:0 lds
  buffer_load_dwordx4 v17, s[8:11], s18 offen offset:1024 lds
  buffer_load_dwordx4 v18, s[8:11], s18 offen offset:2048 lds
  buffer_load_dwordx4 v19, s[8:11], s18 offen offset:3072 lds
  s_add_u32 s18, s54, 458752
  s_add_u32 m0, s26, 57344
  s_nop 0
  buffer_load_dwordx4 v16, s[8:11], s18 offen offset:0 lds
  buffer_load_dwordx4 v17, s[8:11], s18 offen offset:1024 lds
  buffer_load_dwordx4 v18, s[8:11], s18 offen offset:2048 lds
  buffer_load_dwordx4 v19, s[8:11], s18 offen offset:3072 lds
  s_mov_b32 s8, s42
  s_and_b32 s9, s43, 0xffff
  s_mov_b32 s10, 0x80000
  s_mov_b32 s11, 0x20000
  s_add_u32 s18, s54, 0
  s_add_u32 m0, s26, 131072
  s_nop 0
  buffer_load_dwordx4 v16, s[8:11], s18 offen offset:0 lds
  buffer_load_dwordx4 v17, s[8:11], s18 offen offset:1024 lds
  buffer_load_dwordx4 v18, s[8:11], s18 offen offset:2048 lds
  buffer_load_dwordx4 v19, s[8:11], s18 offen offset:3072 lds
  s_add_u32 s18, s54, 65536
  s_add_u32 m0, s26, 139264
  s_nop 0
  buffer_load_dwordx4 v16, s[8:11], s18 offen offset:0 lds
  buffer_load_dwordx4 v17, s[8:11], s18 offen offset:1024 lds
  buffer_load_dwordx4 v18, s[8:11], s18 offen offset:2048 lds
  buffer_load_dwordx4 v19, s[8:11], s18 offen offset:3072 lds
  s_add_u32 s18, s54, 131072
  s_add_u32 m0, s26, 147456
  s_nop 0
  buffer_load_dwordx4 v16, s[8:11], s18 offen offset:0 lds
  buffer_load_dwordx4 v17, s[8:11], s18 offen offset:1024 lds
  buffer_load_dwordx4 v18, s[8:11], s18 offen offset:2048 lds
  buffer_load_dwordx4 v19, s[8:11], s18 offen offset:3072 lds
  s_add_u32 s18, s54, 196608
  s_add_u32 m0, s26, 155648
  s_nop 0
  buffer_load_dwordx4 v16, s[8:11], s18 offen offset:0 lds
  buffer_load_dwordx4 v17, s[8:11], s18 offen offset:1024 lds
  buffer_load_dwordx4 v18, s[8:11], s18 offen offset:2048 lds
  buffer_load_dwordx4 v19, s[8:11], s18 offen offset:3072 lds
  s_waitcnt vmcnt(16)
  s_barrier
  s_barrier
  s_barrier
  s_barrier
  s_add_u32 s18, s54, 262144
  s_add_u32 m0, s26, 0
  s_nop 0
  buffer_load_dwordx4 v16, s[8:11], s18 offen offset:0 lds
  buffer_load_dwordx4 v17, s[8:11], s18 offen offset:1024 lds
  buffer_load_dwordx4 v18, s[8:11], s18 offen offset:2048 lds
  buffer_load_dwordx4 v19, s[8:11], s18 offen offset:3072 lds
  s_mov_b32 s8, s44
  s_and_b32 s9, s45, 0xffff
  s_mov_b32 s10, 0x1c0000
  s_mov_b32 s11, 0x20000
  s_lshl_b32 s18, s4, 1
  s_add_u32 s18, s18, s7
  s_mul_i32 s18, s18, 28672
  s_add_u32 s18, s18, 8192
  v_lshlrev_b32 v7, 7, v0
  buffer_load_dword v24, v7, s[8:11], s18 offen
  s_lshl_b32 s18, s4, 1
  s_add_u32 s18, s18, s7
  s_mul_i32 s18, s18, 28672
  s_add_u32 s18, s18, 16384
  v_lshlrev_b32 v7, 7, v0
  buffer_load_dword v24, v7, s[8:11], s18 offen
  s_lshl_b32 s18, s4, 1
  s_add_u32 s18, s18, s7
  s_mul_i32 s18, s18, 28672
  s_add_u32 s18, s18, 24576
  v_lshlrev_b32 v7, 7, v0
  s_mov_b32 exec_hi, 0
  buffer_load_dword v24, v7, s[8:11], s18 offen
  s_mov_b64 exec, -1
  s_barrier
  s_mov_b32 s8, s42
  s_and_b32 s9, s43, 0xffff
  s_mov_b32 s10, 0x80000
  s_mov_b32 s11, 0x20000
  s_add_u32 s18, s54, 327680
  s_add_u32 m0, s26, 8192
  s_nop 0
  buffer_load_dwordx4 v16, s[8:11], s18 offen offset:0 lds
  buffer_load_dwordx4 v17, s[8:11], s18 offen offset:1024 lds
  buffer_load_dwordx4 v18, s[8:11], s18 offen offset:2048 lds
  buffer_load_dwordx4 v19, s[8:11], s18 offen offset:3072 lds
  s_barrier
  s_add_u32 s18, s54, 393216
  s_add_u32 m0, s26, 16384
  s_nop 0
  buffer_load_dwordx4 v16, s[8:11], s18 offen offset:0 lds
  buffer_load_dwordx4 v17, s[8:11], s18 offen offset:1024 lds
  buffer_load_dwordx4 v18, s[8:11], s18 offen offset:2048 lds
  buffer_load_dwordx4 v19, s[8:11], s18 offen offset:3072 lds
  s_barrier
  s_add_u32 s18, s54, 458752
  s_add_u32 m0, s26, 24576
  s_nop 0
  buffer_load_dwordx4 v16, s[8:11], s18 offen offset:0 lds
  buffer_load_dwordx4 v17, s[8:11], s18 offen offset:1024 lds
  buffer_load_dwordx4 v18, s[8:11], s18 offen offset:2048 lds
  buffer_load_dwordx4 v19, s[8:11], s18 offen offset:3072 lds
  s_barrier
  s_mov_b32 s8, s44
  s_and_b32 s9, s45, 0xffff
  s_mov_b32 s10, 0x1c0000
  s_mov_b32 s11, 0x20000
  s_add_u32 s18, s56, 0
  s_add_u32 m0, s26, 32768
  s_nop 0
  buffer_load_dwordx4 v20, s[8:11], s18 offen offset:0 lds
  buffer_load_dwordx4 v21, s[8:11], s18 offen offset:1024 lds
  buffer_load_dwordx4 v22, s[8:11], s18 offen offset:2048 lds
  buffer_load_dwordx4 v23, s[8:11], s18 offen offset:3072 lds
  s_barrier
  s_add_u32 s18, s56, 114688
  s_add_u32 m0, s26, 40960
  s_nop 0
  buffer_load_dwordx4 v20, s[8:11], s18 offen offset:0 lds
  buffer_load_dwordx4 v21, s[8:11], s18 offen offset:1024 lds
  buffer_load_dwordx4 v22, s[8:11], s18 offen offset:2048 lds
  buffer_load_dwordx4 v23, s[8:11], s18 offen offset:3072 lds
  s_waitcnt vmcnt(8)
  s_barrier
  s_add_u32 s18, s56, 229376
  s_add_u32 m0, s26, 49152
  s_nop 0
  buffer_load_dwordx4 v20, s[8:11], s18 offen offset:0 lds
  buffer_load_dwordx4 v21, s[8:11], s18 offen offset:1024 lds
  buffer_load_dwordx4 v22, s[8:11], s18 offen offset:2048 lds
  buffer_load_dwordx4 v23, s[8:11], s18 offen offset:3072 lds
  s_add_u32 s18, s56, 344064
  s_add_u32 m0, s26, 57344
  s_nop 0
  buffer_load_dwordx4 v20, s[8:11], s18 offen offset:0 lds
  buffer_load_dwordx4 v21, s[8:11], s18 offen offset:1024 lds
  buffer_load_dwordx4 v22, s[8:11], s18 offen offset:2048 lds
  buffer_load_dwordx4 v23, s[8:11], s18 offen offset:3072 lds
  s_add_u32 s18, s56, 458752
  s_add_u32 m0, s26, 65536
  s_nop 0
  buffer_load_dwordx4 v20, s[8:11], s18 offen offset:0 lds
  buffer_load_dwordx4 v21, s[8:11], s18 offen offset:1024 lds
  buffer_load_dwordx4 v22, s[8:11], s18 offen offset:2048 lds
  buffer_load_dwordx4 v23, s[8:11], s18 offen offset:3072 lds
  s_add_u32 s18, s56, 573440
  s_add_u32 m0, s26, 73728
  s_nop 0
  buffer_load_dwordx4 v20, s[8:11], s18 offen offset:0 lds
  buffer_load_dwordx4 v21, s[8:11], s18 offen offset:1024 lds
  buffer_load_dwordx4 v22, s[8:11], s18 offen offset:2048 lds
  buffer_load_dwordx4 v23, s[8:11], s18 offen offset:3072 lds
  s_add_u32 s18, s56, 688128
  s_add_u32 m0, s26, 81920
  s_nop 0
  buffer_load_dwordx4 v20, s[8:11], s18 offen offset:0 lds
  buffer_load_dwordx4 v21, s[8:11], s18 offen offset:1024 lds
  buffer_load_dwordx4 v22, s[8:11], s18 offen offset:2048 lds
  buffer_load_dwordx4 v23, s[8:11], s18 offen offset:3072 lds
  s_add_u32 s18, s56, 802816
  s_add_u32 m0, s26, 90112
  s_nop 0
  buffer_load_dwordx4 v20, s[8:11], s18 offen offset:0 lds
  buffer_load_dwordx4 v21, s[8:11], s18 offen offset:1024 lds
  buffer_load_dwordx4 v22, s[8:11], s18 offen offset:2048 lds
  buffer_load_dwordx4 v23, s[8:11], s18 offen offset:3072 lds
  s_add_u32 s18, s56, 917504
  s_add_u32 m0, s26, 98304
  s_nop 0
  buffer_load_dwordx4 v20, s[8:11], s18 offen offset:0 lds
  buffer_load_dwordx4 v21, s[8:11], s18 offen offset:1024 lds
  buffer_load_dwordx4 v22, s[8:11], s18 offen offset:2048 lds
  buffer_load_dwordx4 v23, s[8:11], s18 offen offset:3072 lds
  s_add_u32 s18, s56, 1032192
  s_add_u32 m0, s26, 106496
  s_nop 0
  buffer_load_dwordx4 v20, s[8:11], s18 offen offset:0 lds
  buffer_load_dwordx4 v21, s[8:11], s18 offen offset:1024 lds
  buffer_load_dwordx4 v22, s[8:11], s18 offen offset:2048 lds
  buffer_load_dwordx4 v23, s[8:11], s18 offen offset:3072 lds
  s_add_u32 s18, s56, 1146880
  s_add_u32 m0, s26, 114688
  s_nop 0
  buffer_load_dwordx4 v20, s[8:11], s18 offen offset:0 lds
  buffer_load_dwordx4 v21, s[8:11], s18 offen offset:1024 lds
  buffer_load_dwordx4 v22, s[8:11], s18 offen offset:2048 lds
  buffer_load_dwordx4 v23, s[8:11], s18 offen offset:3072 lds
  s_add_u32 s18, s56, 1261568
  s_add_u32 m0, s26, 122880
  s_nop 0
  buffer_load_dwordx4 v20, s[8:11], s18 offen offset:0 lds
  buffer_load_dwordx4 v21, s[8:11], s18 offen offset:1024 lds
  buffer_load_dwordx4 v22, s[8:11], s18 offen offset:2048 lds
  buffer_load_dwordx4 v23, s[8:11], s18 offen offset:3072 lds
  s_barrier
  s_mov_b32 s8, s46
  s_and_b32 s9, s47, 0xffff
  s_mov_b32 s10, 0x1c0000
  s_mov_b32 s11, 0x20000
  s_mov_b32 s60, 0x8010700
  s_mov_b32 s61, 0x40a0902
  s_lshl_b32 s18, s4, 1
  s_and_b32 s27, s18, 0x38
  s_lshr_b64 s[60:61], s[60:61], s27
  s_and_b32 s60, s60, 0xff
  s_and_b32 s18, s18, 6
  s_add_u32 s18, s18, s7
  s_lshl_b32 s60, s60, 3
  s_add_u32 s18, s18, s60
  s_lshl_b32 s18, s18, 13
  v_lshlrev_b32 v7, 7, v0
  buffer_load_dword v24, v7, s[8:11], s18 offen
  s_mov_b32 s60, 0x150f0e0b
  s_mov_b32 s61, 0x17100316
  s_lshl_b32 s18, s4, 1
  s_and_b32 s27, s18, 0x38
  s_lshr_b64 s[60:61], s[60:61], s27
  s_and_b32 s60, s60, 0xff
  s_and_b32 s18, s18, 6
  s_add_u32 s18, s18, s7
  s_lshl_b32 s60, s60, 3
  s_add_u32 s18, s18, s60
  s_lshl_b32 s18, s18, 13
  v_lshlrev_b32 v7, 7, v0
  buffer_load_dword v24, v7, s[8:11], s18 offen
  s_barrier
  s_barrier
  s_cmp_lt_u32 s4, 28
  s_cbranch_scc1 L_A_g3
  s_barrier
  s_add_u32 s18, s54, 0
  s_add_u32 m0, s26, 0
  s_nop 0
  buffer_load_dwordx4 v16, s[8:11], s18 offen offset:0 lds
  buffer_load_dwordx4 v17, s[8:11], s18 offen offset:1024 lds
  buffer_load_dwordx4 v18, s[8:11], s18 offen offset:2048 lds
  buffer_load_dwordx4 v19, s[8:11], s18 offen offset:3072 lds
  s_add_u32 s18, s54, 458752
  s_add_u32 m0, s26, 40960
  s_nop 0
  buffer_load_dwordx4 v16, s[8:11], s18 offen offset:0 lds
  buffer_load_dwordx4 v17, s[8:11], s18 offen offset:1024 lds
  buffer_load_dwordx4 v18, s[8:11], s18 offen offset:2048 lds
  buffer_load_dwordx4 v19, s[8:11], s18 offen offset:3072 lds
  s_add_u32 s18, s54, 65536
  s_add_u32 m0, s26, 8192
  s_nop 0
  buffer_load_dwordx4 v16, s[8:11], s18 offen offset:0 lds
  buffer_load_dwordx4 v17, s[8:11], s18 offen offset:1024 lds
  buffer_load_dwordx4 v18, s[8:11], s18 offen offset:2048 lds
  buffer_load_dwordx4 v19, s[8:11], s18 offen offset:3072 lds
  s_add_u32 s18, s54, 524288
  s_add_u32 m0, s26, 49152
  s_nop 0
  buffer_load_dwordx4 v16, s[8:11], s18 offen offset:0 lds
  buffer_load_dwordx4 v17, s[8:11], s18 offen offset:1024 lds
  buffer_load_dwordx4 v18, s[8:11], s18 offen offset:2048 lds
  buffer_load_dwordx4 v19, s[8:11], s18 offen offset:3072 lds
  s_add_u32 s18, s54, 131072
  s_add_u32 m0, s26, 16384
  s_nop 0
  buffer_load_dwordx4 v16, s[8:11], s18 offen offset:0 lds
  buffer_load_dwordx4 v17, s[8:11], s18 offen offset:1024 lds
  buffer_load_dwordx4 v18, s[8:11], s18 offen offset:2048 lds
  buffer_load_dwordx4 v19, s[8:11], s18 offen offset:3072 lds
  s_add_u32 s18, s54, 589824
  s_add_u32 m0, s26, 57344
  s_nop 0
  buffer_load_dwordx4 v16, s[8:11], s18 offen offset:0 lds
  buffer_load_dwordx4 v17, s[8:11], s18 offen offset:1024 lds
  buffer_load_dwordx4 v18, s[8:11], s18 offen offset:2048 lds
  buffer_load_dwordx4 v19, s[8:11], s18 offen offset:3072 lds
  s_add_u32 s18, s54, 655360
  s_add_u32 m0, s26, 65536
  s_nop 0
  buffer_load_dwordx4 v16, s[8:11], s18 offen offset:0 lds
  buffer_load_dwordx4 v17, s[8:11], s18 offen offset:1024 lds
  buffer_load_dwordx4 v18, s[8:11], s18 offen offset:2048 lds
  buffer_load_dwordx4 v19, s[8:11], s18 offen offset:3072 lds
  s_add_u32 s18, s54, 262144
  s_add_u32 m0, s26, 32768
  s_nop 0
  buffer_load_dwordx4 v16, s[8:11], s18 offen offset:0 lds
  buffer_load_dwordx4 v17, s[8:11], s18 offen offset:1024 lds
  buffer_load_dwordx4 v18, s[8:11], s18 offen offset:2048 lds
  buffer_load_dwordx4 v19, s[8:11], s18 offen offset:3072 lds
  s_add_u32 s18, s54, 720896
  s_add_u32 m0, s26, 73728
  s_nop 0
  buffer_load_dwordx4 v16, s[8:11], s18 offen offset:0 lds
  buffer_load_dwordx4 v17, s[8:11], s18 offen offset:1024 lds
  buffer_load_dwordx4 v18, s[8:11], s18 offen offset:2048 lds
  buffer_load_dwordx4 v19, s[8:11], s18 offen offset:3072 lds
  s_add_u32 s18, s54, 917504
  s_add_u32 m0, s26, 81920
  s_nop 0
  buffer_load_dwordx4 v16, s[8:11], s18 offen offset:0 lds
  buffer_load_dwordx4 v17, s[8:11], s18 offen offset:1024 lds
  buffer_load_dwordx4 v18, s[8:11], s18 offen offset:2048 lds
  buffer_load_dwordx4 v19, s[8:11], s18 offen offset:3072 lds
  s_add_u32 s18, s54, 983040
  s_add_u32 m0, s26, 90112
  s_nop 0
  buffer_load_dwordx4 v16, s[8:11], s18 offen offset:0 lds
  buffer_load_dwordx4 v17, s[8:11], s18 offen offset:1024 lds
  buffer_load_dwordx4 v18, s[8:11], s18 offen offset:2048 lds
  buffer_load_dwordx4 v19, s[8:11], s18 offen offset:3072 lds
  s_add_u32 s18, s54, 1114112
  s_add_u32 m0, s26, 106496
  s_nop 0
  buffer_load_dwordx4 v16, s[8:11], s18 offen offset:0 lds
  buffer_load_dwordx4 v17, s[8:11], s18 offen offset:1024 lds
  buffer_load_dwordx4 v18, s[8:11], s18 offen offset:2048 lds
  buffer_load_dwordx4 v19, s[8:11], s18 offen offset:3072 lds
  s_add_u32 s18, s54, 1572864
  s_add_u32 m0, s26, 147456
  s_nop 0
  buffer_load_dwordx4 v16, s[8:11], s18 offen offset:0 lds
  buffer_load_dwordx4 v17, s[8:11], s18 offen offset:1024 lds
  buffer_load_dwordx4 v18, s[8:11], s18 offen offset:2048 lds
  buffer_load_dwordx4 v19, s[8:11], s18 offen offset:3072 lds
  s_add_u32 s18, s54, 1179648
  s_add_u32 m0, s26, 114688
  s_nop 0
  buffer_load_dwordx4 v16, s[8:11], s18 offen offset:0 lds
  buffer_load_dwordx4 v17, s[8:11], s18 offen offset:1024 lds
  buffer_load_dwordx4 v18, s[8:11], s18 offen offset:2048 lds
  buffer_load_dwordx4 v19, s[8:11], s18 offen offset:3072 lds
  s_add_u32 s18, s54, 1638400
  s_add_u32 m0, s26, 155648
  s_nop 0
  buffer_load_dwordx4 v16, s[8:11], s18 offen offset:0 lds
  buffer_load_dwordx4 v17, s[8:11], s18 offen offset:1024 lds
  buffer_load_dwordx4 v18, s[8:11], s18 offen offset:2048 lds
  buffer_load_dwordx4 v19, s[8:11], s18 offen offset:3072 lds
  s_add_u32 s18, s54, 327680
  buffer_load_dwordx4 v[32:35], v16, s[8:11], s18 offen offset:0
  buffer_load_dwordx4 v[36:39], v17, s[8:11], s18 offen offset:1024
  buffer_load_dwordx4 v[40:43], v18, s[8:11], s18 offen offset:2048
  buffer_load_dwordx4 v[44:47], v19, s[8:11], s18 offen offset:3072
  s_add_u32 s18, s54, 786432
  buffer_load_dwordx4 v[48:51], v16, s[8:11], s18 offen offset:0
  buffer_load_dwordx4 v[52:55], v17, s[8:11], s18 offen offset:1024
  buffer_load_dwordx4 v[56:59], v18, s[8:11], s18 offen offset:2048
  buffer_load_dwordx4 v[60:63], v19, s[8:11], s18 offen offset:3072
  s_add_u32 s18, s54, 1245184
  buffer_load_dwordx4 v[64:67], v16, s[8:11], s18 offen offset:0
  buffer_load_dwordx4 v[68:71], v17, s[8:11], s18 offen offset:1024
  buffer_load_dwordx4 v[72:75], v18, s[8:11], s18 offen offset:2048
  buffer_load_dwordx4 v[76:79], v19, s[8:11], s18 offen offset:3072
  s_add_u32 s18, s54, 1703936
  buffer_load_dwordx4 v[80:83], v16, s[8:11], s18 offen offset:0
  buffer_load_dwordx4 v[84:87], v17, s[8:11], s18 offen offset:1024
  buffer_load_dwordx4 v[88:91], v18, s[8:11], s18 offen offset:2048
  buffer_load_dwordx4 v[92:95], v19, s[8:11], s18 offen offset:3072
  s_add_u32 s18, s54, 393216
  buffer_load_dwordx4 v[96:99], v16, s[8:11], s18 offen offset:0
  buffer_load_dwordx4 v[100:103], v17, s[8:11], s18 offen offset:1024
  buffer_load_dwordx4 v[104:107], v18, s[8:11], s18 offen offset:2048
  buffer_load_dwordx4 v[108:111], v19, s[8:11], s18 offen offset:3072
  s_add_u32 s18, s54, 851968
  buffer_load_dwordx4 v[112:115], v16, s[8:11], s18 offen offset:0
  buffer_load_dwordx4 v[116:119], v17, s[8:11], s18 offen offset:1024
  buffer_load_dwordx4 v[120:123], v18, s[8:11], s18 offen offset:2048
  buffer_load_dwordx4 v[124:127], v19, s[8:11], s18 offen offset:3072
  s_add_u32 s18, s54, 1310720
  buffer_load_dwordx4 v[128:131], v16, s[8:11], s18 offen offset:0
  buffer_load_dwordx4 v[132:135], v17, s[8:11], s18 offen offset:1024
  buffer_load_dwordx4 v[136:139], v18, s[8:11], s18 offen offset:2048
  buffer_load_dwordx4 v[140:143], v19, s[8:11], s18 offen offset:3072
  s_add_u32 s18, s54, 1769472
  buffer_load_dwordx4 v[144:147], v16, s[8:11], s18 offen offset:0
  buffer_load_dwordx4 v[148:151], v17, s[8:11], s18 offen offset:1024
  buffer_load_dwordx4 v[152:155], v18, s[8:11], s18 offen offset:2048
  buffer_load_dwordx4 v[156:159], v19, s[8:11], s18 offen offset:3072
  s_branch L_A_g4
L_A_g3:
  s_waitcnt vmcnt(2)
  s_barrier
  s_barrier
  s_add_u32 s18, s54, 0
  s_add_u32 m0, s26, 0
  s_nop 0
  buffer_load_dwordx4 v16, s[8:11], s18 offen offset:0 lds
  buffer_load_dwordx4 v17, s[8:11], s18 offen offset:1024 lds
  buffer_load_dwordx4 v18, s[8:11], s18 offen offset:2048 lds
  buffer_load_dwordx4 v19, s[8:11], s18 offen offset:3072 lds
  s_add_u32 s18, s54, 458752
  s_add_u32 m0, s26, 40960
  s_nop 0
  buffer_load_dwordx4 v16, s[8:11], s18 offen offset:0 lds
  buffer_load_dwordx4 v17, s[8:11], s18 offen offset:1024 lds
  buffer_load_dwordx4 v18, s[8:11], s18 offen offset:2048 lds
  buffer_load_dwordx4 v19, s[8:11], s18 offen offset:3072 lds
  s_add_u32 s18, s54, 65536
  s_add_u32 m0, s26, 8192
  s_nop 0
  buffer_load_dwordx4 v16, s[8:11], s18 offen offset:0 lds
  buffer_load_dwordx4 v17, s[8:11], s18 offen offset:1024 lds
  buffer_load_dwordx4 v18, s[8:11], s18 offen offset:2048 lds
  buffer_load_dwordx4 v19, s[8:11], s18 offen offset:3072 lds
  s_add_u32 s18, s54, 524288
  s_add_u32 m0, s26, 49152
  s_nop 0
  buffer_load_dwordx4 v16, s[8:11], s18 offen offset:0 lds
  buffer_load_dwordx4 v17, s[8:11], s18 offen offset:1024 lds
  buffer_load_dwordx4 v18, s[8:11], s18 offen offset:2048 lds
  buffer_load_dwordx4 v19, s[8:11], s18 offen offset:3072 lds
  s_add_u32 s18, s54, 131072
  s_add_u32 m0, s26, 16384
  s_nop 0
  buffer_load_dwordx4 v16, s[8:11], s18 offen offset:0 lds
  buffer_load_dwordx4 v17, s[8:11], s18 offen offset:1024 lds
  buffer_load_dwordx4 v18, s[8:11], s18 offen offset:2048 lds
  buffer_load_dwordx4 v19, s[8:11], s18 offen offset:3072 lds
  s_add_u32 s18, s54, 589824
  s_add_u32 m0, s26, 57344
  s_nop 0
  buffer_load_dwordx4 v16, s[8:11], s18 offen offset:0 lds
  buffer_load_dwordx4 v17, s[8:11], s18 offen offset:1024 lds
  buffer_load_dwordx4 v18, s[8:11], s18 offen offset:2048 lds
  buffer_load_dwordx4 v19, s[8:11], s18 offen offset:3072 lds
  s_add_u32 s18, s54, 655360
  s_add_u32 m0, s26, 65536
  s_nop 0
  buffer_load_dwordx4 v16, s[8:11], s18 offen offset:0 lds
  buffer_load_dwordx4 v17, s[8:11], s18 offen offset:1024 lds
  buffer_load_dwordx4 v18, s[8:11], s18 offen offset:2048 lds
  buffer_load_dwordx4 v19, s[8:11], s18 offen offset:3072 lds
  s_add_u32 s18, s54, 262144
  s_add_u32 m0, s26, 32768
  s_nop 0
  buffer_load_dwordx4 v16, s[8:11], s18 offen offset:0 lds
  buffer_load_dwordx4 v17, s[8:11], s18 offen offset:1024 lds
  buffer_load_dwordx4 v18, s[8:11], s18 offen offset:2048 lds
  buffer_load_dwordx4 v19, s[8:11], s18 offen offset:3072 lds
  s_add_u32 s18, s54, 720896
  s_add_u32 m0, s26, 73728
  s_nop 0
  buffer_load_dwordx4 v16, s[8:11], s18 offen offset:0 lds
  buffer_load_dwordx4 v17, s[8:11], s18 offen offset:1024 lds
  buffer_load_dwordx4 v18, s[8:11], s18 offen offset:2048 lds
  buffer_load_dwordx4 v19, s[8:11], s18 offen offset:3072 lds
  s_add_u32 s18, s54, 917504
  s_add_u32 m0, s26, 81920
  s_nop 0
  buffer_load_dwordx4 v16, s[8:11], s18 offen offset:0 lds
  buffer_load_dwordx4 v17, s[8:11], s18 offen offset:1024 lds
  buffer_load_dwordx4 v18, s[8:11], s18 offen offset:2048 lds
  buffer_load_dwordx4 v19, s[8:11], s18 offen offset:3072 lds
  s_add_u32 s18, s54, 983040
  s_add_u32 m0, s26, 90112
  s_nop 0
  buffer_load_dwordx4 v16, s[8:11], s18 offen offset:0 lds
  buffer_load_dwordx4 v17, s[8:11], s18 offen offset:1024 lds
  buffer_load_dwordx4 v18, s[8:11], s18 offen offset:2048 lds
  buffer_load_dwordx4 v19, s[8:11], s18 offen offset:3072 lds
  s_mov_b32 s60, 0x19121811
  s_mov_b32 s61, 0x19191919
  s_lshl_b32 s18, s4, 1
  s_and_b32 s27, s18, 0x38
  s_lshr_b64 s[60:61], s[60:61], s27
  s_and_b32 s60, s60, 0xff
  s_and_b32 s18, s18, 6
  s_add_u32 s18, s18, s7
  s_lshl_b32 s60, s60, 3
  s_add_u32 s18, s18, s60
  s_lshl_b32 s18, s18, 13
  v_lshlrev_b32 v7, 7, v0
  buffer_load_dword v24, v7, s[8:11], s18 offen
  s_barrier
  s_add_u32 s18, s54, 1114112
  s_add_u32 m0, s26, 106496
  s_nop 0
  buffer_load_dwordx4 v16, s[8:11], s18 offen offset:0 lds
  buffer_load_dwordx4 v17, s[8:11], s18 offen offset:1024 lds
  buffer_load_dwordx4 v18, s[8:11], s18 offen offset:2048 lds
  buffer_load_dwordx4 v19, s[8:11], s18 offen offset:3072 lds
  s_add_u32 s18, s54, 1572864
  s_add_u32 m0, s26, 147456
  s_nop 0
  buffer_load_dwordx4 v16, s[8:11], s18 offen offset:0 lds
  buffer_load_dwordx4 v17, s[8:11], s18 offen offset:1024 lds
  buffer_load_dwordx4 v18, s[8:11], s18 offen offset:2048 lds
  buffer_load_dwordx4 v19, s[8:11], s18 offen offset:3072 lds
  s_add_u32 s18, s54, 1179648
  s_add_u32 m0, s26, 114688
  s_nop 0
  buffer_load_dwordx4 v16, s[8:11], s18 offen offset:0 lds
  buffer_load_dwordx4 v17, s[8:11], s18 offen offset:1024 lds
  buffer_load_dwordx4 v18, s[8:11], s18 offen offset:2048 lds
  buffer_load_dwordx4 v19, s[8:11], s18 offen offset:3072 lds
  s_add_u32 s18, s54, 1638400
  s_add_u32 m0, s26, 155648
  s_nop 0
  buffer_load_dwordx4 v16, s[8:11], s18 offen offset:0 lds
  buffer_load_dwordx4 v17, s[8:11], s18 offen offset:1024 lds
  buffer_load_dwordx4 v18, s[8:11], s18 offen offset:2048 lds
  buffer_load_dwordx4 v19, s[8:11], s18 offen offset:3072 lds
  s_add_u32 s18, s54, 327680
  buffer_load_dwordx4 v[32:35], v16, s[8:11], s18 offen offset:0
  buffer_load_dwordx4 v[36:39], v17, s[8:11], s18 offen offset:1024
  buffer_load_dwordx4 v[40:43], v18, s[8:11], s18 offen offset:2048
  buffer_load_dwordx4 v[44:47], v19, s[8:11], s18 offen offset:3072
  s_add_u32 s18, s54, 786432
  buffer_load_dwordx4 v[48:51], v16, s[8:11], s18 offen offset:0
  buffer_load_dwordx4 v[52:55], v17, s[8:11], s18 offen offset:1024
  buffer_load_dwordx4 v[56:59], v18, s[8:11], s18 offen offset:2048
  buffer_load_dwordx4 v[60:63], v19, s[8:11], s18 offen offset:3072
  s_add_u32 s18, s54, 1245184
  buffer_load_dwordx4 v[64:67], v16, s[8:11], s18 offen offset:0
  buffer_load_dwordx4 v[68:71], v17, s[8:11], s18 offen offset:1024
  buffer_load_dwordx4 v[72:75], v18, s[8:11], s18 offen offset:2048
  buffer_load_dwordx4 v[76:79], v19, s[8:11], s18 offen offset:3072
  s_add_u32 s18, s54, 1703936
  buffer_load_dwordx4 v[80:83], v16, s[8:11], s18 offen offset:0
  buffer_load_dwordx4 v[84:87], v17, s[8:11], s18 offen offset:1024
  buffer_load_dwordx4 v[88:91], v18, s[8:11], s18 offen offset:2048
  buffer_load_dwordx4 v[92:95], v19, s[8:11], s18 offen offset:3072
  s_add_u32 s18, s54, 393216
  buffer_load_dwordx4 v[96:99], v16, s[8:11], s18 offen offset:0
  buffer_load_dwordx4 v[100:103], v17, s[8:11], s18 offen offset:1024
  buffer_load_dwordx4 v[104:107], v18, s[8:11], s18 offen offset:2048
  buffer_load_dwordx4 v[108:111], v19, s[8:11], s18 offen offset:3072
  s_add_u32 s18, s54, 851968
  buffer_load_dwordx4 v[112:115], v16, s[8:11], s18 offen offset:0
  buffer_load_dwordx4 v[116:119], v17, s[8:11], s18 offen offset:1024
  buffer_load_dwordx4 v[120:123], v18, s[8:11], s18 offen offset:2048
  buffer_load_dwordx4 v[124:127], v19, s[8:11], s18 offen offset:3072
  s_add_u32 s18, s54, 1310720
  buffer_load_dwordx4 v[128:131], v16, s[8:11], s18 offen offset:0
  buffer_load_dwordx4 v[132:135], v17, s[8:11], s18 offen offset:1024
  buffer_load_dwordx4 v[136:139], v18, s[8:11], s18 offen offset:2048
  buffer_load_dwordx4 v[140:143], v19, s[8:11], s18 offen offset:3072
  s_add_u32 s18, s54, 1769472
  buffer_load_dwordx4 v[144:147], v16, s[8:11], s18 offen offset:0
  buffer_load_dwordx4 v[148:151], v17, s[8:11], s18 offen offset:1024
  buffer_load_dwordx4 v[152:155], v18, s[8:11], s18 offen offset:2048
  buffer_load_dwordx4 v[156:159], v19, s[8:11], s18 offen offset:3072
L_A_g4:
  s_waitcnt vmcnt(0) lgkmcnt(0)
  s_barrier
  s_barrier
  s_waitcnt vmcnt(28)
  ds_write_b128 v28, v[32:35] offset:0
  ds_write_b128 v28, v[36:39] offset:1024
  ds_write_b128 v28, v[40:43] offset:2048
  ds_write_b128 v28, v[44:47] offset:3072
  s_waitcnt vmcnt(24)
  ds_write_b128 v28, v[48:51] offset:40960
  ds_write_b128 v28, v[52:55] offset:41984
  ds_write_b128 v28, v[56:59] offset:43008
  ds_write_b128 v28, v[60:63] offset:44032
  s_waitcnt vmcnt(20)
  ds_write_b128 v29, v[64:67] offset:16384
  ds_write_b128 v29, v[68:71] offset:17408
  ds_write_b128 v29, v[72:75] offset:18432
  ds_write_b128 v29, v[76:79] offset:19456
  s_waitcnt vmcnt(16)
  ds_write_b128 v29, v[80:83] offset:57344
  ds_write_b128 v29, v[84:87] offset:58368
  ds_write_b128 v29, v[88:91] offset:59392
  ds_write_b128 v29, v[92:95] offset:60416
  s_waitcnt vmcnt(12)
  ds_write_b128 v28, v[96:99] offset:8192
  ds_write_b128 v28, v[100:103] offset:9216
  ds_write_b128 v28, v[104:107] offset:10240
  ds_write_b128 v28, v[108:111] offset:11264
  s_waitcnt vmcnt(8)
  ds_write_b128 v28, v[112:115] offset:49152
  ds_write_b128 v28, v[116:119] offset:50176
  ds_write_b128 v28, v[120:123] offset:51200
  ds_write_b128 v28, v[124:127] offset:52224
  s_waitcnt vmcnt(4)
  ds_write_b128 v29, v[128:131] offset:24576
  ds_write_b128 v29, v[132:135] offset:25600
  ds_write_b128 v29, v[136:139] offset:26624
  ds_write_b128 v29, v[140:143] offset:27648
  s_waitcnt vmcnt(0)
  ds_write_b128 v30, v[144:147] offset:0
  ds_write_b128 v30, v[148:151] offset:1024
  ds_write_b128 v30, v[152:155] offset:2048
  ds_write_b128 v30, v[156:159] offset:3072
  s_waitcnt lgkmcnt(0)
  s_barrier
  s_endpgm
L_compute:
  s_load_dwordx2 s[38:39], s[0:1], 8
  s_load_dwordx4 s[40:43], s[0:1], 16
  s_load_dwordx4 s[44:47], s[0:1], 32
  s_load_dwordx2 s[48:49], s[0:1], 48
  s_load_dwordx2 s[50:51], s[0:1], 96
  s_load_dwordx2 s[54:55], s[0:1], 88
  v_lshrrev_b32 v1, 2, v0
  v_mul_u32_u24 v1, 528, v1
  v_and_b32 v2, 3, v0
  v_lshl_add_u32 v1, v2, 2, v1
  v_add_u32 v1, 0x10000, v1
  v_mov_b32 v2, 0
  s_mov_b64 exec, 0xfff
  ds_write_b32 v1, v2 offset:28480
  s_mov_b64 exec, -1
  s_lshr_b32 s6, s5, 1
  s_and_b32 s7, s5, 1
  s_lshl_b32 s16, s3, 6
  s_lshl_b32 s17, s4, 1
  s_add_u32 s16, s16, s17
  s_add_u32 s16, s16, s6
  s_lshl_b32 s25, s16, 8
  s_lshl_b32 s17, s16, 1
  v_lshl_add_u32 v2, s7, 6, v0
  v_lshlrev_b32 v3, 1, v2
  v_xor_b32 v4, 128, v3
  v_mov_b32 v6, 0
  s_waitcnt lgkmcnt(0)
  s_mov_b32 s8, s38
  s_and_b32 s9, s39, 0xffff
  s_mov_b32 s10, 0x20000
  s_mov_b32 s11, 0x20000
  buffer_load_ushort v8, v3, s[8:11], s25 offen
  s_mov_b32 s8, s40
  s_and_b32 s9, s41, 0xffff
  s_mov_b32 s10, 0x20000
  s_mov_b32 s11, 0x20000
  buffer_load_ushort v9, v3, s[8:11], s25 offen
  s_mov_b32 s8, s42
  s_and_b32 s9, s43, 0xffff
  s_mov_b32 s10, 0x20000
  s_mov_b32 s11, 0x20000
  buffer_load_ushort v10, v3, s[8:11], s25 offen
  buffer_load_ushort v12, v4, s[8:11], s25 offen
  s_mov_b32 s8, s44
  s_and_b32 s9, s45, 0xffff
  s_mov_b32 s10, 0x20000
  s_mov_b32 s11, 0x20000
  buffer_load_ushort v11, v3, s[8:11], s25 offen
  buffer_load_ushort v13, v4, s[8:11], s25 offen
  s_mov_b32 s8, s46
  s_and_b32 s9, s47, 0xffff
  s_mov_b32 s10, 0x400
  s_mov_b32 s11, 0x20000
  buffer_load_ushort v15, v6, s[8:11], s17 offen
  s_mov_b32 s8, s48
  s_and_b32 s9, s49, 0xffff
  s_mov_b32 s10, 0x400
  s_mov_b32 s11, 0x20000
  buffer_load_ushort v72, v6, s[8:11], s17 offen
  s_mov_b32 s12, s52
  s_and_b32 s13, s53, 0xffff
  s_mov_b32 s14, 0x1200000
  s_mov_b32 s15, 0x20000
  s_barrier
  s_mul_i32 s26, s6, 33280
  s_add_u32 s26, s26, 82944
  v_lshl_add_u32 v5, v2, 2, s26
  v_and_b32 v6, 15, v0
  v_sub_u32 v6, 15, v6
  v_bfe_u32 v7, v0, 4, 2
  s_lshl_b32 s18, s5, 2
  s_add_u32 s18, s18, 94016
  v_mov_b32 v73, s18
  v_xor_b32 v74, 4, v73
  s_cmp_eq_u32 s7, 0
  s_movk_i32 s28, 1024
  s_cselect_b32 s28, 0, s28
  s_cselect_b32 s29, 0, 3
  s_cselect_b32 s30, 0, 35
  v_add_u32 v66, s28, v6
  v_cvt_f32_u32 v66, v66
  v_cvt_pk_bf16_f32 v66, v66, v66
  v_and_b32 v66, 0xffff0000, v66
  v_cvt_u32_f32 v66, v66
  v_subrev_u32 v66, s28, v66
  v_lshrrev_b32 v66, s29, v66
  v_add_u32 v66, s30, v66
  v_mul_u32_u24 v66, 528, v66
  v_lshl_add_u32 v66, v7, 4, v66
  v_add_u32 v66, s26, v66
  s_movk_i32 s28, 1280
  s_cselect_b32 s28, 256, s28
  s_cselect_b32 s29, 1, 3
  s_cselect_b32 s30, 16, 38
  v_add_u32 v67, s28, v6
  v_cvt_f32_u32 v67, v67
  v_cvt_pk_bf16_f32 v67, v67, v67
  v_and_b32 v67, 0xffff0000, v67
  v_cvt_u32_f32 v67, v67
  v_subrev_u32 v67, s28, v67
  v_lshrrev_b32 v67, s29, v67
  v_add_u32 v67, s30, v67
  v_mul_u32_u24 v67, 528, v67
  v_lshl_add_u32 v67, v7, 4, v67
  v_add_u32 v67, s26, v67
  s_movk_i32 s28, 1536
  s_cselect_b32 s28, 512, s28
  s_cselect_b32 s29, 2, 3
  s_cselect_b32 s30, 25, 41
  v_add_u32 v68, s28, v6
  v_cvt_f32_u32 v68, v68
  v_cvt_pk_bf16_f32 v68, v68, v68
  v_and_b32 v68, 0xffff0000, v68
  v_cvt_u32_f32 v68, v68
  v_subrev_u32 v68, s28, v68
  v_lshrrev_b32 v68, s29, v68
  v_add_u32 v68, s30, v68
  v_mul_u32_u24 v68, 528, v68
  v_lshl_add_u32 v68, v7, 4, v68
  v_add_u32 v68, s26, v68
  s_movk_i32 s28, 1792
  s_cselect_b32 s28, 768, s28
  s_cselect_b32 s29, 2, 3
  s_cselect_b32 s30, 30, 44
  v_add_u32 v69, s28, v6
  v_cvt_f32_u32 v69, v69
  v_cvt_pk_bf16_f32 v69, v69, v69
  v_and_b32 v69, 0xffff0000, v69
  v_cvt_u32_f32 v69, v69
  v_subrev_u32 v69, s28, v69
  v_lshrrev_b32 v69, s29, v69
  v_add_u32 v69, s30, v69
  v_mul_u32_u24 v69, 528, v69
  v_lshl_add_u32 v69, v7, 4, v69
  v_add_u32 v69, s26, v69
  v_add_u32 v70, 47, v6
  v_mul_u32_u24 v70, 528, v70
  v_lshl_add_u32 v70, v7, 4, v70
  v_add_u32 v70, s26, v70
  v_and_b32 v71, 15, v0
  v_lshlrev_b32 v71, 5, v71
  v_lshl_add_u32 v71, v7, 3, v71
  s_waitcnt vmcnt(0)
  v_lshlrev_b32 v15, 16, v15
  v_lshlrev_b32 v72, 16, v72
  s_nop 0
  v_readfirstlane_b32 s24, v15
  v_readfirstlane_b32 s23, v72
  v_lshlrev_b32 v8, 16, v8
  v_lshlrev_b32 v9, 16, v9
  v_lshlrev_b32 v10, 16, v10
  v_lshlrev_b32 v11, 16, v11
  v_lshlrev_b32 v12, 16, v12
  v_lshlrev_b32 v13, 16, v13
  v_mov_b32 v14, s24
  v_mul_f32 v14, 0x3fb8aa3b, v14
  v_mul_f32 v8, 0x3fb8aa3b, v8
  v_exp_f32 v14, v14
  v_exp_f32 v8, v8
  v_max3_f32 v12, |v12|, |v13|, |v10|
  v_max_f32 v12, |v11|, v12
  v_cvt_pk_bf16_f32 v14, v14, v14
  v_and_b32 v14, 0xffff0000, v14
  v_cvt_pk_bf16_f32 v8, v8, v8
  v_and_b32 v8, 0xffff0000, v8
  s_nop 1
  v_max_f32_dpp v12, v12, v12 row_ror:8 row_mask:0xf bank_mask:0xf
  s_nop 1
  v_max_f32_dpp v12, v12, v12 row_ror:4 row_mask:0xf bank_mask:0xf
  s_nop 1
  v_max_f32_dpp v12, v12, v12 row_ror:2 row_mask:0xf bank_mask:0xf
  s_nop 1
  v_max_f32_dpp v12, v12, v12 row_ror:1 row_mask:0xf bank_mask:0xf
  v_mul_f32 v8, v8, v14
  v_mul_f32 v9, v9, v14
  v_mov_b32 v13, v12
  v_mul_f32 v8, 0xbfb8aa3b, v8
  s_nop 1
  v_permlane32_swap_b32 v12, v13
  v_mul_f32 v9, 0x3e22f983, v9
  v_max_f32 v12, v12, v13
  v_mov_b32 v13, v12
  s_nop 1
  v_permlane16_swap_b32 v12, v13
  s_nop 1
  v_max_f32 v12, v12, v13
  v_and_b32 v12, 0x7f800000, v12
  v_max_u32 v12, 0x0d800000, v12
  v_sub_u32 v13, 0x7f800000, v12
  v_mul_f32 v14, v14, v12
  v_mul_f32 v22, v10, v13
  v_mul_f32 v23, v11, v13
  v_mul_f32 v24, 0x3f800000, v8
  v_mul_f32 v25, 0x3f800000, v9
  v_exp_f32 v24, v24
  v_fract_f32 v25, v25
  s_nop 0
  v_cos_f32 v16, v25
  v_sin_f32 v17, v25
  s_nop 0
  v_mul_f32 v16, v16, v24
  v_mul_f32 v17, v17, v24
  v_mul_f32 v24, 0x41800000, v8
  v_mul_f32 v25, 0x41800000, v9
  v_exp_f32 v24, v24
  v_fract_f32 v25, v25
  s_nop 0
  v_cos_f32 v18, v25
  v_sin_f32 v19, v25
  s_nop 0
  v_mul_f32 v18, v18, v24
  v_mul_f32 v19, v19, v24
  v_mul_f32 v24, 0x43800000, v8
  v_mul_f32 v25, 0x43800000, v9
  v_exp_f32 v24, v24
  v_fract_f32 v25, v25
  s_nop 0
  v_cos_f32 v20, v25
  v_sin_f32 v21, v25
  s_nop 0
  v_mul_f32 v20, v20, v24
  v_mul_f32 v21, v21, v24
  v_mov_b32 v24, 1.0
  v_mov_b32 v25, 0
  v_pk_mul_f32 v[58:59], v[16:17], v[16:17] op_sel:[0,0] op_sel_hi:[0,1]
  v_pk_fma_f32 v[26:27], v[16:17], v[16:17], v[58:59] op_sel:[1,1,0] op_sel_hi:[1,0,1] neg_lo:[0,1,0]
  v_cvt_pk_f16_f32 v60, v22, -v23
  ds_write_b32 v5, v60 offset:0
  v_cvt_pk_f16_f32 v61, v24, v25
  ds_write_b32 v5, v61 offset:24816
  v_pk_mul_f32 v[54:55], v[22:23], v[16:17] op_sel:[0,0] op_sel_hi:[0,1]
  v_pk_mul_f32 v[58:59], v[22:23], v[20:21] op_sel:[0,0] op_sel_hi:[0,1]
  v_pk_fma_f32 v[46:47], v[22:23], v[16:17], v[54:55] op_sel:[1,1,0] op_sel_hi:[1,0,1] neg_lo:[0,1,0]
  v_pk_fma_f32 v[32:33], v[22:23], v[20:21], v[58:59] op_sel:[1,1,0] op_sel_hi:[1,0,1] neg_lo:[0,1,0]
  v_cvt_pk_f16_f32 v62, v46, -v47
  ds_write_b32 v5, v62 offset:528
  v_cvt_pk_f16_f32 v63, v18, v19
  ds_write_b32 v5, v63 offset:25344
  v_cvt_pk_f16_f32 v60, v32, -v33
  ds_write_b32 v5, v60 offset:8448
  v_pk_mul_f32 v[54:55], v[46:47], v[16:17] op_sel:[0,0] op_sel_hi:[0,1]
  v_pk_mul_f32 v[56:57], v[18:19], v[18:19] op_sel:[0,0] op_sel_hi:[0,1]
  v_pk_mul_f32 v[58:59], v[26:27], v[26:27] op_sel:[0,0] op_sel_hi:[0,1]
  v_pk_mul_f32 v[64:65], v[32:33], v[26:27] op_sel:[0,0] op_sel_hi:[0,1]
  v_pk_fma_f32 v[46:47], v[46:47], v[16:17], v[54:55] op_sel:[1,1,0] op_sel_hi:[1,0,1] neg_lo:[0,1,0]
  v_pk_fma_f32 v[48:49], v[18:19], v[18:19], v[56:57] op_sel:[1,1,0] op_sel_hi:[1,0,1] neg_lo:[0,1,0]
  v_pk_fma_f32 v[28:29], v[26:27], v[26:27], v[58:59] op_sel:[1,1,0] op_sel_hi:[1,0,1] neg_lo:[0,1,0]
  v_pk_fma_f32 v[52:53], v[32:33], v[26:27], v[64:65] op_sel:[1,1,0] op_sel_hi:[1,0,1] neg_lo:[0,1,0]
  v_cvt_pk_f16_f32 v61, v46, -v47
  ds_write_b32 v5, v61 offset:1056
  v_cvt_pk_f16_f32 v62, v48, v49
  ds_write_b32 v5, v62 offset:25872
  v_cvt_pk_f16_f32 v63, v52, -v53
  ds_write_b32 v5, v63 offset:8976
  v_pk_mul_f32 v[54:55], v[46:47], v[16:17] op_sel:[0,0] op_sel_hi:[0,1]
  v_pk_mul_f32 v[56:57], v[48:49], v[18:19] op_sel:[0,0] op_sel_hi:[0,1]
  v_pk_mul_f32 v[58:59], v[32:33], v[20:21] op_sel:[0,0] op_sel_hi:[0,1]
  v_pk_mul_f32 v[64:65], v[52:53], v[26:27] op_sel:[0,0] op_sel_hi:[0,1]
  v_pk_fma_f32 v[46:47], v[46:47], v[16:17], v[54:55] op_sel:[1,1,0] op_sel_hi:[1,0,1] neg_lo:[0,1,0]
  v_pk_fma_f32 v[48:49], v[48:49], v[18:19], v[56:57] op_sel:[1,1,0] op_sel_hi:[1,0,1] neg_lo:[0,1,0]
  v_pk_fma_f32 v[34:35], v[32:33], v[20:21], v[58:59] op_sel:[1,1,0] op_sel_hi:[1,0,1] neg_lo:[0,1,0]
  v_pk_fma_f32 v[52:53], v[52:53], v[26:27], v[64:65] op_sel:[1,1,0] op_sel_hi:[1,0,1] neg_lo:[0,1,0]
  v_cvt_pk_f16_f32 v60, v46, -v47
  ds_write_b32 v5, v60 offset:1584
  v_cvt_pk_f16_f32 v61, v48, v49
  ds_write_b32 v5, v61 offset:26400
  v_cvt_pk_f16_f32 v62, v34, -v35
  ds_write_b32 v5, v62 offset:13200
  v_cvt_pk_f16_f32 v63, v52, -v53
  ds_write_b32 v5, v63 offset:9504
  v_pk_mul_f32 v[54:55], v[46:47], v[16:17] op_sel:[0,0] op_sel_hi:[0,1]
  v_pk_mul_f32 v[56:57], v[48:49], v[18:19] op_sel:[0,0] op_sel_hi:[0,1]
  v_pk_mul_f32 v[58:59], v[28:29], v[28:29] op_sel:[0,0] op_sel_hi:[0,1]
  v_pk_mul_f32 v[64:65], v[52:53], v[26:27] op_sel:[0,0] op_sel_hi:[0,1]
  v_pk_fma_f32 v[46:47], v[46:47], v[16:17], v[54:55] op_sel:[1,1,0] op_sel_hi:[1,0,1] neg_lo:[0,1,0]
  v_pk_fma_f32 v[48:49], v[48:49], v[18:19], v[56:57] op_sel:[1,1,0] op_sel_hi:[1,0,1] neg_lo:[0,1,0]
  v_pk_fma_f32 v[30:31], v[28:29], v[28:29], v[58:59] op_sel:[1,1,0] op_sel_hi:[1,0,1] neg_lo:[0,1,0]
  v_pk_fma_f32 v[52:53], v[52:53], v[26:27], v[64:65] op_sel:[1,1,0] op_sel_hi:[1,0,1] neg_lo:[0,1,0]
  v_cvt_pk_f16_f32 v60, v46, -v47
  ds_write_b32 v5, v60 offset:2112
  v_cvt_pk_f16_f32 v61, v48, v49
  ds_write_b32 v5, v61 offset:26928
  v_cvt_pk_f16_f32 v62, v52, -v53
  ds_write_b32 v5, v62 offset:10032
  v_pk_mul_f32 v[54:55], v[46:47], v[16:17] op_sel:[0,0] op_sel_hi:[0,1]
  v_pk_mul_f32 v[56:57], v[48:49], v[18:19] op_sel:[0,0] op_sel_hi:[0,1]
  v_pk_mul_f32 v[58:59], v[34:35], v[20:21] op_sel:[0,0] op_sel_hi:[0,1]
  v_pk_mul_f32 v[64:65], v[52:53], v[26:27] op_sel:[0,0] op_sel_hi:[0,1]
  v_pk_fma_f32 v[46:47], v[46:47], v[16:17], v[54:55] op_sel:[1,1,0] op_sel_hi:[1,0,1] neg_lo:[0,1,0]
  v_pk_fma_f32 v[48:49], v[48:49], v[18:19], v[56:57] op_sel:[1,1,0] op_sel_hi:[1,0,1] neg_lo:[0,1,0]
  v_pk_fma_f32 v[36:37], v[34:35], v[20:21], v[58:59] op_sel:[1,1,0] op_sel_hi:[1,0,1] neg_lo:[0,1,0]
  v_pk_fma_f32 v[52:53], v[52:53], v[26:27], v[64:65] op_sel:[1,1,0] op_sel_hi:[1,0,1] neg_lo:[0,1,0]
  v_cvt_pk_f16_f32 v63, v46, -v47
  ds_write_b32 v5, v63 offset:2640
  v_cvt_pk_f16_f32 v60, v48, v49
  ds_write_b32 v5, v60 offset:27456
  v_cvt_pk_f16_f32 v61, v36, -v37
  ds_write_b32 v5, v61 offset:15840
  v_cvt_pk_f16_f32 v62, v52, -v53
  ds_write_b32 v5, v62 offset:10560
  v_pk_mul_f32 v[54:55], v[46:47], v[16:17] op_sel:[0,0] op_sel_hi:[0,1]
  v_pk_mul_f32 v[56:57], v[48:49], v[18:19] op_sel:[0,0] op_sel_hi:[0,1]
  v_pk_mul_f32 v[58:59], v[36:37], v[20:21] op_sel:[0,0] op_sel_hi:[0,1]
  v_pk_mul_f32 v[64:65], v[52:53], v[26:27] op_sel:[0,0] op_sel_hi:[0,1]
  v_pk_fma_f32 v[46:47], v[46:47], v[16:17], v[54:55] op_sel:[1,1,0] op_sel_hi:[1,0,1] neg_lo:[0,1,0]
  v_pk_fma_f32 v[48:49], v[48:49], v[18:19], v[56:57] op_sel:[1,1,0] op_sel_hi:[1,0,1] neg_lo:[0,1,0]
  v_pk_fma_f32 v[38:39], v[36:37], v[20:21], v[58:59] op_sel:[1,1,0] op_sel_hi:[1,0,1] neg_lo:[0,1,0]
  v_pk_fma_f32 v[52:53], v[52:53], v[26:27], v[64:65] op_sel:[1,1,0] op_sel_hi:[1,0,1] neg_lo:[0,1,0]
  v_cvt_pk_f16_f32 v63, v46, -v47
  ds_write_b32 v5, v63 offset:3168
  v_cvt_pk_f16_f32 v60, v48, v49
  ds_write_b32 v5, v60 offset:27984
  v_cvt_pk_f16_f32 v61, v38, -v39
  ds_write_b32 v5, v61 offset:18480
  v_cvt_pk_f16_f32 v62, v52, -v53
  ds_write_b32 v5, v62 offset:11088
  v_pk_mul_f32 v[54:55], v[46:47], v[16:17] op_sel:[0,0] op_sel_hi:[0,1]
  v_pk_mul_f32 v[56:57], v[48:49], v[18:19] op_sel:[0,0] op_sel_hi:[0,1]
  v_pk_mul_f32 v[58:59], v[38:39], v[20:21] op_sel:[0,0] op_sel_hi:[0,1]
  v_pk_mul_f32 v[64:65], v[52:53], v[26:27] op_sel:[0,0] op_sel_hi:[0,1]
  v_pk_fma_f32 v[46:47], v[46:47], v[16:17], v[54:55] op_sel:[1,1,0] op_sel_hi:[1,0,1] neg_lo:[0,1,0]
  v_pk_fma_f32 v[48:49], v[48:49], v[18:19], v[56:57] op_sel:[1,1,0] op_sel_hi:[1,0,1] neg_lo:[0,1,0]
  v_pk_fma_f32 v[40:41], v[38:39], v[20:21], v[58:59] op_sel:[1,1,0] op_sel_hi:[1,0,1] neg_lo:[0,1,0]
  v_pk_fma_f32 v[52:53], v[52:53], v[26:27], v[64:65] op_sel:[1,1,0] op_sel_hi:[1,0,1] neg_lo:[0,1,0]
  v_cvt_pk_f16_f32 v63, v46, -v47
  ds_write_b32 v5, v63 offset:3696
  v_cvt_pk_f16_f32 v60, v48, v49
  ds_write_b32 v5, v60 offset:28512
  v_cvt_pk_f16_f32 v61, v40, -v41
  ds_write_b32 v5, v61 offset:20064
  v_cvt_pk_f16_f32 v62, v52, -v53
  ds_write_b32 v5, v62 offset:11616
  v_pk_mul_f32 v[54:55], v[46:47], v[16:17] op_sel:[0,0] op_sel_hi:[0,1]
  v_pk_mul_f32 v[56:57], v[48:49], v[18:19] op_sel:[0,0] op_sel_hi:[0,1]
  v_pk_mul_f32 v[58:59], v[40:41], v[20:21] op_sel:[0,0] op_sel_hi:[0,1]
  v_pk_mul_f32 v[64:65], v[52:53], v[26:27] op_sel:[0,0] op_sel_hi:[0,1]
  v_pk_fma_f32 v[46:47], v[46:47], v[16:17], v[54:55] op_sel:[1,1,0] op_sel_hi:[1,0,1] neg_lo:[0,1,0]
  v_pk_fma_f32 v[48:49], v[48:49], v[18:19], v[56:57] op_sel:[1,1,0] op_sel_hi:[1,0,1] neg_lo:[0,1,0]
  v_pk_fma_f32 v[42:43], v[40:41], v[20:21], v[58:59] op_sel:[1,1,0] op_sel_hi:[1,0,1] neg_lo:[0,1,0]
  v_pk_fma_f32 v[52:53], v[52:53], v[26:27], v[64:65] op_sel:[1,1,0] op_sel_hi:[1,0,1] neg_lo:[0,1,0]
  v_cvt_pk_f16_f32 v63, v46, -v47
  ds_write_b32 v5, v63 offset:4224
  v_cvt_pk_f16_f32 v60, v48, v49
  ds_write_b32 v5, v60 offset:29040
  v_cvt_pk_f16_f32 v61, v42, -v43
  ds_write_b32 v5, v61 offset:21648
  v_cvt_pk_f16_f32 v62, v52, -v53
  ds_write_b32 v5, v62 offset:12144
  v_pk_mul_f32 v[54:55], v[46:47], v[16:17] op_sel:[0,0] op_sel_hi:[0,1]
  v_pk_mul_f32 v[56:57], v[48:49], v[18:19] op_sel:[0,0] op_sel_hi:[0,1]
  v_pk_mul_f32 v[58:59], v[42:43], v[20:21] op_sel:[0,0] op_sel_hi:[0,1]
  v_pk_mul_f32 v[64:65], v[52:53], v[26:27] op_sel:[0,0] op_sel_hi:[0,1]
  v_pk_fma_f32 v[46:47], v[46:47], v[16:17], v[54:55] op_sel:[1,1,0] op_sel_hi:[1,0,1] neg_lo:[0,1,0]
  v_pk_fma_f32 v[48:49], v[48:49], v[18:19], v[56:57] op_sel:[1,1,0] op_sel_hi:[1,0,1] neg_lo:[0,1,0]
  v_pk_fma_f32 v[44:45], v[42:43], v[20:21], v[58:59] op_sel:[1,1,0] op_sel_hi:[1,0,1] neg_lo:[0,1,0]
  v_pk_fma_f32 v[52:53], v[52:53], v[26:27], v[64:65] op_sel:[1,1,0] op_sel_hi:[1,0,1] neg_lo:[0,1,0]
  v_cvt_pk_f16_f32 v63, v46, -v47
  ds_write_b32 v5, v63 offset:4752
  v_cvt_pk_f16_f32 v60, v48, v49
  ds_write_b32 v5, v60 offset:29568
  v_cvt_pk_f16_f32 v61, v44, -v45
  ds_write_b32 v5, v61 offset:23232
  v_cvt_pk_f16_f32 v62, v52, -v53
  ds_write_b32 v5, v62 offset:12672
  v_pk_mul_f32 v[54:55], v[46:47], v[16:17] op_sel:[0,0] op_sel_hi:[0,1]
  v_pk_mul_f32 v[56:57], v[48:49], v[18:19] op_sel:[0,0] op_sel_hi:[0,1]
  v_pk_mul_f32 v[58:59], v[38:39], v[30:31] op_sel:[0,0] op_sel_hi:[0,1]
  v_pk_mul_f32 v[64:65], v[34:35], v[28:29] op_sel:[0,0] op_sel_hi:[0,1]
  v_pk_fma_f32 v[46:47], v[46:47], v[16:17], v[54:55] op_sel:[1,1,0] op_sel_hi:[1,0,1] neg_lo:[0,1,0]
  v_pk_fma_f32 v[48:49], v[48:49], v[18:19], v[56:57] op_sel:[1,1,0] op_sel_hi:[1,0,1] neg_lo:[0,1,0]
  v_pk_fma_f32 v[50:51], v[38:39], v[30:31], v[58:59] op_sel:[1,1,0] op_sel_hi:[1,0,1] neg_lo:[0,1,0]
  v_pk_fma_f32 v[52:53], v[34:35], v[28:29], v[64:65] op_sel:[1,1,0] op_sel_hi:[1,0,1] neg_lo:[0,1,0]
  v_cvt_pk_f16_f32 v63, v46, -v47
  ds_write_b32 v5, v63 offset:5280
  v_cvt_pk_f16_f32 v60, v48, v49
  ds_write_b32 v5, v60 offset:30096
  v_cvt_pk_f16_f32 v61, v50, -v51
  ds_write_b32 v5, v61 offset:19008
  v_cvt_pk_f16_f32 v62, v52, -v53
  ds_write_b32 v5, v62 offset:13728
  v_pk_mul_f32 v[54:55], v[46:47], v[16:17] op_sel:[0,0] op_sel_hi:[0,1]
  v_pk_mul_f32 v[56:57], v[48:49], v[18:19] op_sel:[0,0] op_sel_hi:[0,1]
  v_pk_mul_f32 v[58:59], v[38:39], v[18:19] op_sel:[0,0] op_sel_hi:[0,1]
  v_pk_mul_f32 v[64:65], v[52:53], v[28:29] op_sel:[0,0] op_sel_hi:[0,1]
  v_pk_fma_f32 v[46:47], v[46:47], v[16:17], v[54:55] op_sel:[1,1,0] op_sel_hi:[1,0,1] neg_lo:[0,1,0]
  v_pk_fma_f32 v[48:49], v[48:49], v[18:19], v[56:57] op_sel:[1,1,0] op_sel_hi:[1,0,1] neg_lo:[0,1,0]
  v_pk_fma_f32 v[50:51], v[38:39], v[18:19], v[58:59] op_sel:[1,1,0] op_sel_hi:[1,0,1] neg_lo:[0,1,0]
  v_pk_fma_f32 v[52:53], v[52:53], v[28:29], v[64:65] op_sel:[1,1,0] op_sel_hi:[1,0,1] neg_lo:[0,1,0]
  v_cvt_pk_f16_f32 v63, v46, -v47
  ds_write_b32 v5, v63 offset:5808
  v_cvt_pk_f16_f32 v60, v48, v49
  ds_write_b32 v5, v60 offset:30624
  v_cvt_pk_f16_f32 v61, v50, -v51
  ds_write_b32 v5, v61 offset:19536
  v_cvt_pk_f16_f32 v62, v52, -v53
  ds_write_b32 v5, v62 offset:14256
  v_pk_mul_f32 v[54:55], v[46:47], v[16:17] op_sel:[0,0] op_sel_hi:[0,1]
  v_pk_mul_f32 v[56:57], v[48:49], v[18:19] op_sel:[0,0] op_sel_hi:[0,1]
  v_pk_mul_f32 v[58:59], v[40:41], v[30:31] op_sel:[0,0] op_sel_hi:[0,1]
  v_pk_mul_f32 v[64:65], v[52:53], v[28:29] op_sel:[0,0] op_sel_hi:[0,1]
  v_pk_fma_f32 v[46:47], v[46:47], v[16:17], v[54:55] op_sel:[1,1,0] op_sel_hi:[1,0,1] neg_lo:[0,1,0]
  v_pk_fma_f32 v[48:49], v[48:49], v[18:19], v[56:57] op_sel:[1,1,0] op_sel_hi:[1,0,1] neg_lo:[0,1,0]
  v_pk_fma_f32 v[50:51], v[40:41], v[30:31], v[58:59] op_sel:[1,1,0] op_sel_hi:[1,0,1] neg_lo:[0,1,0]
  v_pk_fma_f32 v[52:53], v[52:53], v[28:29], v[64:65] op_sel:[1,1,0] op_sel_hi:[1,0,1] neg_lo:[0,1,0]
  v_cvt_pk_f16_f32 v63, v46, -v47
  ds_write_b32 v5, v63 offset:6336
  v_cvt_pk_f16_f32 v60, v48, v49
  ds_write_b32 v5, v60 offset:31152
  v_cvt_pk_f16_f32 v61, v50, -v51
  ds_write_b32 v5, v61 offset:20592
  v_cvt_pk_f16_f32 v62, v52, -v53
  ds_write_b32 v5, v62 offset:14784
  v_pk_mul_f32 v[54:55], v[46:47], v[16:17] op_sel:[0,0] op_sel_hi:[0,1]
  v_pk_mul_f32 v[56:57], v[48:49], v[18:19] op_sel:[0,0] op_sel_hi:[0,1]
  v_pk_mul_f32 v[58:59], v[40:41], v[18:19] op_sel:[0,0] op_sel_hi:[0,1]
  v_pk_mul_f32 v[64:65], v[52:53], v[28:29] op_sel:[0,0] op_sel_hi:[0,1]
  v_pk_fma_f32 v[46:47], v[46:47], v[16:17], v[54:55] op_sel:[1,1,0] op_sel_hi:[1,0,1] neg_lo:[0,1,0]
  v_pk_fma_f32 v[48:49], v[48:49], v[18:19], v[56:57] op_sel:[1,1,0] op_sel_hi:[1,0,1] neg_lo:[0,1,0]
  v_pk_fma_f32 v[50:51], v[40:41], v[18:19], v[58:59] op_sel:[1,1,0] op_sel_hi:[1,0,1] neg_lo:[0,1,0]
  v_pk_fma_f32 v[52:53], v[52:53], v[28:29], v[64:65] op_sel:[1,1,0] op_sel_hi:[1,0,1] neg_lo:[0,1,0]
  v_cvt_pk_f16_f32 v63, v46, -v47
  ds_write_b32 v5, v63 offset:6864
  v_cvt_pk_f16_f32 v60, v48, v49
  ds_write_b32 v5, v60 offset:31680
  v_cvt_pk_f16_f32 v61, v50, -v51
  ds_write_b32 v5, v61 offset:21120
  v_cvt_pk_f16_f32 v62, v52, -v53
  ds_write_b32 v5, v62 offset:15312
  v_pk_mul_f32 v[54:55], v[46:47], v[16:17] op_sel:[0,0] op_sel_hi:[0,1]
  v_pk_mul_f32 v[56:57], v[48:49], v[18:19] op_sel:[0,0] op_sel_hi:[0,1]
  v_pk_mul_f32 v[58:59], v[42:43], v[30:31] op_sel:[0,0] op_sel_hi:[0,1]
  v_pk_mul_f32 v[64:65], v[36:37], v[28:29] op_sel:[0,0] op_sel_hi:[0,1]
  v_pk_fma_f32 v[46:47], v[46:47], v[16:17], v[54:55] op_sel:[1,1,0] op_sel_hi:[1,0,1] neg_lo:[0,1,0]
  v_pk_fma_f32 v[48:49], v[48:49], v[18:19], v[56:57] op_sel:[1,1,0] op_sel_hi:[1,0,1] neg_lo:[0,1,0]
  v_pk_fma_f32 v[50:51], v[42:43], v[30:31], v[58:59] op_sel:[1,1,0] op_sel_hi:[1,0,1] neg_lo:[0,1,0]
  v_pk_fma_f32 v[52:53], v[36:37], v[28:29], v[64:65] op_sel:[1,1,0] op_sel_hi:[1,0,1] neg_lo:[0,1,0]
  v_cvt_pk_f16_f32 v63, v46, -v47
  ds_write_b32 v5, v63 offset:7392
  v_cvt_pk_f16_f32 v60, v48, v49
  ds_write_b32 v5, v60 offset:32208
  v_cvt_pk_f16_f32 v61, v50, -v51
  ds_write_b32 v5, v61 offset:22176
  v_cvt_pk_f16_f32 v62, v52, -v53
  ds_write_b32 v5, v62 offset:16368
  v_pk_mul_f32 v[54:55], v[46:47], v[16:17] op_sel:[0,0] op_sel_hi:[0,1]
  v_pk_mul_f32 v[56:57], v[48:49], v[18:19] op_sel:[0,0] op_sel_hi:[0,1]
  v_pk_mul_f32 v[58:59], v[42:43], v[18:19] op_sel:[0,0] op_sel_hi:[0,1]
  v_pk_mul_f32 v[64:65], v[52:53], v[28:29] op_sel:[0,0] op_sel_hi:[0,1]
  v_pk_fma_f32 v[46:47], v[46:47], v[16:17], v[54:55] op_sel:[1,1,0] op_sel_hi:[1,0,1] neg_lo:[0,1,0]
  v_pk_fma_f32 v[48:49], v[48:49], v[18:19], v[56:57] op_sel:[1,1,0] op_sel_hi:[1,0,1] neg_lo:[0,1,0]
  v_pk_fma_f32 v[50:51], v[42:43], v[18:19], v[58:59] op_sel:[1,1,0] op_sel_hi:[1,0,1] neg_lo:[0,1,0]
  v_pk_fma_f32 v[52:53], v[52:53], v[28:29], v[64:65] op_sel:[1,1,0] op_sel_hi:[1,0,1] neg_lo:[0,1,0]
  v_cvt_pk_f16_f32 v63, v46, -v47
  ds_write_b32 v5, v63 offset:7920
  v_cvt_pk_f16_f32 v60, v48, v49
  ds_write_b32 v5, v60 offset:32736
  v_cvt_pk_f16_f32 v61, v50, -v51
  ds_write_b32 v5, v61 offset:22704
  v_cvt_pk_f16_f32 v62, v52, -v53
  ds_write_b32 v5, v62 offset:16896
  v_pk_mul_f32 v[58:59], v[44:45], v[30:31] op_sel:[0,0] op_sel_hi:[0,1]
  v_pk_mul_f32 v[64:65], v[52:53], v[28:29] op_sel:[0,0] op_sel_hi:[0,1]
  v_pk_fma_f32 v[50:51], v[44:45], v[30:31], v[58:59] op_sel:[1,1,0] op_sel_hi:[1,0,1] neg_lo:[0,1,0]
  v_pk_fma_f32 v[52:53], v[52:53], v[28:29], v[64:65] op_sel:[1,1,0] op_sel_hi:[1,0,1] neg_lo:[0,1,0]
  v_cvt_pk_f16_f32 v63, v50, -v51
  ds_write_b32 v5, v63 offset:23760
  v_cvt_pk_f16_f32 v60, v52, -v53
  ds_write_b32 v5, v60 offset:17424
  v_pk_mul_f32 v[58:59], v[44:45], v[18:19] op_sel:[0,0] op_sel_hi:[0,1]
  v_pk_mul_f32 v[64:65], v[52:53], v[28:29] op_sel:[0,0] op_sel_hi:[0,1]
  v_pk_fma_f32 v[50:51], v[44:45], v[18:19], v[58:59] op_sel:[1,1,0] op_sel_hi:[1,0,1] neg_lo:[0,1,0]
  v_pk_fma_f32 v[52:53], v[52:53], v[28:29], v[64:65] op_sel:[1,1,0] op_sel_hi:[1,0,1] neg_lo:[0,1,0]
  v_cvt_pk_f16_f32 v61, v50, -v51
  ds_write_b32 v5, v61 offset:24288
  v_cvt_pk_f16_f32 v62, v52, -v53
  ds_write_b32 v5, v62 offset:17952
  v_mov_b32 v75, 1
  s_waitcnt lgkmcnt(0)
  ds_write_b32 v73, v75
  s_mov_b32 s30, 0
L_ps_15:
  ds_read_b32 v75, v74
  s_add_u32 s30, s30, 1
  s_waitcnt lgkmcnt(0)
  v_readfirstlane_b32 s31, v75
  s_cmp_ge_u32 s31, 1
  s_cbranch_scc1 L_psd_16
  s_cmp_lt_u32 s30, 0x186a00
  s_cbranch_scc1 L_ps_15
L_psd_16:
  ds_read_b128 v[16:19], v70 offset:0
  ds_read_b128 v[20:23], v70 offset:64
  ds_read_b128 v[24:27], v70 offset:128
  ds_read_b128 v[28:31], v70 offset:192
  ds_read_b128 v[32:35], v70 offset:256
  ds_read_b128 v[36:39], v70 offset:320
  ds_read_b128 v[40:43], v70 offset:384
  ds_read_b128 v[44:47], v70 offset:448
  ds_read_b128 v[80:83], v66 offset:0
  ds_read_b128 v[84:87], v66 offset:64
  ds_read_b128 v[88:91], v66 offset:128
  ds_read_b128 v[92:95], v66 offset:192
  ds_read_b128 v[96:99], v66 offset:256
  ds_read_b128 v[100:103], v66 offset:320
  ds_read_b128 v[104:107], v66 offset:384
  ds_read_b128 v[108:111], v66 offset:448
  ds_read_b128 v[112:115], v67 offset:0
  ds_read_b128 v[116:119], v67 offset:64
  ds_read_b128 v[120:123], v67 offset:128
  ds_read_b128 v[124:127], v67 offset:192
  ds_read_b128 v[128:131], v67 offset:256
  ds_read_b128 v[132:135], v67 offset:320
  ds_read_b128 v[136:139], v67 offset:384
  ds_read_b128 v[140:143], v67 offset:448
  s_waitcnt lgkmcnt(15)
  v_mfma_f32_16x16x32_f16 v[48:51], v[80:83], v[16:19], 0
  s_waitcnt lgkmcnt(14)
  v_mfma_f32_16x16x32_f16 v[48:51], v[84:87], v[20:23], v[48:51]
  s_waitcnt lgkmcnt(13)
  v_mfma_f32_16x16x32_f16 v[48:51], v[88:91], v[24:27], v[48:51]
  s_waitcnt lgkmcnt(12)
  v_mfma_f32_16x16x32_f16 v[48:51], v[92:95], v[28:31], v[48:51]
  s_waitcnt lgkmcnt(11)
  v_mfma_f32_16x16x32_f16 v[48:51], v[96:99], v[32:35], v[48:51]
  s_waitcnt lgkmcnt(10)
  v_mfma_f32_16x16x32_f16 v[48:51], v[100:103], v[36:39], v[48:51]
  s_waitcnt lgkmcnt(9)
  v_mfma_f32_16x16x32_f16 v[48:51], v[104:107], v[40:43], v[48:51]
  s_waitcnt lgkmcnt(8)
  v_mfma_f32_16x16x32_f16 v[48:51], v[108:111], v[44:47], v[48:51]
  ds_read_b128 v[80:83], v68 offset:0
  ds_read_b128 v[84:87], v68 offset:64
  ds_read_b128 v[88:91], v68 offset:128
  ds_read_b128 v[92:95], v68 offset:192
  ds_read_b128 v[96:99], v68 offset:256
  ds_read_b128 v[100:103], v68 offset:320
  ds_read_b128 v[104:107], v68 offset:384
  ds_read_b128 v[108:111], v68 offset:448
  s_waitcnt lgkmcnt(15)
  v_mfma_f32_16x16x32_f16 v[52:55], v[112:115], v[16:19], 0
  s_waitcnt lgkmcnt(14)
  v_mfma_f32_16x16x32_f16 v[52:55], v[116:119], v[20:23], v[52:55]
  s_waitcnt lgkmcnt(13)
  v_mfma_f32_16x16x32_f16 v[52:55], v[120:123], v[24:27], v[52:55]
  s_waitcnt lgkmcnt(12)
  v_mfma_f32_16x16x32_f16 v[52:55], v[124:127], v[28:31], v[52:55]
  s_waitcnt lgkmcnt(11)
  v_mfma_f32_16x16x32_f16 v[52:55], v[128:131], v[32:35], v[52:55]
  s_waitcnt lgkmcnt(10)
  v_mfma_f32_16x16x32_f16 v[52:55], v[132:135], v[36:39], v[52:55]
  s_waitcnt lgkmcnt(9)
  v_mfma_f32_16x16x32_f16 v[52:55], v[136:139], v[40:43], v[52:55]
  s_waitcnt lgkmcnt(8)
  v_mfma_f32_16x16x32_f16 v[52:55], v[140:143], v[44:47], v[52:55]
  ds_read_b128 v[112:115], v69 offset:0
  ds_read_b128 v[116:119], v69 offset:64
  ds_read_b128 v[120:123], v69 offset:128
  ds_read_b128 v[124:127], v69 offset:192
  ds_read_b128 v[128:131], v69 offset:256
  ds_read_b128 v[132:135], v69 offset:320
  ds_read_b128 v[136:139], v69 offset:384
  ds_read_b128 v[140:143], v69 offset:448
  s_waitcnt lgkmcnt(15)
  v_mfma_f32_16x16x32_f16 v[56:59], v[80:83], v[16:19], 0
  s_waitcnt lgkmcnt(14)
  v_mfma_f32_16x16x32_f16 v[56:59], v[84:87], v[20:23], v[56:59]
  s_waitcnt lgkmcnt(13)
  v_mfma_f32_16x16x32_f16 v[56:59], v[88:91], v[24:27], v[56:59]
  s_waitcnt lgkmcnt(12)
  v_mfma_f32_16x16x32_f16 v[56:59], v[92:95], v[28:31], v[56:59]
  s_waitcnt lgkmcnt(11)
  v_mfma_f32_16x16x32_f16 v[56:59], v[96:99], v[32:35], v[56:59]
  s_waitcnt lgkmcnt(10)
  v_mfma_f32_16x16x32_f16 v[56:59], v[100:103], v[36:39], v[56:59]
  s_waitcnt lgkmcnt(9)
  v_mfma_f32_16x16x32_f16 v[56:59], v[104:107], v[40:43], v[56:59]
  s_waitcnt lgkmcnt(8)
  v_mfma_f32_16x16x32_f16 v[56:59], v[108:111], v[44:47], v[56:59]
  s_waitcnt lgkmcnt(7)
  v_mfma_f32_16x16x32_f16 v[60:63], v[112:115], v[16:19], 0
  s_waitcnt lgkmcnt(6)
  v_mfma_f32_16x16x32_f16 v[60:63], v[116:119], v[20:23], v[60:63]
  s_waitcnt lgkmcnt(5)
  v_mfma_f32_16x16x32_f16 v[60:63], v[120:123], v[24:27], v[60:63]
  s_waitcnt lgkmcnt(4)
  v_mfma_f32_16x16x32_f16 v[60:63], v[124:127], v[28:31], v[60:63]
  s_waitcnt lgkmcnt(3)
  v_mfma_f32_16x16x32_f16 v[60:63], v[128:131], v[32:35], v[60:63]
  s_waitcnt lgkmcnt(2)
  v_mfma_f32_16x16x32_f16 v[60:63], v[132:135], v[36:39], v[60:63]
  s_waitcnt lgkmcnt(1)
  v_mfma_f32_16x16x32_f16 v[60:63], v[136:139], v[40:43], v[60:63]
  s_waitcnt lgkmcnt(0)
  v_mfma_f32_16x16x32_f16 v[60:63], v[140:143], v[44:47], v[60:63]
  v_readfirstlane_b32 s26, v14
  s_mul_i32 s10, s6, 33280
  s_add_u32 s10, s10, 82944
  v_mov_b32 v75, 2
  s_waitcnt lgkmcnt(0)
  ds_write_b32 v73, v75
  s_mov_b32 s30, 0
L_ps_17:
  ds_read_b32 v75, v74
  s_add_u32 s30, s30, 1
  s_waitcnt lgkmcnt(0)
  v_readfirstlane_b32 s31, v75
  s_cmp_ge_u32 s31, 2
  s_cbranch_scc1 L_psd_18
  s_cmp_lt_u32 s30, 0x186a00
  s_cbranch_scc1 L_ps_17
L_psd_18:
  s_mov_b32 s27, s26
  s_lshl_b32 s18, s7, 11
  s_sub_u32 s18, s10, s18
  v_add_u32 v76, s18, v71
  v_mov_b32 v8, 0
  v_and_b32 v9, 15, v0
  s_mul_i32 s18, s7, 4160
  s_add_u32 s18, s18, s10
  v_lshl_add_u32 v9, v9, 2, s18
  v_cvt_pk_f16_f32 v16, v48, v49
  v_cvt_pk_f16_f32 v17, v50, v51
  v_cvt_pk_f16_f32 v18, v49, v50
  ds_write_b64 v76, v[16:17] offset:7744
  ds_write_b32 v76, v18 offset:3584
  ds_write_b16_d16_hi v76, v17 offset:3588
  ds_write_b16 v76, v16 offset:3582
  v_cvt_pk_f16_f32 v16, v52, v53
  v_cvt_pk_f16_f32 v17, v54, v55
  v_cvt_pk_f16_f32 v18, v53, v54
  ds_write_b64 v76, v[16:17] offset:7232
  ds_write_b32 v76, v18 offset:3072
  ds_write_b16_d16_hi v76, v17 offset:3076
  ds_write_b16 v76, v16 offset:3070
  v_cvt_pk_f16_f32 v16, v56, v57
  v_cvt_pk_f16_f32 v17, v58, v59
  v_cvt_pk_f16_f32 v18, v57, v58
  ds_write_b64 v76, v[16:17] offset:6720
  ds_write_b32 v76, v18 offset:2560
  ds_write_b16_d16_hi v76, v17 offset:2564
  ds_write_b16 v76, v16 offset:2558
  v_cvt_pk_f16_f32 v16, v60, v61
  v_cvt_pk_f16_f32 v17, v62, v63
  v_cvt_pk_f16_f32 v18, v61, v62
  ds_write_b64 v76, v[16:17] offset:6208
  ds_write_b32 v76, v18 offset:2048
  ds_write_b16_d16_hi v76, v17 offset:2052
  v_subrev_u32 v77, 2, v76
  s_sub_u32 s18, s10, 2048
  v_add_u32 v78, 8400, v76
  v_cmp_gt_u32 vcc, s18, v77
  s_nop 1
  v_cndmask_b32 v77, v77, v78, vcc
  ds_write_b16 v77, v16 offset:2048
  ds_write_b32 v9, v8 offset:4096
  v_mov_b32 v9, s10
  ds_write_b16 v9, v8 offset:4094
  v_and_b32 v6, 15, v0
  v_and_b32 v10, 1, v0
  v_mul_u32_u24 v10, 4160, v10
  v_lshl_add_u32 v10, v7, 4, v10
  v_bfe_u32 v11, v0, 1, 3
  v_lshlrev_b32 v11, 2, v11
  v_sub_u32 v10, v10, v11
  s_lshl_b32 s18, s7, 6
  s_sub_u32 s29, s10, s18
  s_add_u32 s29, s29, 3164
  v_add_u32 v12, s29, v10
  v_subrev_u32 v13, 1024, v12
  v_subrev_u32 v14, 2048, v12
  v_subrev_u32 v15, 3072, v12
  s_mul_i32 s21, s6, 8704
  s_add_u32 s21, s21, 65536
  s_sub_u32 s28, s21, s18
  s_add_u32 s28, s28, 96
  v_lshlrev_b32 v10, 5, v6
  v_lshl_add_u32 v11, v7, 4, v10
  v_add_u32 v11, s28, v11
  v_lshl_add_u32 v10, v7, 3, v10
  s_lshl_b32 s18, s7, 11
  s_add_u32 s21, s21, s18
  v_mov_b32 v8, v73
  v_mov_b32 v9, v74
  s_waitcnt lgkmcnt(0)
  s_barrier
  v_mov_b32 v1, 94544
  ds_read_b64 v[2:3], v1
  s_waitcnt lgkmcnt(0)
  v_readfirstlane_b32 s93, v2
  v_readfirstlane_b32 s1, v3
  s_and_b32 s93, s93, -2
  ds_read2_b32 v[16:17], v12 offset0:224 offset1:225
  ds_read2_b32 v[18:19], v12 offset0:226 offset1:227
  ds_read_b128 v[188:191], v11 offset:3968
  ds_read_b128 v[172:175], v11 offset:3456
  ds_read_b128 v[156:159], v11 offset:2944
  ds_read_b128 v[140:143], v11 offset:2432
  ds_read_b128 v[124:127], v11 offset:1920
  ds_read_b128 v[108:111], v11 offset:1408
  s_waitcnt lgkmcnt(5)
  v_mfma_f32_16x16x32_f16 v[60:63], v[16:19], v[188:191], 0
  ds_read_b128 v[92:95], v11 offset:896
  ds_read_b128 v[76:79], v11 offset:384
  s_waitcnt lgkmcnt(6)
  v_mfma_f32_16x16x32_f16 v[56:59], v[16:19], v[172:175], 0
  ds_read2_b32 v[20:21], v12 offset0:192 offset1:193
  ds_read2_b32 v[22:23], v12 offset0:194 offset1:195
  s_waitcnt lgkmcnt(7)
  v_mfma_f32_16x16x32_f16 v[52:55], v[16:19], v[156:159], 0
  ds_read_b128 v[184:187], v11 offset:3840
  ds_read_b128 v[168:171], v11 offset:3328
  s_waitcnt lgkmcnt(8)
  v_mfma_f32_16x16x32_f16 v[48:51], v[16:19], v[140:143], 0
  ds_read_b128 v[152:155], v11 offset:2816
  ds_read_b128 v[136:139], v11 offset:2304
  s_waitcnt lgkmcnt(9)
  v_mfma_f32_16x16x32_f16 v[44:47], v[16:19], v[124:127], 0
  ds_read_b128 v[120:123], v11 offset:1792
  ds_read_b128 v[104:107], v11 offset:1280
  s_waitcnt lgkmcnt(10)
  v_mfma_f32_16x16x32_f16 v[40:43], v[16:19], v[108:111], 0
  ds_read_b128 v[88:91], v11 offset:768
  ds_read_b128 v[72:75], v11 offset:256
  s_waitcnt lgkmcnt(11)
  v_mfma_f32_16x16x32_f16 v[36:39], v[16:19], v[92:95], 0
  ds_read2_b32 v[24:25], v12 offset0:160 offset1:161
  ds_read2_b32 v[26:27], v12 offset0:162 offset1:163
  s_waitcnt lgkmcnt(12)
  v_mfma_f32_16x16x32_f16 v[32:35], v[16:19], v[76:79], 0
  ds_read_b128 v[180:183], v11 offset:3712
  ds_read_b128 v[164:167], v11 offset:3200
  s_waitcnt lgkmcnt(11)
  v_mfma_f32_16x16x32_f16 v[60:63], v[20:23], v[184:187], v[60:63]
  ds_read_b128 v[148:151], v11 offset:2688
  ds_read_b128 v[132:135], v11 offset:2176
  s_waitcnt lgkmcnt(12)
  v_mfma_f32_16x16x32_f16 v[56:59], v[20:23], v[168:171], v[56:59]
  ds_read_b128 v[116:119], v11 offset:1664
  ds_read_b128 v[100:103], v11 offset:1152
  s_waitcnt lgkmcnt(13)
  v_mfma_f32_16x16x32_f16 v[52:55], v[20:23], v[152:155], v[52:55]
  ds_read_b128 v[84:87], v11 offset:640
  s_waitcnt lgkmcnt(13)
  v_mfma_f32_16x16x32_f16 v[48:51], v[20:23], v[136:139], v[48:51]
  ds_read_b128 v[68:71], v11 offset:128
  s_waitcnt lgkmcnt(13)
  v_mfma_f32_16x16x32_f16 v[44:47], v[20:23], v[120:123], v[44:47]
  s_waitcnt lgkmcnt(12)
  v_mfma_f32_16x16x32_f16 v[40:43], v[20:23], v[104:107], v[40:43]
  ds_read2_b32 v[28:29], v12 offset0:128 offset1:129
  ds_read2_b32 v[30:31], v12 offset0:130 offset1:131
  s_waitcnt lgkmcnt(13)
  v_mfma_f32_16x16x32_f16 v[36:39], v[20:23], v[88:91], v[36:39]
  ds_read_b128 v[176:179], v11 offset:3584
  s_waitcnt lgkmcnt(13)
  v_mfma_f32_16x16x32_f16 v[32:35], v[20:23], v[72:75], v[32:35]
  ds_read_b128 v[160:163], v11 offset:3072
  s_waitcnt lgkmcnt(11)
  v_mfma_f32_16x16x32_f16 v[60:63], v[24:27], v[180:183], v[60:63]
  ds_read_b128 v[144:147], v11 offset:2560
  ds_read_b128 v[128:131], v11 offset:2048
  s_waitcnt lgkmcnt(12)
  v_mfma_f32_16x16x32_f16 v[56:59], v[24:27], v[164:167], v[56:59]
  ds_read_b128 v[112:115], v11 offset:1536
  ds_read_b128 v[96:99], v11 offset:1024
  s_waitcnt lgkmcnt(13)
  v_mfma_f32_16x16x32_f16 v[52:55], v[24:27], v[148:151], v[52:55]
  ds_read_b128 v[80:83], v11 offset:512
  s_waitcnt lgkmcnt(13)
  v_mfma_f32_16x16x32_f16 v[48:51], v[24:27], v[132:135], v[48:51]
  ds_read_b128 v[64:67], v11 offset:0
  s_waitcnt lgkmcnt(13)
  v_mfma_f32_16x16x32_f16 v[44:47], v[24:27], v[116:119], v[44:47]
  s_waitcnt lgkmcnt(12)
  v_mfma_f32_16x16x32_f16 v[40:43], v[24:27], v[100:103], v[40:43]
  ds_read2_b32 v[16:17], v12 offset0:96 offset1:97
  ds_read2_b32 v[18:19], v12 offset0:98 offset1:99
  s_waitcnt lgkmcnt(13)
  v_mfma_f32_16x16x32_f16 v[36:39], v[24:27], v[84:87], v[36:39]
  s_waitcnt lgkmcnt(12)
  v_mfma_f32_16x16x32_f16 v[32:35], v[24:27], v[68:71], v[32:35]
  ds_read2_b32 v[20:21], v12 offset0:64 offset1:65
  ds_read2_b32 v[22:23], v12 offset0:66 offset1:67
  s_waitcnt lgkmcnt(11)
  v_mfma_f32_16x16x32_f16 v[60:63], v[28:31], v[176:179], v[60:63]
  ds_read2_b32 v[24:25], v12 offset0:32 offset1:33
  ds_read2_b32 v[26:27], v12 offset0:34 offset1:35
  s_waitcnt lgkmcnt(12)
  v_mfma_f32_16x16x32_f16 v[56:59], v[28:31], v[160:163], v[56:59]
  s_waitcnt lgkmcnt(11)
  v_mfma_f32_16x16x32_f16 v[52:55], v[28:31], v[144:147], v[52:55]
  s_waitcnt lgkmcnt(10)
  v_mfma_f32_16x16x32_f16 v[48:51], v[28:31], v[128:131], v[48:51]
  s_waitcnt lgkmcnt(9)
  v_mfma_f32_16x16x32_f16 v[44:47], v[28:31], v[112:115], v[44:47]
  s_waitcnt lgkmcnt(8)
  v_mfma_f32_16x16x32_f16 v[40:43], v[28:31], v[96:99], v[40:43]
  s_waitcnt lgkmcnt(7)
  v_mfma_f32_16x16x32_f16 v[36:39], v[28:31], v[80:83], v[36:39]
  s_waitcnt lgkmcnt(6)
  v_mfma_f32_16x16x32_f16 v[32:35], v[28:31], v[64:67], v[32:35]
  ds_read2_b32 v[28:29], v12 offset0:0 offset1:1
  ds_read2_b32 v[30:31], v12 offset0:2 offset1:3
  s_waitcnt lgkmcnt(6)
  v_mfma_f32_16x16x32_f16 v[60:63], v[16:19], v[172:175], v[60:63]
  v_mfma_f32_16x16x32_f16 v[56:59], v[16:19], v[156:159], v[56:59]
  v_mfma_f32_16x16x32_f16 v[52:55], v[16:19], v[140:143], v[52:55]
  v_mfma_f32_16x16x32_f16 v[48:51], v[16:19], v[124:127], v[48:51]
  v_mfma_f32_16x16x32_f16 v[44:47], v[16:19], v[108:111], v[44:47]
  v_mfma_f32_16x16x32_f16 v[40:43], v[16:19], v[92:95], v[40:43]
  v_mfma_f32_16x16x32_f16 v[36:39], v[16:19], v[76:79], v[36:39]
  ds_read2_b32 v[16:17], v13 offset0:224 offset1:225
  ds_read2_b32 v[18:19], v13 offset0:226 offset1:227
  s_waitcnt lgkmcnt(6)
  v_mfma_f32_16x16x32_f16 v[60:63], v[20:23], v[168:171], v[60:63]
  v_mfma_f32_16x16x32_f16 v[56:59], v[20:23], v[152:155], v[56:59]
  v_mfma_f32_16x16x32_f16 v[52:55], v[20:23], v[136:139], v[52:55]
  v_mfma_f32_16x16x32_f16 v[48:51], v[20:23], v[120:123], v[48:51]
  v_mfma_f32_16x16x32_f16 v[44:47], v[20:23], v[104:107], v[44:47]
  v_mfma_f32_16x16x32_f16 v[40:43], v[20:23], v[88:91], v[40:43]
  v_mfma_f32_16x16x32_f16 v[36:39], v[20:23], v[72:75], v[36:39]
  ds_read2_b32 v[20:21], v13 offset0:192 offset1:193
  ds_read2_b32 v[22:23], v13 offset0:194 offset1:195
  s_waitcnt lgkmcnt(6)
  v_mfma_f32_16x16x32_f16 v[60:63], v[24:27], v[164:167], v[60:63]
  v_mfma_f32_16x16x32_f16 v[56:59], v[24:27], v[148:151], v[56:59]
  v_mfma_f32_16x16x32_f16 v[52:55], v[24:27], v[132:135], v[52:55]
  v_mfma_f32_16x16x32_f16 v[48:51], v[24:27], v[116:119], v[48:51]
  v_mfma_f32_16x16x32_f16 v[44:47], v[24:27], v[100:103], v[44:47]
  v_mfma_f32_16x16x32_f16 v[40:43], v[24:27], v[84:87], v[40:43]
  v_mfma_f32_16x16x32_f16 v[36:39], v[24:27], v[68:71], v[36:39]
  ds_read2_b32 v[24:25], v13 offset0:160 offset1:161
  ds_read2_b32 v[26:27], v13 offset0:162 offset1:163
  s_waitcnt lgkmcnt(6)
  v_mfma_f32_16x16x32_f16 v[60:63], v[28:31], v[160:163], v[60:63]
  v_mfma_f32_16x16x32_f16 v[56:59], v[28:31], v[144:147], v[56:59]
  v_mfma_f32_16x16x32_f16 v[52:55], v[28:31], v[128:131], v[52:55]
  v_mfma_f32_16x16x32_f16 v[48:51], v[28:31], v[112:115], v[48:51]
  v_mfma_f32_16x16x32_f16 v[44:47], v[28:31], v[96:99], v[44:47]
  v_mfma_f32_16x16x32_f16 v[40:43], v[28:31], v[80:83], v[40:43]
  v_mfma_f32_16x16x32_f16 v[36:39], v[28:31], v[64:67], v[36:39]
  ds_read2_b32 v[28:29], v13 offset0:128 offset1:129
  ds_read2_b32 v[30:31], v13 offset0:130 offset1:131
  s_waitcnt lgkmcnt(6)
  v_mfma_f32_16x16x32_f16 v[60:63], v[16:19], v[156:159], v[60:63]
  v_mfma_f32_16x16x32_f16 v[56:59], v[16:19], v[140:143], v[56:59]
  v_mfma_f32_16x16x32_f16 v[52:55], v[16:19], v[124:127], v[52:55]
  v_mfma_f32_16x16x32_f16 v[48:51], v[16:19], v[108:111], v[48:51]
  v_mfma_f32_16x16x32_f16 v[44:47], v[16:19], v[92:95], v[44:47]
  v_mfma_f32_16x16x32_f16 v[40:43], v[16:19], v[76:79], v[40:43]
  ds_read2_b32 v[16:17], v13 offset0:96 offset1:97
  ds_read2_b32 v[18:19], v13 offset0:98 offset1:99
  s_waitcnt lgkmcnt(6)
  v_mfma_f32_16x16x32_f16 v[60:63], v[20:23], v[152:155], v[60:63]
  v_mfma_f32_16x16x32_f16 v[56:59], v[20:23], v[136:139], v[56:59]
  v_mfma_f32_16x16x32_f16 v[52:55], v[20:23], v[120:123], v[52:55]
  v_mfma_f32_16x16x32_f16 v[48:51], v[20:23], v[104:107], v[48:51]
  v_mfma_f32_16x16x32_f16 v[44:47], v[20:23], v[88:91], v[44:47]
  v_mfma_f32_16x16x32_f16 v[40:43], v[20:23], v[72:75], v[40:43]
  ds_read2_b32 v[20:21], v13 offset0:64 offset1:65
  ds_read2_b32 v[22:23], v13 offset0:66 offset1:67
  s_waitcnt lgkmcnt(6)
  v_mfma_f32_16x16x32_f16 v[60:63], v[24:27], v[148:151], v[60:63]
  v_mfma_f32_16x16x32_f16 v[56:59], v[24:27], v[132:135], v[56:59]
  v_mfma_f32_16x16x32_f16 v[52:55], v[24:27], v[116:119], v[52:55]
  v_mfma_f32_16x16x32_f16 v[48:51], v[24:27], v[100:103], v[48:51]
  v_mfma_f32_16x16x32_f16 v[44:47], v[24:27], v[84:87], v[44:47]
  v_mfma_f32_16x16x32_f16 v[40:43], v[24:27], v[68:71], v[40:43]
  ds_read2_b32 v[24:25], v13 offset0:32 offset1:33
  ds_read2_b32 v[26:27], v13 offset0:34 offset1:35
  s_waitcnt lgkmcnt(6)
  v_mfma_f32_16x16x32_f16 v[60:63], v[28:31], v[144:147], v[60:63]
  v_mfma_f32_16x16x32_f16 v[56:59], v[28:31], v[128:131], v[56:59]
  v_mfma_f32_16x16x32_f16 v[52:55], v[28:31], v[112:115], v[52:55]
  v_mfma_f32_16x16x32_f16 v[48:51], v[28:31], v[96:99], v[48:51]
  v_mfma_f32_16x16x32_f16 v[44:47], v[28:31], v[80:83], v[44:47]
  v_mfma_f32_16x16x32_f16 v[40:43], v[28:31], v[64:67], v[40:43]
  ds_read2_b32 v[28:29], v13 offset0:0 offset1:1
  ds_read2_b32 v[30:31], v13 offset0:2 offset1:3
  s_waitcnt lgkmcnt(6)
  v_mfma_f32_16x16x32_f16 v[60:63], v[16:19], v[140:143], v[60:63]
  v_mfma_f32_16x16x32_f16 v[56:59], v[16:19], v[124:127], v[56:59]
  v_mfma_f32_16x16x32_f16 v[52:55], v[16:19], v[108:111], v[52:55]
  v_mfma_f32_16x16x32_f16 v[48:51], v[16:19], v[92:95], v[48:51]
  v_mfma_f32_16x16x32_f16 v[44:47], v[16:19], v[76:79], v[44:47]
  ds_read2_b32 v[16:17], v14 offset0:224 offset1:225
  ds_read2_b32 v[18:19], v14 offset0:226 offset1:227
  s_waitcnt lgkmcnt(6)
  v_mfma_f32_16x16x32_f16 v[60:63], v[20:23], v[136:139], v[60:63]
  v_mfma_f32_16x16x32_f16 v[56:59], v[20:23], v[120:123], v[56:59]
  v_mfma_f32_16x16x32_f16 v[52:55], v[20:23], v[104:107], v[52:55]
  v_mfma_f32_16x16x32_f16 v[48:51], v[20:23], v[88:91], v[48:51]
  v_mfma_f32_16x16x32_f16 v[44:47], v[20:23], v[72:75], v[44:47]
  ds_read2_b32 v[20:21], v14 offset0:192 offset1:193
  ds_read2_b32 v[22:23], v14 offset0:194 offset1:195
  s_waitcnt lgkmcnt(6)
  v_mfma_f32_16x16x32_f16 v[60:63], v[24:27], v[132:135], v[60:63]
  v_mfma_f32_16x16x32_f16 v[56:59], v[24:27], v[116:119], v[56:59]
  v_mfma_f32_16x16x32_f16 v[52:55], v[24:27], v[100:103], v[52:55]
  v_mfma_f32_16x16x32_f16 v[48:51], v[24:27], v[84:87], v[48:51]
  v_mfma_f32_16x16x32_f16 v[44:47], v[24:27], v[68:71], v[44:47]
  ds_read2_b32 v[24:25], v14 offset0:160 offset1:161
  ds_read2_b32 v[26:27], v14 offset0:162 offset1:163
  s_waitcnt lgkmcnt(6)
  v_mfma_f32_16x16x32_f16 v[60:63], v[28:31], v[128:131], v[60:63]
  v_mfma_f32_16x16x32_f16 v[56:59], v[28:31], v[112:115], v[56:59]
  v_mfma_f32_16x16x32_f16 v[52:55], v[28:31], v[96:99], v[52:55]
  v_mfma_f32_16x16x32_f16 v[48:51], v[28:31], v[80:83], v[48:51]
  v_mfma_f32_16x16x32_f16 v[44:47], v[28:31], v[64:67], v[44:47]
  ds_read2_b32 v[28:29], v14 offset0:128 offset1:129
  ds_read2_b32 v[30:31], v14 offset0:130 offset1:131
  s_waitcnt lgkmcnt(6)
  v_mfma_f32_16x16x32_f16 v[60:63], v[16:19], v[124:127], v[60:63]
  v_mfma_f32_16x16x32_f16 v[56:59], v[16:19], v[108:111], v[56:59]
  v_mfma_f32_16x16x32_f16 v[52:55], v[16:19], v[92:95], v[52:55]
  v_mfma_f32_16x16x32_f16 v[48:51], v[16:19], v[76:79], v[48:51]
  ds_read2_b32 v[16:17], v14 offset0:96 offset1:97
  ds_read2_b32 v[18:19], v14 offset0:98 offset1:99
  s_waitcnt lgkmcnt(6)
  v_mfma_f32_16x16x32_f16 v[60:63], v[20:23], v[120:123], v[60:63]
  v_mfma_f32_16x16x32_f16 v[56:59], v[20:23], v[104:107], v[56:59]
  v_mfma_f32_16x16x32_f16 v[52:55], v[20:23], v[88:91], v[52:55]
  v_mfma_f32_16x16x32_f16 v[48:51], v[20:23], v[72:75], v[48:51]
  ds_read2_b32 v[20:21], v14 offset0:64 offset1:65
  ds_read2_b32 v[22:23], v14 offset0:66 offset1:67
  s_waitcnt lgkmcnt(6)
  v_mfma_f32_16x16x32_f16 v[60:63], v[24:27], v[116:119], v[60:63]
  v_mfma_f32_16x16x32_f16 v[56:59], v[24:27], v[100:103], v[56:59]
  v_mfma_f32_16x16x32_f16 v[52:55], v[24:27], v[84:87], v[52:55]
  v_mfma_f32_16x16x32_f16 v[48:51], v[24:27], v[68:71], v[48:51]
  ds_read2_b32 v[24:25], v14 offset0:32 offset1:33
  ds_read2_b32 v[26:27], v14 offset0:34 offset1:35
  s_waitcnt lgkmcnt(6)
  v_mfma_f32_16x16x32_f16 v[60:63], v[28:31], v[112:115], v[60:63]
  v_mfma_f32_16x16x32_f16 v[56:59], v[28:31], v[96:99], v[56:59]
  v_mfma_f32_16x16x32_f16 v[52:55], v[28:31], v[80:83], v[52:55]
  v_mfma_f32_16x16x32_f16 v[48:51], v[28:31], v[64:67], v[48:51]
  ds_read2_b32 v[28:29], v14 offset0:0 offset1:1
  ds_read2_b32 v[30:31], v14 offset0:2 offset1:3
  s_waitcnt lgkmcnt(6)
  v_mfma_f32_16x16x32_f16 v[60:63], v[16:19], v[108:111], v[60:63]
  v_mfma_f32_16x16x32_f16 v[56:59], v[16:19], v[92:95], v[56:59]
  v_mfma_f32_16x16x32_f16 v[52:55], v[16:19], v[76:79], v[52:55]
  ds_read2_b32 v[16:17], v15 offset0:224 offset1:225
  ds_read2_b32 v[18:19], v15 offset0:226 offset1:227
  s_waitcnt lgkmcnt(6)
  v_mfma_f32_16x16x32_f16 v[60:63], v[20:23], v[104:107], v[60:63]
  v_mfma_f32_16x16x32_f16 v[56:59], v[20:23], v[88:91], v[56:59]
  v_mfma_f32_16x16x32_f16 v[52:55], v[20:23], v[72:75], v[52:55]
  ds_read2_b32 v[20:21], v15 offset0:192 offset1:193
  ds_read2_b32 v[22:23], v15 offset0:194 offset1:195
  s_waitcnt lgkmcnt(6)
  v_mfma_f32_16x16x32_f16 v[60:63], v[24:27], v[100:103], v[60:63]
  v_mfma_f32_16x16x32_f16 v[56:59], v[24:27], v[84:87], v[56:59]
  v_mfma_f32_16x16x32_f16 v[52:55], v[24:27], v[68:71], v[52:55]
  ds_read2_b32 v[24:25], v15 offset0:160 offset1:161
  ds_read2_b32 v[26:27], v15 offset0:162 offset1:163
  s_waitcnt lgkmcnt(6)
  v_mfma_f32_16x16x32_f16 v[60:63], v[28:31], v[96:99], v[60:63]
  v_mfma_f32_16x16x32_f16 v[56:59], v[28:31], v[80:83], v[56:59]
  v_mfma_f32_16x16x32_f16 v[52:55], v[28:31], v[64:67], v[52:55]
  ds_read2_b32 v[28:29], v15 offset0:128 offset1:129
  ds_read2_b32 v[30:31], v15 offset0:130 offset1:131
  s_waitcnt lgkmcnt(6)
  v_mfma_f32_16x16x32_f16 v[60:63], v[16:19], v[92:95], v[60:63]
  v_mfma_f32_16x16x32_f16 v[56:59], v[16:19], v[76:79], v[56:59]
  ds_read2_b32 v[16:17], v15 offset0:96 offset1:97
  ds_read2_b32 v[18:19], v15 offset0:98 offset1:99
  s_waitcnt lgkmcnt(6)
  v_mfma_f32_16x16x32_f16 v[60:63], v[20:23], v[88:91], v[60:63]
  v_mfma_f32_16x16x32_f16 v[56:59], v[20:23], v[72:75], v[56:59]
  ds_read2_b32 v[20:21], v15 offset0:64 offset1:65
  ds_read2_b32 v[22:23], v15 offset0:66 offset1:67
  s_waitcnt lgkmcnt(6)
  v_mfma_f32_16x16x32_f16 v[60:63], v[24:27], v[84:87], v[60:63]
  v_mfma_f32_16x16x32_f16 v[56:59], v[24:27], v[68:71], v[56:59]
  ds_read2_b32 v[24:25], v15 offset0:32 offset1:33
  ds_read2_b32 v[26:27], v15 offset0:34 offset1:35
  s_waitcnt lgkmcnt(6)
  v_mfma_f32_16x16x32_f16 v[60:63], v[28:31], v[80:83], v[60:63]
  v_mfma_f32_16x16x32_f16 v[56:59], v[28:31], v[64:67], v[56:59]
  ds_read2_b32 v[28:29], v15 offset0:0 offset1:1
  ds_read2_b32 v[30:31], v15 offset0:2 offset1:3
  s_waitcnt lgkmcnt(6)
  v_mfma_f32_16x16x32_f16 v[60:63], v[16:19], v[76:79], v[60:63]
  s_waitcnt lgkmcnt(4)
  v_mfma_f32_16x16x32_f16 v[60:63], v[20:23], v[72:75], v[60:63]
  s_waitcnt lgkmcnt(2)
  v_mfma_f32_16x16x32_f16 v[60:63], v[24:27], v[68:71], v[60:63]
  s_waitcnt lgkmcnt(0)
  v_mfma_f32_16x16x32_f16 v[60:63], v[28:31], v[64:67], v[60:63]
  s_lshl_b32 s18, s5, 12
  s_add_u32 s18, s18, 98304
  v_lshl_add_u32 v5, v0, 4, s18
  v_xor_b32 v6, 4096, v5
  v_add_u32 v7, s21, v10
  s_lshl_b32 s28, s16, 12
  s_lshl_b32 s29, s7, 11
  s_add_u32 s28, s28, s29
  s_nop 4
  s_cmp_eq_u32 s7, 0
  s_cbranch_scc1 L_cv_a
  ds_write_b128 v5, v[32:35] offset:0
  ds_write_b128 v5, v[36:39] offset:1024
  ds_write_b128 v5, v[40:43] offset:2048
  ds_write_b128 v5, v[44:47] offset:3072
  v_mov_b32 v16, v48
  v_mov_b32 v17, v49
  v_mov_b32 v18, v50
  v_mov_b32 v19, v51
  v_mov_b32 v20, v52
  v_mov_b32 v21, v53
  v_mov_b32 v22, v54
  v_mov_b32 v23, v55
  v_mov_b32 v24, v56
  v_mov_b32 v25, v57
  v_mov_b32 v26, v58
  v_mov_b32 v27, v59
  v_mov_b32 v28, v60
  v_mov_b32 v29, v61
  v_mov_b32 v30, v62
  v_mov_b32 v31, v63
  s_branch L_cv_b
L_cv_a:
  ds_write_b128 v5, v[48:51] offset:0
  ds_write_b128 v5, v[52:55] offset:1024
  ds_write_b128 v5, v[56:59] offset:2048
  ds_write_b128 v5, v[60:63] offset:3072
  v_mov_b32 v16, v32
  v_mov_b32 v17, v33
  v_mov_b32 v18, v34
  v_mov_b32 v19, v35
  v_mov_b32 v20, v36
  v_mov_b32 v21, v37
  v_mov_b32 v22, v38
  v_mov_b32 v23, v39
  v_mov_b32 v24, v40
  v_mov_b32 v25, v41
  v_mov_b32 v26, v42
  v_mov_b32 v27, v43
  v_mov_b32 v28, v44
  v_mov_b32 v29, v45
  v_mov_b32 v30, v46
  v_mov_b32 v31, v47
L_cv_b:
  ds_read_b64 v[80:81], v7 offset:4608
  ds_read_b64 v[88:89], v7 offset:512
  ds_read_b64 v[82:83], v7 offset:5120
  ds_read_b64 v[90:91], v7 offset:1024
  ds_read_b64 v[84:85], v7 offset:5632
  ds_read_b64 v[92:93], v7 offset:1536
  ds_read_b64 v[86:87], v7 offset:6144
  ds_read_b64 v[94:95], v7 offset:2048
  v_mov_b32 v100, 3
  s_waitcnt lgkmcnt(0)
  ds_write_b32 v8, v100
  s_mov_b32 s30, 0
L_ps_19:
  ds_read_b32 v100, v9
  s_add_u32 s30, s30, 1
  s_waitcnt lgkmcnt(0)
  v_readfirstlane_b32 s31, v100
  s_cmp_ge_u32 s31, 3
  s_cbranch_scc1 L_psd_20
  s_cmp_lt_u32 s30, 0x186a00
  s_cbranch_scc1 L_ps_19
L_psd_20:
  ds_read_b128 v[64:67], v6 offset:0
  ds_read_b128 v[68:71], v6 offset:1024
  ds_read_b128 v[72:75], v6 offset:2048
  ds_read_b128 v[76:79], v6 offset:3072
  s_waitcnt lgkmcnt(3)
  v_pk_add_f32 v[16:17], v[16:17], v[64:65]
  v_lshlrev_b32 v96, 16, v80
  v_and_b32 v97, 0xffff0000, v80
  v_pk_fma_f32 v[16:17], v[16:17], s[26:27], v[96:97]
  v_fma_mix_f32 v16, v88, s23, v16 op_sel_hi:[1,0,0]
  v_fma_mix_f32 v17, v88, s23, v17 op_sel:[1,0,0] op_sel_hi:[1,0,0]
  v_cvt_pk_bf16_f32 v98, v16, v17
  v_pk_add_f32 v[18:19], v[18:19], v[66:67]
  v_lshlrev_b32 v96, 16, v81
  v_and_b32 v97, 0xffff0000, v81
  v_pk_fma_f32 v[18:19], v[18:19], s[26:27], v[96:97]
  v_fma_mix_f32 v18, v89, s23, v18 op_sel_hi:[1,0,0]
  v_fma_mix_f32 v19, v89, s23, v19 op_sel:[1,0,0] op_sel_hi:[1,0,0]
  v_cvt_pk_bf16_f32 v99, v18, v19
  buffer_store_dwordx2 v[98:99], v10, s[12:15], s28 offen offset:0 sc1
  s_waitcnt lgkmcnt(2)
  v_pk_add_f32 v[20:21], v[20:21], v[68:69]
  v_lshlrev_b32 v96, 16, v82
  v_and_b32 v97, 0xffff0000, v82
  v_pk_fma_f32 v[20:21], v[20:21], s[26:27], v[96:97]
  v_fma_mix_f32 v20, v90, s23, v20 op_sel_hi:[1,0,0]
  v_fma_mix_f32 v21, v90, s23, v21 op_sel:[1,0,0] op_sel_hi:[1,0,0]
  v_cvt_pk_bf16_f32 v100, v20, v21
  v_pk_add_f32 v[22:23], v[22:23], v[70:71]
  v_lshlrev_b32 v96, 16, v83
  v_and_b32 v97, 0xffff0000, v83
  v_pk_fma_f32 v[22:23], v[22:23], s[26:27], v[96:97]
  v_fma_mix_f32 v22, v91, s23, v22 op_sel_hi:[1,0,0]
  v_fma_mix_f32 v23, v91, s23, v23 op_sel:[1,0,0] op_sel_hi:[1,0,0]
  v_cvt_pk_bf16_f32 v101, v22, v23
  buffer_store_dwordx2 v[100:101], v10, s[12:15], s28 offen offset:512 sc1
  s_waitcnt lgkmcnt(1)
  v_pk_add_f32 v[24:25], v[24:25], v[72:73]
  v_lshlrev_b32 v96, 16, v84
  v_and_b32 v97, 0xffff0000, v84
  v_pk_fma_f32 v[24:25], v[24:25], s[26:27], v[96:97]
  v_fma_mix_f32 v24, v92, s23, v24 op_sel_hi:[1,0,0]
  v_fma_mix_f32 v25, v92, s23, v25 op_sel:[1,0,0] op_sel_hi:[1,0,0]
  v_cvt_pk_bf16_f32 v102, v24, v25
  v_pk_add_f32 v[26:27], v[26:27], v[74:75]
  v_lshlrev_b32 v96, 16, v85
  v_and_b32 v97, 0xffff0000, v85
  v_pk_fma_f32 v[26:27], v[26:27], s[26:27], v[96:97]
  v_fma_mix_f32 v26, v93, s23, v26 op_sel_hi:[1,0,0]
  v_fma_mix_f32 v27, v93, s23, v27 op_sel:[1,0,0] op_sel_hi:[1,0,0]
  v_cvt_pk_bf16_f32 v103, v26, v27
  buffer_store_dwordx2 v[102:103], v10, s[12:15], s28 offen offset:1024 sc1
  s_waitcnt lgkmcnt(0)
  v_pk_add_f32 v[28:29], v[28:29], v[76:77]
  v_lshlrev_b32 v96, 16, v86
  v_and_b32 v97, 0xffff0000, v86
  v_pk_fma_f32 v[28:29], v[28:29], s[26:27], v[96:97]
  v_fma_mix_f32 v28, v94, s23, v28 op_sel_hi:[1,0,0]
  v_fma_mix_f32 v29, v94, s23, v29 op_sel:[1,0,0] op_sel_hi:[1,0,0]
  v_cvt_pk_bf16_f32 v104, v28, v29
  v_pk_add_f32 v[30:31], v[30:31], v[78:79]
  v_lshlrev_b32 v96, 16, v87
  v_and_b32 v97, 0xffff0000, v87
  v_pk_fma_f32 v[30:31], v[30:31], s[26:27], v[96:97]
  v_fma_mix_f32 v30, v95, s23, v30 op_sel_hi:[1,0,0]
  v_fma_mix_f32 v31, v95, s23, v31 op_sel:[1,0,0] op_sel_hi:[1,0,0]
  v_cvt_pk_bf16_f32 v105, v30, v31
  buffer_store_dwordx2 v[104:105], v10, s[12:15], s28 offen offset:1536 sc1
  v_mov_b32 v1, 95080
  v_mov_b32 v2, 1
  s_mov_b64 exec, 1
  s_waitcnt vmcnt(0)
  ds_add_rtn_u32 v2, v1, v2
  v_mov_b32 v1, 14028800
  s_lshl_b32 s18, s2, 4
  s_waitcnt lgkmcnt(0)
  v_readfirstlane_b32 s19, v2
  v_mov_b32 v2, s93
  s_cmp_lg_u32 s19, 3
  s_cbranch_scc1 L_nof2
  buffer_store_dword v2, v1, s[12:15], s18 offen sc1
L_nof2:
  s_mov_b64 exec, -1
  s_and_b32 s21, s5, 1
  s_lshr_b32 s22, s5, 1
  s_lshr_b32 s19, s4, 3
  s_lshl_b32 s18, s3, 2
  s_add_u32 s19, s19, s18
  s_and_b32 s20, s4, 7
  s_lshl_b32 s29, s19, 6
  s_lshl_b32 s18, s22, 5
  s_add_u32 s29, s29, s18
  s_lshl_b32 s17, s20, 1
  s_add_u32 s17, s17, s21
  s_lshl_b32 s16, s29, 10
  s_lshl_b32 s18, s17, 10
  s_add_u32 s16, s16, s18
  s_lshl_b32 s24, s21, 1
  s_lshl_b32 s25, s22, 1
  s_lshl_b32 s23, s19, 5
  s_lshl_b32 s18, s22, 4
  s_add_u32 s23, s23, s18
  s_add_u32 s23, s23, s17
  s_lshl_b32 s23, s23, 2
  v_lshrrev_b32 v4, 4, v0
  v_lshlrev_b32 v5, 4, v0
  v_and_b32 v7, 15, v0
  s_mov_b32 s90, 0x3b000000
  v_lshrrev_b32 v1, 2, v0
  v_lshlrev_b32 v1, 7, v1
  v_and_b32 v2, 3, v0
  v_lshl_add_u32 v1, v2, 3, v1
  v_bfe_u32 v2, v0, 3, 2
  v_xor_b32 v2, s24, v2
  v_lshl_add_u32 v8, v2, 5, v1
  v_xor_b32 v9, 32, v8
  v_add_u32 v10, 0x10000, v8
  v_add_u32 v11, 0x10000, v9
  v_add_u32 v12, 0x20000, v8
  v_add_u32 v13, 0x20000, v9
  v_lshrrev_b32 v1, 2, v0
  v_lshlrev_b32 v1, 7, v1
  v_and_b32 v2, 3, v0
  v_lshl_add_u32 v1, v2, 3, v1
  v_bfe_u32 v2, v0, 3, 2
  v_xor_b32 v2, s25, v2
  v_lshl_add_u32 v20, v2, 5, v1
  v_xor_b32 v21, 32, v20
  v_add_u32 v22, 0x10000, v20
  v_add_u32 v23, 0x10000, v21
  v_add_u32 v24, 0x20000, v20
  v_add_u32 v25, 0x20000, v21
  s_mov_b32 s80, 0x3f000000
  s_mov_b32 s81, 0x3ecc1a00
  s_mov_b32 s82, 0xbd8707f0
  s_mov_b32 s83, 0x3c1ae5e6
  s_mov_b32 s84, 0xba7c280c
  s_mov_b32 s85, 0x3885dd3d
  s_mov_b32 s86, 0xb6230e95
  s_mov_b32 s87, 0x332a98e9
  s_barrier
  v_mov_b32 v128, 0x3f803f80
  v_mov_b32 v129, 0x3f803f80
  v_mov_b32 v130, 0x3f803f80
  v_mov_b32 v131, 0x3f803f80
  ds_read_b64_tr_b16 v[32:33], v8 offset:0
  ds_read_b64_tr_b16 v[34:35], v8 offset:2048
  ds_read_b64_tr_b16 v[36:37], v9 offset:0
  ds_read_b64_tr_b16 v[38:39], v9 offset:2048
  ds_read_b64_tr_b16 v[40:41], v8 offset:4096
  ds_read_b64_tr_b16 v[42:43], v8 offset:6144
  ds_read_b64_tr_b16 v[44:45], v9 offset:4096
  ds_read_b64_tr_b16 v[46:47], v9 offset:6144
  ds_read_b64_tr_b16 v[48:49], v8 offset:8192
  ds_read_b64_tr_b16 v[50:51], v8 offset:10240
  ds_read_b64_tr_b16 v[52:53], v9 offset:8192
  ds_read_b64_tr_b16 v[54:55], v9 offset:10240
  ds_read_b64_tr_b16 v[56:57], v8 offset:12288
  ds_read_b64_tr_b16 v[58:59], v8 offset:14336
  ds_read_b64_tr_b16 v[60:61], v9 offset:12288
  ds_read_b64_tr_b16 v[62:63], v9 offset:14336
  s_waitcnt lgkmcnt(12)
  v_mfma_f32_16x16x32_bf16 v[136:139], v[32:35], v[128:131], 0
  v_mfma_f32_16x16x32_bf16 v[140:143], v[36:39], v[128:131], 0
  ds_read_b64_tr_b16 v[32:33], v8 offset:16384
  ds_read_b64_tr_b16 v[34:35], v8 offset:18432
  ds_read_b64_tr_b16 v[36:37], v9 offset:16384
  ds_read_b64_tr_b16 v[38:39], v9 offset:18432
  s_waitcnt lgkmcnt(12)
  v_mfma_f32_16x16x32_bf16 v[136:139], v[40:43], v[128:131], v[136:139]
  v_mfma_f32_16x16x32_bf16 v[140:143], v[44:47], v[128:131], v[140:143]
  ds_read_b64_tr_b16 v[40:41], v8 offset:20480
  ds_read_b64_tr_b16 v[42:43], v8 offset:22528
  ds_read_b64_tr_b16 v[44:45], v9 offset:20480
  ds_read_b64_tr_b16 v[46:47], v9 offset:22528
  s_waitcnt lgkmcnt(12)
  v_mfma_f32_16x16x32_bf16 v[136:139], v[48:51], v[128:131], v[136:139]
  v_mfma_f32_16x16x32_bf16 v[140:143], v[52:55], v[128:131], v[140:143]
  ds_read_b64_tr_b16 v[48:49], v8 offset:24576
  ds_read_b64_tr_b16 v[50:51], v8 offset:26624
  ds_read_b64_tr_b16 v[52:53], v9 offset:24576
  ds_read_b64_tr_b16 v[54:55], v9 offset:26624
  s_waitcnt lgkmcnt(12)
  v_mfma_f32_16x16x32_bf16 v[136:139], v[56:59], v[128:131], v[136:139]
  v_mfma_f32_16x16x32_bf16 v[140:143], v[60:63], v[128:131], v[140:143]
  ds_read_b64_tr_b16 v[56:57], v8 offset:28672
  ds_read_b64_tr_b16 v[58:59], v8 offset:30720
  ds_read_b64_tr_b16 v[60:61], v9 offset:28672
  ds_read_b64_tr_b16 v[62:63], v9 offset:30720
  s_waitcnt lgkmcnt(12)
  v_mfma_f32_16x16x32_bf16 v[136:139], v[32:35], v[128:131], v[136:139]
  v_mfma_f32_16x16x32_bf16 v[140:143], v[36:39], v[128:131], v[140:143]
  ds_read_b64_tr_b16 v[32:33], v8 offset:32768
  ds_read_b64_tr_b16 v[34:35], v8 offset:34816
  ds_read_b64_tr_b16 v[36:37], v9 offset:32768
  ds_read_b64_tr_b16 v[38:39], v9 offset:34816
  s_waitcnt lgkmcnt(12)
  v_mfma_f32_16x16x32_bf16 v[136:139], v[40:43], v[128:131], v[136:139]
  v_mfma_f32_16x16x32_bf16 v[140:143], v[44:47], v[128:131], v[140:143]
  ds_read_b64_tr_b16 v[40:41], v8 offset:36864
  ds_read_b64_tr_b16 v[42:43], v8 offset:38912
  ds_read_b64_tr_b16 v[44:45], v9 offset:36864
  ds_read_b64_tr_b16 v[46:47], v9 offset:38912
  s_waitcnt lgkmcnt(12)
  v_mfma_f32_16x16x32_bf16 v[136:139], v[48:51], v[128:131], v[136:139]
  v_mfma_f32_16x16x32_bf16 v[140:143], v[52:55], v[128:131], v[140:143]
  ds_read_b64_tr_b16 v[48:49], v8 offset:40960
  ds_read_b64_tr_b16 v[50:51], v8 offset:43008
  ds_read_b64_tr_b16 v[52:53], v9 offset:40960
  ds_read_b64_tr_b16 v[54:55], v9 offset:43008
  s_waitcnt lgkmcnt(12)
  v_mfma_f32_16x16x32_bf16 v[136:139], v[56:59], v[128:131], v[136:139]
  v_mfma_f32_16x16x32_bf16 v[140:143], v[60:63], v[128:131], v[140:143]
  ds_read_b64_tr_b16 v[56:57], v8 offset:45056
  ds_read_b64_tr_b16 v[58:59], v8 offset:47104
  ds_read_b64_tr_b16 v[60:61], v9 offset:45056
  ds_read_b64_tr_b16 v[62:63], v9 offset:47104
  s_waitcnt lgkmcnt(12)
  v_mfma_f32_16x16x32_bf16 v[136:139], v[32:35], v[128:131], v[136:139]
  v_mfma_f32_16x16x32_bf16 v[140:143], v[36:39], v[128:131], v[140:143]
  ds_read_b64_tr_b16 v[32:33], v8 offset:49152
  ds_read_b64_tr_b16 v[34:35], v8 offset:51200
  ds_read_b64_tr_b16 v[36:37], v9 offset:49152
  ds_read_b64_tr_b16 v[38:39], v9 offset:51200
  s_waitcnt lgkmcnt(12)
  v_mfma_f32_16x16x32_bf16 v[136:139], v[40:43], v[128:131], v[136:139]
  v_mfma_f32_16x16x32_bf16 v[140:143], v[44:47], v[128:131], v[140:143]
  ds_read_b64_tr_b16 v[40:41], v8 offset:53248
  ds_read_b64_tr_b16 v[42:43], v8 offset:55296
  ds_read_b64_tr_b16 v[44:45], v9 offset:53248
  ds_read_b64_tr_b16 v[46:47], v9 offset:55296
  s_waitcnt lgkmcnt(12)
  v_mfma_f32_16x16x32_bf16 v[136:139], v[48:51], v[128:131], v[136:139]
  v_mfma_f32_16x16x32_bf16 v[140:143], v[52:55], v[128:131], v[140:143]
  ds_read_b64_tr_b16 v[48:49], v8 offset:57344
  ds_read_b64_tr_b16 v[50:51], v8 offset:59392
  ds_read_b64_tr_b16 v[52:53], v9 offset:57344
  ds_read_b64_tr_b16 v[54:55], v9 offset:59392
  s_waitcnt lgkmcnt(12)
  v_mfma_f32_16x16x32_bf16 v[136:139], v[56:59], v[128:131], v[136:139]
  v_mfma_f32_16x16x32_bf16 v[140:143], v[60:63], v[128:131], v[140:143]
  ds_read_b64_tr_b16 v[56:57], v8 offset:61440
  ds_read_b64_tr_b16 v[58:59], v8 offset:63488
  ds_read_b64_tr_b16 v[60:61], v9 offset:61440
  ds_read_b64_tr_b16 v[62:63], v9 offset:63488
  s_waitcnt lgkmcnt(12)
  v_mfma_f32_16x16x32_bf16 v[136:139], v[32:35], v[128:131], v[136:139]
  v_mfma_f32_16x16x32_bf16 v[140:143], v[36:39], v[128:131], v[140:143]
  s_waitcnt lgkmcnt(8)
  v_mfma_f32_16x16x32_bf16 v[136:139], v[40:43], v[128:131], v[136:139]
  v_mfma_f32_16x16x32_bf16 v[140:143], v[44:47], v[128:131], v[140:143]
  s_waitcnt lgkmcnt(4)
  v_mfma_f32_16x16x32_bf16 v[136:139], v[48:51], v[128:131], v[136:139]
  v_mfma_f32_16x16x32_bf16 v[140:143], v[52:55], v[128:131], v[140:143]
  s_waitcnt lgkmcnt(0)
  v_mfma_f32_16x16x32_bf16 v[136:139], v[56:59], v[128:131], v[136:139]
  v_mfma_f32_16x16x32_bf16 v[140:143], v[60:63], v[128:131], v[140:143]
  s_barrier
  ds_read_b64_tr_b16 v[96:97], v22 offset:0
  ds_read_b64_tr_b16 v[98:99], v22 offset:2048
  ds_read_b64_tr_b16 v[100:101], v23 offset:0
  ds_read_b64_tr_b16 v[102:103], v23 offset:2048
  ds_read_b64_tr_b16 v[32:33], v8 offset:0
  ds_read_b64_tr_b16 v[34:35], v8 offset:2048
  ds_read_b64_tr_b16 v[36:37], v9 offset:0
  ds_read_b64_tr_b16 v[38:39], v9 offset:2048
  s_waitcnt lgkmcnt(0)
  v_mfma_f32_16x16x32_bf16 v[112:115], v[128:131], v[96:99], 0
  ds_read_b64_tr_b16 v[104:105], v22 offset:4096
  ds_read_b64_tr_b16 v[106:107], v22 offset:6144
  v_mfma_f32_16x16x32_bf16 v[120:123], v[96:99], v[96:99], 0
  ds_read_b64_tr_b16 v[108:109], v23 offset:4096
  ds_read_b64_tr_b16 v[110:111], v23 offset:6144
  v_mfma_f32_16x16x32_bf16 v[116:119], v[128:131], v[100:103], 0
  ds_read_b64_tr_b16 v[40:41], v8 offset:4096
  ds_read_b64_tr_b16 v[42:43], v8 offset:6144
  v_mfma_f32_16x16x32_bf16 v[124:127], v[100:103], v[100:103], 0
  ds_read_b64_tr_b16 v[44:45], v9 offset:4096
  ds_read_b64_tr_b16 v[46:47], v9 offset:6144
  v_mfma_f32_16x16x32_bf16 v[160:163], v[32:35], v[96:99], 0
  v_mfma_f32_16x16x32_bf16 v[164:167], v[32:35], v[100:103], 0
  v_mfma_f32_16x16x32_bf16 v[168:171], v[36:39], v[96:99], 0
  v_mfma_f32_16x16x32_bf16 v[172:175], v[36:39], v[100:103], 0
  s_barrier
  s_waitcnt lgkmcnt(0)
  v_mfma_f32_16x16x32_bf16 v[112:115], v[128:131], v[104:107], v[112:115]
  ds_read_b64_tr_b16 v[96:97], v22 offset:8192
  ds_read_b64_tr_b16 v[98:99], v22 offset:10240
  v_mfma_f32_16x16x32_bf16 v[120:123], v[104:107], v[104:107], v[120:123]
  ds_read_b64_tr_b16 v[100:101], v23 offset:8192
  ds_read_b64_tr_b16 v[102:103], v23 offset:10240
  v_mfma_f32_16x16x32_bf16 v[116:119], v[128:131], v[108:111], v[116:119]
  ds_read_b64_tr_b16 v[32:33], v8 offset:8192
  ds_read_b64_tr_b16 v[34:35], v8 offset:10240
  v_mfma_f32_16x16x32_bf16 v[124:127], v[108:111], v[108:111], v[124:127]
  ds_read_b64_tr_b16 v[36:37], v9 offset:8192
  ds_read_b64_tr_b16 v[38:39], v9 offset:10240
  v_mfma_f32_16x16x32_bf16 v[160:163], v[40:43], v[104:107], v[160:163]
  v_mfma_f32_16x16x32_bf16 v[164:167], v[40:43], v[108:111], v[164:167]
  v_mfma_f32_16x16x32_bf16 v[168:171], v[44:47], v[104:107], v[168:171]
  v_mfma_f32_16x16x32_bf16 v[172:175], v[44:47], v[108:111], v[172:175]
  s_waitcnt lgkmcnt(0)
  v_mfma_f32_16x16x32_bf16 v[112:115], v[128:131], v[96:99], v[112:115]
  ds_read_b64_tr_b16 v[104:105], v22 offset:12288
  ds_read_b64_tr_b16 v[106:107], v22 offset:14336
  v_mfma_f32_16x16x32_bf16 v[120:123], v[96:99], v[96:99], v[120:123]
  ds_read_b64_tr_b16 v[108:109], v23 offset:12288
  ds_read_b64_tr_b16 v[110:111], v23 offset:14336
  v_mfma_f32_16x16x32_bf16 v[116:119], v[128:131], v[100:103], v[116:119]
  ds_read_b64_tr_b16 v[40:41], v8 offset:12288
  ds_read_b64_tr_b16 v[42:43], v8 offset:14336
  v_mfma_f32_16x16x32_bf16 v[124:127], v[100:103], v[100:103], v[124:127]
  ds_read_b64_tr_b16 v[44:45], v9 offset:12288
  ds_read_b64_tr_b16 v[46:47], v9 offset:14336
  v_mfma_f32_16x16x32_bf16 v[160:163], v[32:35], v[96:99], v[160:163]
  v_mfma_f32_16x16x32_bf16 v[164:167], v[32:35], v[100:103], v[164:167]
  v_mfma_f32_16x16x32_bf16 v[168:171], v[36:39], v[96:99], v[168:171]
  v_mfma_f32_16x16x32_bf16 v[172:175], v[36:39], v[100:103], v[172:175]
  s_barrier
  s_waitcnt lgkmcnt(0)
  v_mfma_f32_16x16x32_bf16 v[112:115], v[128:131], v[104:107], v[112:115]
  ds_read_b64_tr_b16 v[96:97], v22 offset:16384
  ds_read_b64_tr_b16 v[98:99], v22 offset:18432
  v_mfma_f32_16x16x32_bf16 v[120:123], v[104:107], v[104:107], v[120:123]
  ds_read_b64_tr_b16 v[100:101], v23 offset:16384
  ds_read_b64_tr_b16 v[102:103], v23 offset:18432
  v_mfma_f32_16x16x32_bf16 v[116:119], v[128:131], v[108:111], v[116:119]
  ds_read_b64_tr_b16 v[32:33], v8 offset:16384
  ds_read_b64_tr_b16 v[34:35], v8 offset:18432
  v_mfma_f32_16x16x32_bf16 v[124:127], v[108:111], v[108:111], v[124:127]
  ds_read_b64_tr_b16 v[36:37], v9 offset:16384
  ds_read_b64_tr_b16 v[38:39], v9 offset:18432
  v_mfma_f32_16x16x32_bf16 v[160:163], v[40:43], v[104:107], v[160:163]
  v_mfma_f32_16x16x32_bf16 v[164:167], v[40:43], v[108:111], v[164:167]
  v_mfma_f32_16x16x32_bf16 v[168:171], v[44:47], v[104:107], v[168:171]
  v_mfma_f32_16x16x32_bf16 v[172:175], v[44:47], v[108:111], v[172:175]
  s_waitcnt lgkmcnt(0)
  v_mfma_f32_16x16x32_bf16 v[112:115], v[128:131], v[96:99], v[112:115]
  ds_read_b64_tr_b16 v[104:105], v22 offset:20480
  ds_read_b64_tr_b16 v[106:107], v22 offset:22528
  v_mfma_f32_16x16x32_bf16 v[120:123], v[96:99], v[96:99], v[120:123]
  ds_read_b64_tr_b16 v[108:109], v23 offset:20480
  ds_read_b64_tr_b16 v[110:111], v23 offset:22528
  v_mfma_f32_16x16x32_bf16 v[116:119], v[128:131], v[100:103], v[116:119]
  ds_read_b64_tr_b16 v[40:41], v8 offset:20480
  ds_read_b64_tr_b16 v[42:43], v8 offset:22528
  v_mfma_f32_16x16x32_bf16 v[124:127], v[100:103], v[100:103], v[124:127]
  ds_read_b64_tr_b16 v[44:45], v9 offset:20480
  ds_read_b64_tr_b16 v[46:47], v9 offset:22528
  v_mfma_f32_16x16x32_bf16 v[160:163], v[32:35], v[96:99], v[160:163]
  v_mfma_f32_16x16x32_bf16 v[164:167], v[32:35], v[100:103], v[164:167]
  v_mfma_f32_16x16x32_bf16 v[168:171], v[36:39], v[96:99], v[168:171]
  v_mfma_f32_16x16x32_bf16 v[172:175], v[36:39], v[100:103], v[172:175]
  s_barrier
  s_waitcnt lgkmcnt(0)
  v_mfma_f32_16x16x32_bf16 v[112:115], v[128:131], v[104:107], v[112:115]
  ds_read_b64_tr_b16 v[96:97], v22 offset:24576
  ds_read_b64_tr_b16 v[98:99], v22 offset:26624
  v_mfma_f32_16x16x32_bf16 v[120:123], v[104:107], v[104:107], v[120:123]
  ds_read_b64_tr_b16 v[100:101], v23 offset:24576
  ds_read_b64_tr_b16 v[102:103], v23 offset:26624
  v_mfma_f32_16x16x32_bf16 v[116:119], v[128:131], v[108:111], v[116:119]
  ds_read_b64_tr_b16 v[32:33], v8 offset:24576
  ds_read_b64_tr_b16 v[34:35], v8 offset:26624
  v_mfma_f32_16x16x32_bf16 v[124:127], v[108:111], v[108:111], v[124:127]
  ds_read_b64_tr_b16 v[36:37], v9 offset:24576
  ds_read_b64_tr_b16 v[38:39], v9 offset:26624
  v_mfma_f32_16x16x32_bf16 v[160:163], v[40:43], v[104:107], v[160:163]
  v_mfma_f32_16x16x32_bf16 v[164:167], v[40:43], v[108:111], v[164:167]
  v_mfma_f32_16x16x32_bf16 v[168:171], v[44:47], v[104:107], v[168:171]
  v_mfma_f32_16x16x32_bf16 v[172:175], v[44:47], v[108:111], v[172:175]
  s_waitcnt lgkmcnt(0)
  v_mfma_f32_16x16x32_bf16 v[112:115], v[128:131], v[96:99], v[112:115]
  ds_read_b64_tr_b16 v[104:105], v22 offset:28672
  ds_read_b64_tr_b16 v[106:107], v22 offset:30720
  v_mfma_f32_16x16x32_bf16 v[120:123], v[96:99], v[96:99], v[120:123]
  ds_read_b64_tr_b16 v[108:109], v23 offset:28672
  ds_read_b64_tr_b16 v[110:111], v23 offset:30720
  v_mfma_f32_16x16x32_bf16 v[116:119], v[128:131], v[100:103], v[116:119]
  ds_read_b64_tr_b16 v[40:41], v8 offset:28672
  ds_read_b64_tr_b16 v[42:43], v8 offset:30720
  v_mfma_f32_16x16x32_bf16 v[124:127], v[100:103], v[100:103], v[124:127]
  ds_read_b64_tr_b16 v[44:45], v9 offset:28672
  ds_read_b64_tr_b16 v[46:47], v9 offset:30720
  v_mfma_f32_16x16x32_bf16 v[160:163], v[32:35], v[96:99], v[160:163]
  v_mfma_f32_16x16x32_bf16 v[164:167], v[32:35], v[100:103], v[164:167]
  v_mfma_f32_16x16x32_bf16 v[168:171], v[36:39], v[96:99], v[168:171]
  v_mfma_f32_16x16x32_bf16 v[172:175], v[36:39], v[100:103], v[172:175]
  s_barrier
  s_waitcnt lgkmcnt(0)
  v_mfma_f32_16x16x32_bf16 v[112:115], v[128:131], v[104:107], v[112:115]
  ds_read_b64_tr_b16 v[96:97], v22 offset:32768
  ds_read_b64_tr_b16 v[98:99], v22 offset:34816
  v_mfma_f32_16x16x32_bf16 v[120:123], v[104:107], v[104:107], v[120:123]
  ds_read_b64_tr_b16 v[100:101], v23 offset:32768
  ds_read_b64_tr_b16 v[102:103], v23 offset:34816
  v_mfma_f32_16x16x32_bf16 v[116:119], v[128:131], v[108:111], v[116:119]
  ds_read_b64_tr_b16 v[32:33], v8 offset:32768
  ds_read_b64_tr_b16 v[34:35], v8 offset:34816
  v_mfma_f32_16x16x32_bf16 v[124:127], v[108:111], v[108:111], v[124:127]
  ds_read_b64_tr_b16 v[36:37], v9 offset:32768
  ds_read_b64_tr_b16 v[38:39], v9 offset:34816
  v_mfma_f32_16x16x32_bf16 v[160:163], v[40:43], v[104:107], v[160:163]
  v_mfma_f32_16x16x32_bf16 v[164:167], v[40:43], v[108:111], v[164:167]
  v_mfma_f32_16x16x32_bf16 v[168:171], v[44:47], v[104:107], v[168:171]
  v_mfma_f32_16x16x32_bf16 v[172:175], v[44:47], v[108:111], v[172:175]
  s_waitcnt lgkmcnt(0)
  v_mfma_f32_16x16x32_bf16 v[112:115], v[128:131], v[96:99], v[112:115]
  ds_read_b64_tr_b16 v[104:105], v22 offset:36864
  ds_read_b64_tr_b16 v[106:107], v22 offset:38912
  v_mfma_f32_16x16x32_bf16 v[120:123], v[96:99], v[96:99], v[120:123]
  ds_read_b64_tr_b16 v[108:109], v23 offset:36864
  ds_read_b64_tr_b16 v[110:111], v23 offset:38912
  v_mfma_f32_16x16x32_bf16 v[116:119], v[128:131], v[100:103], v[116:119]
  ds_read_b64_tr_b16 v[40:41], v8 offset:36864
  ds_read_b64_tr_b16 v[42:43], v8 offset:38912
  v_mfma_f32_16x16x32_bf16 v[124:127], v[100:103], v[100:103], v[124:127]
  ds_read_b64_tr_b16 v[44:45], v9 offset:36864
  ds_read_b64_tr_b16 v[46:47], v9 offset:38912
  v_mfma_f32_16x16x32_bf16 v[160:163], v[32:35], v[96:99], v[160:163]
  v_mfma_f32_16x16x32_bf16 v[164:167], v[32:35], v[100:103], v[164:167]
  v_mfma_f32_16x16x32_bf16 v[168:171], v[36:39], v[96:99], v[168:171]
  v_mfma_f32_16x16x32_bf16 v[172:175], v[36:39], v[100:103], v[172:175]
  s_barrier
  s_waitcnt lgkmcnt(0)
  v_mfma_f32_16x16x32_bf16 v[112:115], v[128:131], v[104:107], v[112:115]
  ds_read_b64_tr_b16 v[96:97], v22 offset:40960
  ds_read_b64_tr_b16 v[98:99], v22 offset:43008
  v_mfma_f32_16x16x32_bf16 v[120:123], v[104:107], v[104:107], v[120:123]
  ds_read_b64_tr_b16 v[100:101], v23 offset:40960
  ds_read_b64_tr_b16 v[102:103], v23 offset:43008
  v_mfma_f32_16x16x32_bf16 v[116:119], v[128:131], v[108:111], v[116:119]
  ds_read_b64_tr_b16 v[32:33], v8 offset:40960
  ds_read_b64_tr_b16 v[34:35], v8 offset:43008
  v_mfma_f32_16x16x32_bf16 v[124:127], v[108:111], v[108:111], v[124:127]
  ds_read_b64_tr_b16 v[36:37], v9 offset:40960
  ds_read_b64_tr_b16 v[38:39], v9 offset:43008
  v_mfma_f32_16x16x32_bf16 v[160:163], v[40:43], v[104:107], v[160:163]
  v_mfma_f32_16x16x32_bf16 v[164:167], v[40:43], v[108:111], v[164:167]
  v_mfma_f32_16x16x32_bf16 v[168:171], v[44:47], v[104:107], v[168:171]
  v_mfma_f32_16x16x32_bf16 v[172:175], v[44:47], v[108:111], v[172:175]
  s_waitcnt lgkmcnt(0)
  v_mfma_f32_16x16x32_bf16 v[112:115], v[128:131], v[96:99], v[112:115]
  ds_read_b64_tr_b16 v[104:105], v22 offset:45056
  ds_read_b64_tr_b16 v[106:107], v22 offset:47104
  v_mfma_f32_16x16x32_bf16 v[120:123], v[96:99], v[96:99], v[120:123]
  ds_read_b64_tr_b16 v[108:109], v23 offset:45056
  ds_read_b64_tr_b16 v[110:111], v23 offset:47104
  v_mfma_f32_16x16x32_bf16 v[116:119], v[128:131], v[100:103], v[116:119]
  ds_read_b64_tr_b16 v[40:41], v8 offset:45056
  ds_read_b64_tr_b16 v[42:43], v8 offset:47104
  v_mfma_f32_16x16x32_bf16 v[124:127], v[100:103], v[100:103], v[124:127]
  ds_read_b64_tr_b16 v[44:45], v9 offset:45056
  ds_read_b64_tr_b16 v[46:47], v9 offset:47104
  v_mfma_f32_16x16x32_bf16 v[160:163], v[32:35], v[96:99], v[160:163]
  v_mfma_f32_16x16x32_bf16 v[164:167], v[32:35], v[100:103], v[164:167]
  v_mfma_f32_16x16x32_bf16 v[168:171], v[36:39], v[96:99], v[168:171]
  v_mfma_f32_16x16x32_bf16 v[172:175], v[36:39], v[100:103], v[172:175]
  s_barrier
  s_waitcnt lgkmcnt(0)
  v_mfma_f32_16x16x32_bf16 v[112:115], v[128:131], v[104:107], v[112:115]
  ds_read_b64_tr_b16 v[96:97], v22 offset:49152
  ds_read_b64_tr_b16 v[98:99], v22 offset:51200
  v_mfma_f32_16x16x32_bf16 v[120:123], v[104:107], v[104:107], v[120:123]
  ds_read_b64_tr_b16 v[100:101], v23 offset:49152
  ds_read_b64_tr_b16 v[102:103], v23 offset:51200
  v_mfma_f32_16x16x32_bf16 v[116:119], v[128:131], v[108:111], v[116:119]
  ds_read_b64_tr_b16 v[32:33], v8 offset:49152
  ds_read_b64_tr_b16 v[34:35], v8 offset:51200
  v_mfma_f32_16x16x32_bf16 v[124:127], v[108:111], v[108:111], v[124:127]
  ds_read_b64_tr_b16 v[36:37], v9 offset:49152
  ds_read_b64_tr_b16 v[38:39], v9 offset:51200
  v_mfma_f32_16x16x32_bf16 v[160:163], v[40:43], v[104:107], v[160:163]
  v_mfma_f32_16x16x32_bf16 v[164:167], v[40:43], v[108:111], v[164:167]
  v_mfma_f32_16x16x32_bf16 v[168:171], v[44:47], v[104:107], v[168:171]
  v_mfma_f32_16x16x32_bf16 v[172:175], v[44:47], v[108:111], v[172:175]
  s_waitcnt lgkmcnt(0)
  v_mfma_f32_16x16x32_bf16 v[112:115], v[128:131], v[96:99], v[112:115]
  ds_read_b64_tr_b16 v[104:105], v22 offset:53248
  ds_read_b64_tr_b16 v[106:107], v22 offset:55296
  v_mfma_f32_16x16x32_bf16 v[120:123], v[96:99], v[96:99], v[120:123]
  ds_read_b64_tr_b16 v[108:109], v23 offset:53248
  ds_read_b64_tr_b16 v[110:111], v23 offset:55296
  v_mfma_f32_16x16x32_bf16 v[116:119], v[128:131], v[100:103], v[116:119]
  ds_read_b64_tr_b16 v[40:41], v8 offset:53248
  ds_read_b64_tr_b16 v[42:43], v8 offset:55296
  v_mfma_f32_16x16x32_bf16 v[124:127], v[100:103], v[100:103], v[124:127]
  ds_read_b64_tr_b16 v[44:45], v9 offset:53248
  ds_read_b64_tr_b16 v[46:47], v9 offset:55296
  v_mfma_f32_16x16x32_bf16 v[160:163], v[32:35], v[96:99], v[160:163]
  v_mfma_f32_16x16x32_bf16 v[164:167], v[32:35], v[100:103], v[164:167]
  v_mfma_f32_16x16x32_bf16 v[168:171], v[36:39], v[96:99], v[168:171]
  v_mfma_f32_16x16x32_bf16 v[172:175], v[36:39], v[100:103], v[172:175]
  s_barrier
  s_waitcnt lgkmcnt(0)
  v_mfma_f32_16x16x32_bf16 v[112:115], v[128:131], v[104:107], v[112:115]
  ds_read_b64_tr_b16 v[96:97], v22 offset:57344
  ds_read_b64_tr_b16 v[98:99], v22 offset:59392
  v_mfma_f32_16x16x32_bf16 v[120:123], v[104:107], v[104:107], v[120:123]
  ds_read_b64_tr_b16 v[100:101], v23 offset:57344
  ds_read_b64_tr_b16 v[102:103], v23 offset:59392
  v_mfma_f32_16x16x32_bf16 v[116:119], v[128:131], v[108:111], v[116:119]
  ds_read_b64_tr_b16 v[32:33], v8 offset:57344
  ds_read_b64_tr_b16 v[34:35], v8 offset:59392
  v_mfma_f32_16x16x32_bf16 v[124:127], v[108:111], v[108:111], v[124:127]
  ds_read_b64_tr_b16 v[36:37], v9 offset:57344
  ds_read_b64_tr_b16 v[38:39], v9 offset:59392
  v_mfma_f32_16x16x32_bf16 v[160:163], v[40:43], v[104:107], v[160:163]
  v_mfma_f32_16x16x32_bf16 v[164:167], v[40:43], v[108:111], v[164:167]
  v_mfma_f32_16x16x32_bf16 v[168:171], v[44:47], v[104:107], v[168:171]
  v_mfma_f32_16x16x32_bf16 v[172:175], v[44:47], v[108:111], v[172:175]
  s_waitcnt lgkmcnt(0)
  v_mfma_f32_16x16x32_bf16 v[112:115], v[128:131], v[96:99], v[112:115]
  ds_read_b64_tr_b16 v[104:105], v22 offset:61440
  ds_read_b64_tr_b16 v[106:107], v22 offset:63488
  v_mfma_f32_16x16x32_bf16 v[120:123], v[96:99], v[96:99], v[120:123]
  ds_read_b64_tr_b16 v[108:109], v23 offset:61440
  ds_read_b64_tr_b16 v[110:111], v23 offset:63488
  v_mfma_f32_16x16x32_bf16 v[116:119], v[128:131], v[100:103], v[116:119]
  ds_read_b64_tr_b16 v[40:41], v8 offset:61440
  ds_read_b64_tr_b16 v[42:43], v8 offset:63488
  v_mfma_f32_16x16x32_bf16 v[124:127], v[100:103], v[100:103], v[124:127]
  ds_read_b64_tr_b16 v[44:45], v9 offset:61440
  ds_read_b64_tr_b16 v[46:47], v9 offset:63488
  v_mfma_f32_16x16x32_bf16 v[160:163], v[32:35], v[96:99], v[160:163]
  v_mfma_f32_16x16x32_bf16 v[164:167], v[32:35], v[100:103], v[164:167]
  v_mfma_f32_16x16x32_bf16 v[168:171], v[36:39], v[96:99], v[168:171]
  v_mfma_f32_16x16x32_bf16 v[172:175], v[36:39], v[100:103], v[172:175]
  s_waitcnt lgkmcnt(0)
  v_mfma_f32_16x16x32_bf16 v[112:115], v[128:131], v[104:107], v[112:115]
  v_mfma_f32_16x16x32_bf16 v[120:123], v[104:107], v[104:107], v[120:123]
  v_mfma_f32_16x16x32_bf16 v[116:119], v[128:131], v[108:111], v[116:119]
  v_mfma_f32_16x16x32_bf16 v[124:127], v[108:111], v[108:111], v[124:127]
  v_mfma_f32_16x16x32_bf16 v[160:163], v[40:43], v[104:107], v[160:163]
  v_mfma_f32_16x16x32_bf16 v[164:167], v[40:43], v[108:111], v[164:167]
  v_mfma_f32_16x16x32_bf16 v[168:171], v[44:47], v[104:107], v[168:171]
  v_mfma_f32_16x16x32_bf16 v[172:175], v[44:47], v[108:111], v[172:175]
  s_lshl_b32 s18, s17, 12
  s_add_u32 s18, s18, 65536
  v_add_u32 v1, s18, v20
  v_add_u32 v2, s18, v21
  ds_read_b64_tr_b16 v[240:241], v1 offset:0
  ds_read_b64_tr_b16 v[242:243], v1 offset:2048
  ds_read_b64_tr_b16 v[244:245], v2 offset:0
  ds_read_b64_tr_b16 v[246:247], v2 offset:2048
  v_and_b32 v3, 3, v0
  v_lshrrev_b32 v6, 2, v7
  v_cmp_eq_u32 s[40:41], 1, v3
  v_cmp_eq_u32 s[42:43], 2, v3
  v_cmp_eq_u32 s[44:45], 3, v3
  v_cmp_eq_u32 s[46:47], v6, v4
  s_waitcnt lgkmcnt(0)
  s_barrier
  v_cndmask_b32 v120, v120, v121, s[40:41]
  v_cndmask_b32 v120, v120, v122, s[42:43]
  v_cndmask_b32 v120, v120, v123, s[44:45]
  v_cndmask_b32 v120, 0, v120, s[46:47]
  v_mov_b32 v121, v120
  v_cndmask_b32 v124, v124, v125, s[40:41]
  v_cndmask_b32 v124, v124, v126, s[42:43]
  v_cndmask_b32 v124, v124, v127, s[44:45]
  v_cndmask_b32 v124, 0, v124, s[46:47]
  v_mov_b32 v125, v124
  v_permlane32_swap_b32 v120, v121
  s_nop 0
  v_permlane32_swap_b32 v124, v125
  v_add_f32 v120, v120, v121
  v_mov_b32 v121, v120
  v_add_f32 v124, v124, v125
  v_mov_b32 v125, v124
  v_permlane16_swap_b32 v120, v121
  s_nop 0
  v_permlane16_swap_b32 v124, v125
  s_add_u32 s33, s16, 2097152
  s_add_u32 s27, s16, 2113536
  v_add_f32 v120, v120, v121
  v_mul_f32 v112, 0x3b000000, v112
  v_mul_f32 v121, v112, v112
  v_fma_f32 v120, v120, s90, -v121
  v_max_f32 v120, 0, v120
  v_cvt_pk_bf16_f32 v114, v112, v112
  v_and_b32 v114, 0xffff0000, v114
  v_cvt_pk_bf16_f32 v121, v120, v120
  v_and_b32 v121, 0xffff0000, v121
  v_add_f32 v121, 0x3727c5ac, v121
  v_cvt_pk_bf16_f32 v121, v121, v121
  v_and_b32 v121, 0xffff0000, v121
  v_sqrt_f32 v121, v121
  s_nop 0
  v_cvt_pk_bf16_f32 v121, v121, v121
  v_and_b32 v121, 0xffff0000, v121
  v_rcp_f32 v115, v121
  s_nop 0
  v_sub_f32 v112, v112, v114
  v_mul_f32 v120, v120, v115
  v_mul_f32 v112, v112, v115
  v_mul_f32 v120, v120, v115
  v_cvt_pk_bf16_f32 v112, v112, v112
  v_and_b32 v112, 0xffff0000, v112
  v_cvt_pk_bf16_f32 v120, v120, v120
  v_and_b32 v120, 0xffff0000, v120
  v_add_f32 v120, 0x3727c5ac, v120
  v_fma_f32 v112, -v112, v121, -v114
  v_cvt_pk_bf16_f32 v120, v120, v120
  v_and_b32 v120, 0xffff0000, v120
  v_sqrt_f32 v120, v120
  s_nop 0
  v_cvt_pk_bf16_f32 v120, v120, v120
  v_and_b32 v120, 0xffff0000, v120
  v_rcp_f32 v121, v120
  s_nop 0
  v_mul_f32 v121, v121, v115
  v_add_f32 v124, v124, v125
  v_mul_f32 v116, 0x3b000000, v116
  v_mul_f32 v125, v116, v116
  v_fma_f32 v124, v124, s90, -v125
  v_max_f32 v124, 0, v124
  v_cvt_pk_bf16_f32 v118, v116, v116
  v_and_b32 v118, 0xffff0000, v118
  v_cvt_pk_bf16_f32 v125, v124, v124
  v_and_b32 v125, 0xffff0000, v125
  v_add_f32 v125, 0x3727c5ac, v125
  v_cvt_pk_bf16_f32 v125, v125, v125
  v_and_b32 v125, 0xffff0000, v125
  v_sqrt_f32 v125, v125
  s_nop 0
  v_cvt_pk_bf16_f32 v125, v125, v125
  v_and_b32 v125, 0xffff0000, v125
  v_rcp_f32 v119, v125
  s_nop 0
  v_sub_f32 v116, v116, v118
  v_mul_f32 v124, v124, v119
  v_mul_f32 v116, v116, v119
  v_mul_f32 v124, v124, v119
  v_cvt_pk_bf16_f32 v116, v116, v116
  v_and_b32 v116, 0xffff0000, v116
  v_cvt_pk_bf16_f32 v124, v124, v124
  v_and_b32 v124, 0xffff0000, v124
  v_add_f32 v124, 0x3727c5ac, v124
  v_fma_f32 v116, -v116, v125, -v118
  v_cvt_pk_bf16_f32 v124, v124, v124
  v_and_b32 v124, 0xffff0000, v124
  v_sqrt_f32 v124, v124
  s_nop 0
  v_cvt_pk_bf16_f32 v124, v124, v124
  v_and_b32 v124, 0xffff0000, v124
  v_rcp_f32 v125, v124
  s_nop 0
  v_mul_f32 v125, v125, v119
  v_pk_fma_f32 v[160:161], v[136:137], v[112:113], v[160:161] op_sel:[0,0,0] op_sel_hi:[1,0,1]
  v_pk_fma_f32 v[162:163], v[138:139], v[112:113], v[162:163] op_sel:[0,0,0] op_sel_hi:[1,0,1]
  v_pk_fma_f32 v[168:169], v[140:141], v[112:113], v[168:169] op_sel:[0,0,0] op_sel_hi:[1,0,1]
  v_pk_fma_f32 v[170:171], v[142:143], v[112:113], v[170:171] op_sel:[0,0,0] op_sel_hi:[1,0,1]
  v_pk_mul_f32 v[160:161], v[160:161], v[120:121] op_sel:[0,1] op_sel_hi:[1,1]
  v_pk_mul_f32 v[162:163], v[162:163], v[120:121] op_sel:[0,1] op_sel_hi:[1,1]
  v_pk_mul_f32 v[168:169], v[168:169], v[120:121] op_sel:[0,1] op_sel_hi:[1,1]
  v_pk_mul_f32 v[170:171], v[170:171], v[120:121] op_sel:[0,1] op_sel_hi:[1,1]
  v_pk_mul_f32 v[32:33], v[160:161], v[160:161]
  v_pk_mul_f32 v[34:35], v[162:163], v[162:163]
  v_pk_mul_f32 v[36:37], v[168:169], v[168:169]
  v_pk_mul_f32 v[38:39], v[170:171], v[170:171]
  v_pk_fma_f32 v[40:41], v[32:33], s[86:87], s[86:87] op_sel:[0,1,0] op_sel_hi:[1,1,0]
  v_pk_fma_f32 v[42:43], v[34:35], s[86:87], s[86:87] op_sel:[0,1,0] op_sel_hi:[1,1,0]
  v_pk_fma_f32 v[44:45], v[36:37], s[86:87], s[86:87] op_sel:[0,1,0] op_sel_hi:[1,1,0]
  v_pk_fma_f32 v[46:47], v[38:39], s[86:87], s[86:87] op_sel:[0,1,0] op_sel_hi:[1,1,0]
  v_pk_fma_f32 v[40:41], v[40:41], v[32:33], s[84:85] op_sel:[0,0,1] op_sel_hi:[1,1,1]
  v_pk_fma_f32 v[42:43], v[42:43], v[34:35], s[84:85] op_sel:[0,0,1] op_sel_hi:[1,1,1]
  v_pk_fma_f32 v[44:45], v[44:45], v[36:37], s[84:85] op_sel:[0,0,1] op_sel_hi:[1,1,1]
  v_pk_fma_f32 v[46:47], v[46:47], v[38:39], s[84:85] op_sel:[0,0,1] op_sel_hi:[1,1,1]
  v_pk_fma_f32 v[40:41], v[40:41], v[32:33], s[84:85] op_sel:[0,0,0] op_sel_hi:[1,1,0]
  v_pk_fma_f32 v[42:43], v[42:43], v[34:35], s[84:85] op_sel:[0,0,0] op_sel_hi:[1,1,0]
  v_pk_fma_f32 v[44:45], v[44:45], v[36:37], s[84:85] op_sel:[0,0,0] op_sel_hi:[1,1,0]
  v_pk_fma_f32 v[46:47], v[46:47], v[38:39], s[84:85] op_sel:[0,0,0] op_sel_hi:[1,1,0]
  v_pk_fma_f32 v[40:41], v[40:41], v[32:33], s[82:83] op_sel:[0,0,1] op_sel_hi:[1,1,1]
  v_pk_fma_f32 v[42:43], v[42:43], v[34:35], s[82:83] op_sel:[0,0,1] op_sel_hi:[1,1,1]
  v_pk_fma_f32 v[44:45], v[44:45], v[36:37], s[82:83] op_sel:[0,0,1] op_sel_hi:[1,1,1]
  v_pk_fma_f32 v[46:47], v[46:47], v[38:39], s[82:83] op_sel:[0,0,1] op_sel_hi:[1,1,1]
  v_pk_fma_f32 v[40:41], v[40:41], v[32:33], s[82:83] op_sel:[0,0,0] op_sel_hi:[1,1,0]
  v_pk_fma_f32 v[42:43], v[42:43], v[34:35], s[82:83] op_sel:[0,0,0] op_sel_hi:[1,1,0]
  v_pk_fma_f32 v[44:45], v[44:45], v[36:37], s[82:83] op_sel:[0,0,0] op_sel_hi:[1,1,0]
  v_pk_fma_f32 v[46:47], v[46:47], v[38:39], s[82:83] op_sel:[0,0,0] op_sel_hi:[1,1,0]
  v_pk_fma_f32 v[40:41], v[40:41], v[32:33], s[80:81] op_sel:[0,0,1] op_sel_hi:[1,1,1]
  v_pk_fma_f32 v[42:43], v[42:43], v[34:35], s[80:81] op_sel:[0,0,1] op_sel_hi:[1,1,1]
  v_pk_fma_f32 v[44:45], v[44:45], v[36:37], s[80:81] op_sel:[0,0,1] op_sel_hi:[1,1,1]
  v_pk_fma_f32 v[46:47], v[46:47], v[38:39], s[80:81] op_sel:[0,0,1] op_sel_hi:[1,1,1]
  v_pk_fma_f32 v[40:41], v[40:41], v[160:161], s[80:81] op_sel_hi:[1,1,0] clamp
  v_pk_fma_f32 v[42:43], v[42:43], v[162:163], s[80:81] op_sel_hi:[1,1,0] clamp
  v_pk_fma_f32 v[44:45], v[44:45], v[168:169], s[80:81] op_sel_hi:[1,1,0] clamp
  v_pk_fma_f32 v[46:47], v[46:47], v[170:171], s[80:81] op_sel_hi:[1,1,0] clamp
  v_pk_mul_f32 v[32:33], v[40:41], v[160:161]
  v_pk_mul_f32 v[34:35], v[42:43], v[162:163]
  v_pk_mul_f32 v[36:37], v[44:45], v[168:169]
  v_pk_mul_f32 v[38:39], v[46:47], v[170:171]
  v_cvt_pk_bf16_f32 v48, v32, v33
  v_cvt_pk_bf16_f32 v49, v34, v35
  v_cvt_pk_bf16_f32 v50, v36, v37
  v_cvt_pk_bf16_f32 v51, v38, v39
  buffer_store_dwordx4 v[48:51], v5, s[12:15], s33 offen sc1
  v_pk_fma_f32 v[164:165], v[136:137], v[116:117], v[164:165] op_sel:[0,0,0] op_sel_hi:[1,0,1]
  v_pk_fma_f32 v[166:167], v[138:139], v[116:117], v[166:167] op_sel:[0,0,0] op_sel_hi:[1,0,1]
  v_pk_fma_f32 v[172:173], v[140:141], v[116:117], v[172:173] op_sel:[0,0,0] op_sel_hi:[1,0,1]
  v_pk_fma_f32 v[174:175], v[142:143], v[116:117], v[174:175] op_sel:[0,0,0] op_sel_hi:[1,0,1]
  v_pk_mul_f32 v[164:165], v[164:165], v[124:125] op_sel:[0,1] op_sel_hi:[1,1]
  v_pk_mul_f32 v[166:167], v[166:167], v[124:125] op_sel:[0,1] op_sel_hi:[1,1]
  v_pk_mul_f32 v[172:173], v[172:173], v[124:125] op_sel:[0,1] op_sel_hi:[1,1]
  v_pk_mul_f32 v[174:175], v[174:175], v[124:125] op_sel:[0,1] op_sel_hi:[1,1]
  v_pk_mul_f32 v[32:33], v[164:165], v[164:165]
  v_pk_mul_f32 v[34:35], v[166:167], v[166:167]
  v_pk_mul_f32 v[36:37], v[172:173], v[172:173]
  v_pk_mul_f32 v[38:39], v[174:175], v[174:175]
  v_pk_fma_f32 v[40:41], v[32:33], s[86:87], s[86:87] op_sel:[0,1,0] op_sel_hi:[1,1,0]
  v_pk_fma_f32 v[42:43], v[34:35], s[86:87], s[86:87] op_sel:[0,1,0] op_sel_hi:[1,1,0]
  v_pk_fma_f32 v[44:45], v[36:37], s[86:87], s[86:87] op_sel:[0,1,0] op_sel_hi:[1,1,0]
  v_pk_fma_f32 v[46:47], v[38:39], s[86:87], s[86:87] op_sel:[0,1,0] op_sel_hi:[1,1,0]
  v_pk_fma_f32 v[40:41], v[40:41], v[32:33], s[84:85] op_sel:[0,0,1] op_sel_hi:[1,1,1]
  v_pk_fma_f32 v[42:43], v[42:43], v[34:35], s[84:85] op_sel:[0,0,1] op_sel_hi:[1,1,1]
  v_pk_fma_f32 v[44:45], v[44:45], v[36:37], s[84:85] op_sel:[0,0,1] op_sel_hi:[1,1,1]
  v_pk_fma_f32 v[46:47], v[46:47], v[38:39], s[84:85] op_sel:[0,0,1] op_sel_hi:[1,1,1]
  v_pk_fma_f32 v[40:41], v[40:41], v[32:33], s[84:85] op_sel:[0,0,0] op_sel_hi:[1,1,0]
  v_pk_fma_f32 v[42:43], v[42:43], v[34:35], s[84:85] op_sel:[0,0,0] op_sel_hi:[1,1,0]
  v_pk_fma_f32 v[44:45], v[44:45], v[36:37], s[84:85] op_sel:[0,0,0] op_sel_hi:[1,1,0]
  v_pk_fma_f32 v[46:47], v[46:47], v[38:39], s[84:85] op_sel:[0,0,0] op_sel_hi:[1,1,0]
  v_pk_fma_f32 v[40:41], v[40:41], v[32:33], s[82:83] op_sel:[0,0,1] op_sel_hi:[1,1,1]
  v_pk_fma_f32 v[42:43], v[42:43], v[34:35], s[82:83] op_sel:[0,0,1] op_sel_hi:[1,1,1]
  v_pk_fma_f32 v[44:45], v[44:45], v[36:37], s[82:83] op_sel:[0,0,1] op_sel_hi:[1,1,1]
  v_pk_fma_f32 v[46:47], v[46:47], v[38:39], s[82:83] op_sel:[0,0,1] op_sel_hi:[1,1,1]
  v_pk_fma_f32 v[40:41], v[40:41], v[32:33], s[82:83] op_sel:[0,0,0] op_sel_hi:[1,1,0]
  v_pk_fma_f32 v[42:43], v[42:43], v[34:35], s[82:83] op_sel:[0,0,0] op_sel_hi:[1,1,0]
  v_pk_fma_f32 v[44:45], v[44:45], v[36:37], s[82:83] op_sel:[0,0,0] op_sel_hi:[1,1,0]
  v_pk_fma_f32 v[46:47], v[46:47], v[38:39], s[82:83] op_sel:[0,0,0] op_sel_hi:[1,1,0]
  v_pk_fma_f32 v[40:41], v[40:41], v[32:33], s[80:81] op_sel:[0,0,1] op_sel_hi:[1,1,1]
  v_pk_fma_f32 v[42:43], v[42:43], v[34:35], s[80:81] op_sel:[0,0,1] op_sel_hi:[1,1,1]
  v_pk_fma_f32 v[44:45], v[44:45], v[36:37], s[80:81] op_sel:[0,0,1] op_sel_hi:[1,1,1]
  v_pk_fma_f32 v[46:47], v[46:47], v[38:39], s[80:81] op_sel:[0,0,1] op_sel_hi:[1,1,1]
  v_pk_fma_f32 v[40:41], v[40:41], v[164:165], s[80:81] op_sel_hi:[1,1,0] clamp
  v_pk_fma_f32 v[42:43], v[42:43], v[166:167], s[80:81] op_sel_hi:[1,1,0] clamp
  v_pk_fma_f32 v[44:45], v[44:45], v[172:173], s[80:81] op_sel_hi:[1,1,0] clamp
  v_pk_fma_f32 v[46:47], v[46:47], v[174:175], s[80:81] op_sel_hi:[1,1,0] clamp
  v_pk_mul_f32 v[32:33], v[40:41], v[164:165]
  v_pk_mul_f32 v[34:35], v[42:43], v[166:167]
  v_pk_mul_f32 v[36:37], v[44:45], v[172:173]
  v_pk_mul_f32 v[38:39], v[46:47], v[174:175]
  v_cvt_pk_bf16_f32 v52, v32, v33
  v_cvt_pk_bf16_f32 v53, v34, v35
  v_cvt_pk_bf16_f32 v54, v36, v37
  v_cvt_pk_bf16_f32 v55, v38, v39
  buffer_store_dwordx4 v[52:55], v5, s[12:15], s27 offen sc1
  v_mul_f32 v114, -v114, v115
  v_lshlrev_b32 v224, 16, v240
  v_and_b32 v225, 0xffff0000, v240
  v_pk_fma_f32 v[224:225], v[224:225], v[114:115], v[114:115] op_sel:[0,1,0] op_sel_hi:[1,1,0]
  v_lshlrev_b32 v226, 16, v241
  v_and_b32 v227, 0xffff0000, v241
  v_pk_fma_f32 v[226:227], v[226:227], v[114:115], v[114:115] op_sel:[0,1,0] op_sel_hi:[1,1,0]
  v_lshlrev_b32 v232, 16, v242
  v_and_b32 v233, 0xffff0000, v242
  v_pk_fma_f32 v[232:233], v[232:233], v[114:115], v[114:115] op_sel:[0,1,0] op_sel_hi:[1,1,0]
  v_lshlrev_b32 v234, 16, v243
  v_and_b32 v235, 0xffff0000, v243
  v_pk_fma_f32 v[234:235], v[234:235], v[114:115], v[114:115] op_sel:[0,1,0] op_sel_hi:[1,1,0]
  v_mul_f32 v118, -v118, v119
  v_lshlrev_b32 v228, 16, v244
  v_and_b32 v229, 0xffff0000, v244
  v_pk_fma_f32 v[228:229], v[228:229], v[118:119], v[118:119] op_sel:[0,1,0] op_sel_hi:[1,1,0]
  v_lshlrev_b32 v230, 16, v245
  v_and_b32 v231, 0xffff0000, v245
  v_pk_fma_f32 v[230:231], v[230:231], v[118:119], v[118:119] op_sel:[0,1,0] op_sel_hi:[1,1,0]
  v_lshlrev_b32 v236, 16, v246
  v_and_b32 v237, 0xffff0000, v246
  v_pk_fma_f32 v[236:237], v[236:237], v[118:119], v[118:119] op_sel:[0,1,0] op_sel_hi:[1,1,0]
  v_lshlrev_b32 v238, 16, v247
  v_and_b32 v239, 0xffff0000, v247
  v_pk_fma_f32 v[238:239], v[238:239], v[118:119], v[118:119] op_sel:[0,1,0] op_sel_hi:[1,1,0]
  s_lshl_b32 s31, s23, 2
  v_mov_b32 v1, 14041088
  v_mov_b32 v3, 14057472
  v_mov_b32 v2, s93
  s_mov_b64 exec, 1
  s_waitcnt vmcnt(0)
  buffer_store_dword v2, v1, s[12:15], s23 offen
  buffer_store_dword v2, v3, s[12:15], s31 offen sc1
  s_mov_b64 exec, -1
  s_xor_b32 s18, s5, 0
  s_xor_b32 s18, s18, 2
  s_lshr_b32 s24, s18, 1
  s_and_b32 s18, s18, 1
  s_lshl_b32 s24, s24, 17
  s_lshl_b32 s18, s18, 14
  s_add_u32 s18, s18, s24
  v_add_u32 v12, s18, v5
  s_mov_b32 s27, s18
  s_xor_b32 s18, s5, 1
  s_xor_b32 s18, s18, 2
  s_lshr_b32 s24, s18, 1
  s_and_b32 s18, s18, 1
  s_lshl_b32 s24, s24, 17
  s_lshl_b32 s18, s18, 14
  s_add_u32 s18, s18, s24
  v_add_u32 v13, s18, v5
  s_xor_b32 s18, s5, 2
  s_xor_b32 s18, s18, 2
  s_lshr_b32 s24, s18, 1
  s_and_b32 s18, s18, 1
  s_lshl_b32 s24, s24, 17
  s_lshl_b32 s18, s18, 14
  s_add_u32 s18, s18, s24
  v_add_u32 v14, s18, v5
  s_xor_b32 s18, s5, 3
  s_xor_b32 s18, s18, 2
  s_lshr_b32 s24, s18, 1
  s_and_b32 s18, s18, 1
  s_lshl_b32 s24, s24, 17
  s_lshl_b32 s18, s18, 14
  s_add_u32 s18, s18, s24
  v_add_u32 v15, s18, v5
  s_lshl_b32 s24, s21, 1
  v_lshrrev_b32 v1, 2, v0
  v_lshlrev_b32 v1, 7, v1
  v_and_b32 v2, 3, v0
  v_lshl_add_u32 v1, v2, 3, v1
  v_bfe_u32 v2, v0, 3, 2
  v_xor_b32 v2, s24, v2
  v_add_u32 v1, s27, v1
  v_lshl_add_u32 v8, v2, 5, v1
  v_xor_b32 v9, 32, v8
  v_xor_b32 v10, 64, v8
  v_xor_b32 v11, 96, v8
  s_lshl_b32 s18, s19, 2
  s_lshl_b32 s24, s22, 1
  s_add_u32 s18, s18, s24
  s_mul_i32 s40, s18, 16384
  s_xor_b32 s18, s18, 2
  s_mul_i32 s42, s18, 16384
  s_mul_i32 s18, s5, 4096
  s_add_u32 s18, s18, 2080768
  s_add_u32 s40, s40, s18
  s_add_u32 s42, s42, s18
  s_add_u32 s41, s40, 16384
  s_add_u32 s43, s42, 16384
  s_lshr_b32 s24, s5, 1
  s_add_u32 s24, s24, 1
  s_sub_u32 s18, 0, s24
  s_bitcmp1_b32 s5, 0
  s_cselect_b32 s24, s24, s18
  s_add_u32 s18, s24, 16
  v_add_u32 v1, s18, v7
  v_lshrrev_b32 v2, 4, v1
  v_and_b32 v1, 15, v1
  v_lshlrev_b32 v2, 14, v2
  v_lshl_add_u32 v2, v1, 4, v2
  v_lshl_add_u32 v2, v4, 8, v2
  v_bfrev_b32 v3, -2
  s_add_u32 s24, s24, s29

  v_add_u32 v1, s24, v7
  v_add_u32 v1, 0, v1
  v_cmp_gt_u32 vcc, 2048, v1
  s_nop 1
  v_cndmask_b32 v24, v3, v2, vcc

  v_add_u32 v1, s24, v7
  v_add_u32 v1, 16, v1
  v_cmp_gt_u32 vcc, 2048, v1
  s_nop 1
  v_cndmask_b32 v25, v3, v2, vcc
  s_xor_b32 s18, s29, 32
  s_sub_u32 s18, s18, s29
  s_add_u32 s18, s18, s24
  v_add_u32 v1, s18, v7
  v_add_u32 v1, 0, v1
  v_cmp_gt_u32 vcc, 2048, v1
  s_nop 1
  v_cndmask_b32 v26, v3, v2, vcc

  v_add_u32 v1, s18, v7
  v_add_u32 v1, 16, v1
  v_cmp_gt_u32 vcc, 2048, v1
  s_nop 1
  v_cndmask_b32 v27, v3, v2, vcc
  ds_read_b64_tr_b16 v[32:33], v8 offset:0
  ds_read_b64_tr_b16 v[34:35], v8 offset:2048
  ds_read_b64_tr_b16 v[36:37], v9 offset:0
  ds_read_b64_tr_b16 v[38:39], v9 offset:2048
  ds_read_b64_tr_b16 v[40:41], v10 offset:0
  ds_read_b64_tr_b16 v[42:43], v10 offset:2048
  ds_read_b64_tr_b16 v[44:45], v11 offset:0
  ds_read_b64_tr_b16 v[46:47], v11 offset:2048
  v_lshrrev_b32 v1, 2, v0
  v_lshlrev_b32 v1, 4, v1
  s_bitcmp1_b32 s5, 0
  s_cselect_b32 s18, 32, -16
  v_mov_b32 v2, s18
  v_cmp_lt_u32 vcc, 7, v0
  s_nop 1
  v_cndmask_b32 v1, v1, v2, vcc
  v_and_b32 v2, 3, v0
  s_lshl_b32 s18, s19, 5
  s_lshl_b32 s24, s5, 2
  s_add_u32 s18, s18, s24
  v_add3_u32 v1, v1, v2, s18
  v_and_b32 v1, 1023, v1
  s_and_b32 s18, s5, 1
  s_mul_i32 s18, s18, 3
  s_and_b32 s24, s19, 3
  s_mov_b32 s45, 0
  s_cmp_eq_u32 s18, s24
  s_cselect_b32 s44, 0xf00, 0
  v_lshlrev_b32 v2, 4, v1
  v_add_u32 v2, 14057472, v2
  v_lshlrev_b32 v1, 2, v1
  v_add_u32 v1, 14041088, v1
  s_cmp_eq_u32 s1, 0
  s_cselect_b64 vcc, s[44:45], -1
  v_cndmask_b32 v1, v1, v2, vcc
  s_mov_b32 exec_lo, 0xfff
  s_mov_b32 exec_hi, 0
  s_mov_b32 s30, 0
L_poll_21:
  buffer_load_dword v100, v1, s[12:15], 0 offen sc1
  s_add_u32 s30, s30, 1
  s_waitcnt vmcnt(0)
  v_cmp_ne_u32 vcc, s93, v100
  s_cbranch_vccz L_polld_22
  s_cmp_lt_u32 s30, 100000
  s_cbranch_scc1 L_poll_21
L_polld_22:
  s_mov_b64 exec, -1
  buffer_load_dwordx4 v[64:67], v24, s[12:15], s40 offen offset:0
  buffer_load_dwordx4 v[68:71], v25, s[12:15], s41 offen offset:0
  buffer_load_dwordx4 v[72:75], v26, s[12:15], s42 offen offset:0
  buffer_load_dwordx4 v[76:79], v27, s[12:15], s43 offen offset:0
  buffer_load_dwordx4 v[80:83], v24, s[12:15], s40 offen offset:1024
  buffer_load_dwordx4 v[84:87], v25, s[12:15], s41 offen offset:1024
  buffer_load_dwordx4 v[88:91], v26, s[12:15], s42 offen offset:1024
  buffer_load_dwordx4 v[92:95], v27, s[12:15], s43 offen offset:1024
  buffer_load_dwordx4 v[96:99], v24, s[12:15], s40 offen offset:2048
  buffer_load_dwordx4 v[100:103], v25, s[12:15], s41 offen offset:2048
  buffer_load_dwordx4 v[104:107], v26, s[12:15], s42 offen offset:2048
  buffer_load_dwordx4 v[108:111], v27, s[12:15], s43 offen offset:2048
  buffer_load_dwordx4 v[112:115], v24, s[12:15], s40 offen offset:3072
  buffer_load_dwordx4 v[116:119], v25, s[12:15], s41 offen offset:3072
  buffer_load_dwordx4 v[120:123], v26, s[12:15], s42 offen offset:3072
  buffer_load_dwordx4 v[124:127], v27, s[12:15], s43 offen offset:3072
  s_barrier
  s_waitcnt lgkmcnt(0)
  s_waitcnt vmcnt(15)
  v_mfma_f32_16x16x32_bf16 v[160:163], v[32:35], v[64:67], v[224:227]
  ds_read_b64_tr_b16 v[48:49], v8 offset:4096
  v_mfma_f32_16x16x32_bf16 v[168:171], v[36:39], v[64:67], v[232:235]
  ds_read_b64_tr_b16 v[50:51], v8 offset:6144
  v_mfma_f32_16x16x32_bf16 v[176:179], v[40:43], v[64:67], 0
  ds_read_b64_tr_b16 v[52:53], v9 offset:4096
  v_mfma_f32_16x16x32_bf16 v[184:187], v[44:47], v[64:67], 0
  ds_read_b64_tr_b16 v[54:55], v9 offset:6144
  s_waitcnt vmcnt(14)
  v_mfma_f32_16x16x32_bf16 v[164:167], v[32:35], v[68:71], v[228:231]
  ds_read_b64_tr_b16 v[56:57], v10 offset:4096
  v_mfma_f32_16x16x32_bf16 v[172:175], v[36:39], v[68:71], v[236:239]
  ds_read_b64_tr_b16 v[58:59], v10 offset:6144
  v_mfma_f32_16x16x32_bf16 v[180:183], v[40:43], v[68:71], 0
  ds_read_b64_tr_b16 v[60:61], v11 offset:4096
  v_mfma_f32_16x16x32_bf16 v[188:191], v[44:47], v[68:71], 0
  ds_read_b64_tr_b16 v[62:63], v11 offset:6144
  s_waitcnt vmcnt(13)
  v_mfma_f32_16x16x32_bf16 v[192:195], v[32:35], v[72:75], 0
  v_mfma_f32_16x16x32_bf16 v[200:203], v[36:39], v[72:75], 0
  v_mfma_f32_16x16x32_bf16 v[208:211], v[40:43], v[72:75], 0
  v_mfma_f32_16x16x32_bf16 v[216:219], v[44:47], v[72:75], 0
  s_waitcnt vmcnt(12)
  v_mfma_f32_16x16x32_bf16 v[196:199], v[32:35], v[76:79], 0
  v_mfma_f32_16x16x32_bf16 v[204:207], v[36:39], v[76:79], 0
  v_mfma_f32_16x16x32_bf16 v[212:215], v[40:43], v[76:79], 0
  v_mfma_f32_16x16x32_bf16 v[220:223], v[44:47], v[76:79], 0
  s_waitcnt lgkmcnt(0)
  s_waitcnt vmcnt(11)
  v_mfma_f32_16x16x32_bf16 v[160:163], v[48:51], v[80:83], v[160:163]
  ds_read_b64_tr_b16 v[32:33], v8 offset:8192
  v_mfma_f32_16x16x32_bf16 v[168:171], v[52:55], v[80:83], v[168:171]
  ds_read_b64_tr_b16 v[34:35], v8 offset:10240
  v_mfma_f32_16x16x32_bf16 v[176:179], v[56:59], v[80:83], v[176:179]
  ds_read_b64_tr_b16 v[36:37], v9 offset:8192
  v_mfma_f32_16x16x32_bf16 v[184:187], v[60:63], v[80:83], v[184:187]
  ds_read_b64_tr_b16 v[38:39], v9 offset:10240
  s_waitcnt vmcnt(10)
  v_mfma_f32_16x16x32_bf16 v[164:167], v[48:51], v[84:87], v[164:167]
  ds_read_b64_tr_b16 v[40:41], v10 offset:8192
  v_mfma_f32_16x16x32_bf16 v[172:175], v[52:55], v[84:87], v[172:175]
  ds_read_b64_tr_b16 v[42:43], v10 offset:10240
  v_mfma_f32_16x16x32_bf16 v[180:183], v[56:59], v[84:87], v[180:183]
  ds_read_b64_tr_b16 v[44:45], v11 offset:8192
  v_mfma_f32_16x16x32_bf16 v[188:191], v[60:63], v[84:87], v[188:191]
  ds_read_b64_tr_b16 v[46:47], v11 offset:10240
  s_waitcnt vmcnt(9)
  v_mfma_f32_16x16x32_bf16 v[192:195], v[48:51], v[88:91], v[192:195]
  v_mfma_f32_16x16x32_bf16 v[200:203], v[52:55], v[88:91], v[200:203]
  v_mfma_f32_16x16x32_bf16 v[208:211], v[56:59], v[88:91], v[208:211]
  v_mfma_f32_16x16x32_bf16 v[216:219], v[60:63], v[88:91], v[216:219]
  s_waitcnt vmcnt(8)
  v_mfma_f32_16x16x32_bf16 v[196:199], v[48:51], v[92:95], v[196:199]
  v_mfma_f32_16x16x32_bf16 v[204:207], v[52:55], v[92:95], v[204:207]
  v_mfma_f32_16x16x32_bf16 v[212:215], v[56:59], v[92:95], v[212:215]
  v_mfma_f32_16x16x32_bf16 v[220:223], v[60:63], v[92:95], v[220:223]
  s_waitcnt lgkmcnt(0)
  s_waitcnt vmcnt(7)
  v_mfma_f32_16x16x32_bf16 v[160:163], v[32:35], v[96:99], v[160:163]
  ds_read_b64_tr_b16 v[48:49], v8 offset:12288
  v_mfma_f32_16x16x32_bf16 v[168:171], v[36:39], v[96:99], v[168:171]
  ds_read_b64_tr_b16 v[50:51], v8 offset:14336
  v_mfma_f32_16x16x32_bf16 v[176:179], v[40:43], v[96:99], v[176:179]
  ds_read_b64_tr_b16 v[52:53], v9 offset:12288
  v_mfma_f32_16x16x32_bf16 v[184:187], v[44:47], v[96:99], v[184:187]
  ds_read_b64_tr_b16 v[54:55], v9 offset:14336
  s_waitcnt vmcnt(6)
  v_mfma_f32_16x16x32_bf16 v[164:167], v[32:35], v[100:103], v[164:167]
  ds_read_b64_tr_b16 v[56:57], v10 offset:12288
  v_mfma_f32_16x16x32_bf16 v[172:175], v[36:39], v[100:103], v[172:175]
  ds_read_b64_tr_b16 v[58:59], v10 offset:14336
  v_mfma_f32_16x16x32_bf16 v[180:183], v[40:43], v[100:103], v[180:183]
  ds_read_b64_tr_b16 v[60:61], v11 offset:12288
  v_mfma_f32_16x16x32_bf16 v[188:191], v[44:47], v[100:103], v[188:191]
  ds_read_b64_tr_b16 v[62:63], v11 offset:14336
  s_waitcnt vmcnt(5)
  v_mfma_f32_16x16x32_bf16 v[192:195], v[32:35], v[104:107], v[192:195]
  v_mfma_f32_16x16x32_bf16 v[200:203], v[36:39], v[104:107], v[200:203]
  v_mfma_f32_16x16x32_bf16 v[208:211], v[40:43], v[104:107], v[208:211]
  v_mfma_f32_16x16x32_bf16 v[216:219], v[44:47], v[104:107], v[216:219]
  s_waitcnt vmcnt(4)
  v_mfma_f32_16x16x32_bf16 v[196:199], v[32:35], v[108:111], v[196:199]
  v_mfma_f32_16x16x32_bf16 v[204:207], v[36:39], v[108:111], v[204:207]
  v_mfma_f32_16x16x32_bf16 v[212:215], v[40:43], v[108:111], v[212:215]
  v_mfma_f32_16x16x32_bf16 v[220:223], v[44:47], v[108:111], v[220:223]
  s_waitcnt lgkmcnt(0)
  s_waitcnt vmcnt(3)
  v_mfma_f32_16x16x32_bf16 v[160:163], v[48:51], v[112:115], v[160:163]
  v_mfma_f32_16x16x32_bf16 v[168:171], v[52:55], v[112:115], v[168:171]
  v_mfma_f32_16x16x32_bf16 v[176:179], v[56:59], v[112:115], v[176:179]
  v_mfma_f32_16x16x32_bf16 v[184:187], v[60:63], v[112:115], v[184:187]
  s_waitcnt vmcnt(2)
  v_mfma_f32_16x16x32_bf16 v[164:167], v[48:51], v[116:119], v[164:167]
  v_mfma_f32_16x16x32_bf16 v[172:175], v[52:55], v[116:119], v[172:175]
  v_mfma_f32_16x16x32_bf16 v[180:183], v[56:59], v[116:119], v[180:183]
  v_mfma_f32_16x16x32_bf16 v[188:191], v[60:63], v[116:119], v[188:191]
  s_waitcnt vmcnt(1)
  v_mfma_f32_16x16x32_bf16 v[192:195], v[48:51], v[120:123], v[192:195]
  v_mfma_f32_16x16x32_bf16 v[200:203], v[52:55], v[120:123], v[200:203]
  v_mfma_f32_16x16x32_bf16 v[208:211], v[56:59], v[120:123], v[208:211]
  v_mfma_f32_16x16x32_bf16 v[216:219], v[60:63], v[120:123], v[216:219]
  s_waitcnt vmcnt(0)
  v_mfma_f32_16x16x32_bf16 v[196:199], v[48:51], v[124:127], v[196:199]
  v_mfma_f32_16x16x32_bf16 v[204:207], v[52:55], v[124:127], v[204:207]
  v_mfma_f32_16x16x32_bf16 v[212:215], v[56:59], v[124:127], v[212:215]
  v_mfma_f32_16x16x32_bf16 v[220:223], v[60:63], v[124:127], v[220:223]
  ds_write_b128 v12, v[176:179] offset:0
  ds_write_b128 v12, v[180:183] offset:1024
  ds_write_b128 v12, v[184:187] offset:2048
  ds_write_b128 v12, v[188:191] offset:3072
  ds_write_b128 v12, v[192:195] offset:4096
  ds_write_b128 v12, v[196:199] offset:5120
  ds_write_b128 v12, v[200:203] offset:6144
  ds_write_b128 v12, v[204:207] offset:7168
  ds_write_b128 v12, v[208:211] offset:8192
  ds_write_b128 v12, v[212:215] offset:9216
  ds_write_b128 v12, v[216:219] offset:10240
  ds_write_b128 v12, v[220:223] offset:11264
  s_waitcnt lgkmcnt(0)
  s_barrier
  ds_read_b128 v[64:67], v13 offset:0
  ds_read_b128 v[68:71], v13 offset:1024
  ds_read_b128 v[72:75], v13 offset:2048
  ds_read_b128 v[76:79], v13 offset:3072
  ds_read_b128 v[80:83], v14 offset:4096
  ds_read_b128 v[84:87], v14 offset:5120
  ds_read_b128 v[88:91], v14 offset:6144
  ds_read_b128 v[92:95], v14 offset:7168
  ds_read_b128 v[96:99], v15 offset:8192
  ds_read_b128 v[100:103], v15 offset:9216
  ds_read_b128 v[104:107], v15 offset:10240
  ds_read_b128 v[108:111], v15 offset:11264
  s_waitcnt lgkmcnt(11)
  v_pk_add_f32 v[160:161], v[160:161], v[64:65]
  v_pk_add_f32 v[162:163], v[162:163], v[66:67]
  s_waitcnt lgkmcnt(10)
  v_pk_add_f32 v[164:165], v[164:165], v[68:69]
  v_pk_add_f32 v[166:167], v[166:167], v[70:71]
  s_waitcnt lgkmcnt(9)
  v_pk_add_f32 v[168:169], v[168:169], v[72:73]
  v_pk_add_f32 v[170:171], v[170:171], v[74:75]
  s_waitcnt lgkmcnt(8)
  v_pk_add_f32 v[172:173], v[172:173], v[76:77]
  v_pk_add_f32 v[174:175], v[174:175], v[78:79]
  s_waitcnt lgkmcnt(7)
  v_pk_add_f32 v[160:161], v[160:161], v[80:81]
  v_pk_add_f32 v[162:163], v[162:163], v[82:83]
  s_waitcnt lgkmcnt(6)
  v_pk_add_f32 v[164:165], v[164:165], v[84:85]
  v_pk_add_f32 v[166:167], v[166:167], v[86:87]
  s_waitcnt lgkmcnt(5)
  v_pk_add_f32 v[168:169], v[168:169], v[88:89]
  v_pk_add_f32 v[170:171], v[170:171], v[90:91]
  s_waitcnt lgkmcnt(4)
  v_pk_add_f32 v[172:173], v[172:173], v[92:93]
  v_pk_add_f32 v[174:175], v[174:175], v[94:95]
  s_waitcnt lgkmcnt(3)
  v_pk_add_f32 v[160:161], v[160:161], v[96:97]
  v_pk_add_f32 v[162:163], v[162:163], v[98:99]
  s_waitcnt lgkmcnt(2)
  v_pk_add_f32 v[164:165], v[164:165], v[100:101]
  v_pk_add_f32 v[166:167], v[166:167], v[102:103]
  s_waitcnt lgkmcnt(1)
  v_pk_add_f32 v[168:169], v[168:169], v[104:105]
  v_pk_add_f32 v[170:171], v[170:171], v[106:107]
  s_waitcnt lgkmcnt(0)
  v_pk_add_f32 v[172:173], v[172:173], v[108:109]
  v_pk_add_f32 v[174:175], v[174:175], v[110:111]
  s_add_u32 s24, s16, 4194304
  s_add_u32 s27, s16, 4210688
  v_cvt_pk_bf16_f32 v48, v160, v161
  v_cvt_pk_bf16_f32 v49, v162, v163
  v_cvt_pk_bf16_f32 v50, v168, v169
  v_cvt_pk_bf16_f32 v51, v170, v171
  buffer_store_dwordx4 v[48:51], v5, s[12:15], s24 offen sc1
  v_cvt_pk_bf16_f32 v52, v164, v165
  v_cvt_pk_bf16_f32 v53, v166, v167
  v_cvt_pk_bf16_f32 v54, v172, v173
  v_cvt_pk_bf16_f32 v55, v174, v175
  buffer_store_dwordx4 v[52:55], v5, s[12:15], s27 offen sc1
  v_pk_add_f32 v[40:41], v[160:161], v[162:163]
  v_pk_mul_f32 v[42:43], v[160:161], v[160:161]
  v_pk_add_f32 v[40:41], v[40:41], v[168:169]
  v_pk_fma_f32 v[42:43], v[162:163], v[162:163], v[42:43]
  v_pk_add_f32 v[40:41], v[40:41], v[170:171]
  v_pk_fma_f32 v[42:43], v[168:169], v[168:169], v[42:43]
  v_add_f32 v40, v40, v41
  v_pk_fma_f32 v[42:43], v[170:171], v[170:171], v[42:43]
  v_add_f32 v42, v42, v43
  v_pk_add_f32 v[44:45], v[164:165], v[166:167]
  v_pk_mul_f32 v[46:47], v[164:165], v[164:165]
  v_pk_add_f32 v[44:45], v[44:45], v[172:173]
  v_pk_fma_f32 v[46:47], v[166:167], v[166:167], v[46:47]
  v_pk_add_f32 v[44:45], v[44:45], v[174:175]
  v_pk_fma_f32 v[46:47], v[172:173], v[172:173], v[46:47]
  v_add_f32 v44, v44, v45
  v_pk_fma_f32 v[46:47], v[174:175], v[174:175], v[46:47]
  v_add_f32 v46, v46, v47
  v_permlane32_swap_b32 v40, v42
  s_nop 0
  v_permlane32_swap_b32 v44, v46
  v_add_f32 v40, v40, v42
  v_add_f32 v44, v44, v46
  s_nop 1
  v_permlane16_swap_b32 v40, v44
  v_add_f32 v40, v40, v44
  v_and_b32 v1, 31, v0
  v_lshlrev_b32 v1, 3, v1
  v_lshrrev_b32 v2, 5, v0
  v_lshl_add_u32 v1, v2, 2, v1
  s_lshl_b32 s24, s29, 7
  s_lshl_b32 s27, s17, 8
  s_add_u32 s24, s24, s27
  s_add_u32 s24, s24, 13631488
  buffer_store_dword v40, v1, s[12:15], s24 offen sc1
  s_barrier
  v_lshlrev_b32 v224, 16, v240
  v_and_b32 v225, 0xffff0000, v240
  v_pk_add_f32 v[224:225], v[224:225], v[160:161]
  v_lshlrev_b32 v226, 16, v241
  v_and_b32 v227, 0xffff0000, v241
  v_pk_add_f32 v[226:227], v[226:227], v[162:163]
  v_lshlrev_b32 v232, 16, v242
  v_and_b32 v233, 0xffff0000, v242
  v_pk_add_f32 v[232:233], v[232:233], v[168:169]
  v_lshlrev_b32 v234, 16, v243
  v_and_b32 v235, 0xffff0000, v243
  v_pk_add_f32 v[234:235], v[234:235], v[170:171]
  v_lshlrev_b32 v228, 16, v244
  v_and_b32 v229, 0xffff0000, v244
  v_pk_add_f32 v[228:229], v[228:229], v[164:165]
  v_lshlrev_b32 v230, 16, v245
  v_and_b32 v231, 0xffff0000, v245
  v_pk_add_f32 v[230:231], v[230:231], v[166:167]
  v_lshlrev_b32 v236, 16, v246
  v_and_b32 v237, 0xffff0000, v246
  v_pk_add_f32 v[236:237], v[236:237], v[172:173]
  v_lshlrev_b32 v238, 16, v247
  v_and_b32 v239, 0xffff0000, v247
  v_pk_add_f32 v[238:239], v[238:239], v[174:175]
  s_cmp_lt_u32 s4, 28
  s_cbranch_scc1 L_c_g3
  s_lshl_b32 s31, s23, 2
  v_mov_b32 v1, 14045184
  v_mov_b32 v3, 14073856
  v_mov_b32 v2, s93
  s_mov_b64 exec, 1
  s_waitcnt vmcnt(0)
  buffer_store_dword v2, v1, s[12:15], s23 offen
  buffer_store_dword v2, v3, s[12:15], s31 offen sc1
  s_mov_b64 exec, -1
  s_waitcnt vmcnt(0)
  s_barrier
  s_mov_b32 s8, s54
  s_and_b32 s9, s55, 0xffff
  s_mov_b32 s10, 0x1c0000
  s_mov_b32 s11, 0x20000
  s_and_b32 s18, s4, 1
  s_lshl_b32 s18, s18, 2
  s_add_u32 s18, s18, s5
  s_lshl_b32 s18, s18, 13
  v_lshlrev_b32 v1, 7, v0
  v_add_u32 v1, s18, v1
  s_sleep 1
  s_bitcmp1_b32 s4, 1
  s_cselect_b32 s18, 12, 5
  s_lshl_b32 s18, s18, 16
  buffer_load_dword v31, v1, s[8:11], s18 offen
  s_bitcmp1_b32 s4, 1
  s_cselect_b32 s18, 26, 19
  s_lshl_b32 s18, s18, 16
  buffer_load_dword v31, v1, s[8:11], s18 offen
  s_bitcmp1_b32 s4, 1
  s_cselect_b32 s18, 13, 6
  s_lshl_b32 s18, s18, 16
  buffer_load_dword v31, v1, s[8:11], s18 offen
  s_bitcmp1_b32 s4, 1
  s_cselect_b32 s18, 27, 20
  s_lshl_b32 s18, s18, 16
  buffer_load_dword v31, v1, s[8:11], s18 offen
  s_branch L_c_g4
L_c_g3:
  s_cmp_ge_u32 s4, 14
  s_cselect_b32 s32, 1, 0
  s_cselect_b32 s33, 14, 0
  s_sub_u32 s33, s4, s33
  s_lshl_b32 s18, s3, 1
  s_add_u32 s32, s32, s18
  s_lshl_b32 s32, s32, 2
  s_add_u32 s32, s32, s5
  v_lshlrev_b32 v3, 3, v7
  v_lshl_add_u32 v3, v4, 10, v3
  s_lshl_b32 s35, s32, 12
  s_add_u32 s35, s35, 13631488
  v_lshrrev_b32 v1, 2, v0
  v_lshlrev_b32 v1, 7, v1
  v_and_b32 v2, 3, v0
  v_lshl_add_u32 v1, v2, 3, v1
  v_bfe_u32 v2, v0, 3, 2
  v_lshl_add_u32 v8, v2, 5, v1
  v_xor_b32 v9, 32, v8
  v_xor_b32 v10, 64, v8
  v_xor_b32 v11, 96, v8
  v_add_u32 v12, 0x10000, v8
  v_add_u32 v13, 0x10000, v9
  v_add_u32 v14, 0x10000, v10
  v_add_u32 v15, 0x10000, v11
  v_add_u32 v16, 0x20000, v8
  v_add_u32 v17, 0x20000, v9
  v_add_u32 v18, 0x20000, v10
  v_add_u32 v19, 0x20000, v11
  v_mov_b32 v20, v3
  s_barrier
  s_lshl_b32 s31, s23, 2
  v_mov_b32 v1, 14045184
  v_mov_b32 v3, 14073856
  v_mov_b32 v2, s93
  s_mov_b64 exec, 1
  s_waitcnt vmcnt(0)
  buffer_store_dword v2, v1, s[12:15], s23 offen
  buffer_store_dword v2, v3, s[12:15], s31 offen sc1
  s_mov_b64 exec, -1
  ds_read_b64_tr_b16 v[32:33], v8 offset:32768
  ds_read_b64_tr_b16 v[34:35], v8 offset:34816
  ds_read_b64_tr_b16 v[36:37], v9 offset:32768
  ds_read_b64_tr_b16 v[38:39], v9 offset:34816
  ds_read_b64_tr_b16 v[40:41], v10 offset:32768
  ds_read_b64_tr_b16 v[42:43], v10 offset:34816
  ds_read_b64_tr_b16 v[44:45], v11 offset:32768
  ds_read_b64_tr_b16 v[46:47], v11 offset:34816
  ds_read_b64_tr_b16 v[48:49], v8 offset:36864
  ds_read_b64_tr_b16 v[50:51], v8 offset:38912
  ds_read_b64_tr_b16 v[52:53], v9 offset:36864
  ds_read_b64_tr_b16 v[54:55], v9 offset:38912
  ds_read_b64_tr_b16 v[56:57], v10 offset:36864
  ds_read_b64_tr_b16 v[58:59], v10 offset:38912
  ds_read_b64_tr_b16 v[60:61], v11 offset:36864
  ds_read_b64_tr_b16 v[62:63], v11 offset:38912
  s_lshl_b32 s24, s32, 4
  v_add_u32 v1, s24, v0
  s_lshl_b32 s40, s32, 15
  s_add_u32 s40, s40, 4194304
  s_add_u32 s41, s40, 16384
  v_lshlrev_b32 v2, 4, v1
  v_add_u32 v2, 14073856, v2
  v_lshlrev_b32 v1, 2, v1
  v_add_u32 v1, 14045184, v1
  s_cmp_eq_u32 s1, 0
  s_cselect_b64 vcc, 0, -1
  v_cndmask_b32 v1, v1, v2, vcc
  s_mov_b32 exec_lo, 0xffff
  s_mov_b32 exec_hi, 0
  s_mov_b32 s30, 0
L_poll_23:
  buffer_load_dword v100, v1, s[12:15], 0 offen sc1
  s_add_u32 s30, s30, 1
  s_waitcnt vmcnt(0)
  v_cmp_ne_u32 vcc, s93, v100
  s_cbranch_vccz L_polld_24
  s_cmp_lt_u32 s30, 100000
  s_cbranch_scc1 L_poll_23
L_polld_24:
  s_mov_b64 exec, -1
  buffer_load_dwordx4 v[96:99], v5, s[12:15], s40 offen offset:0
  buffer_load_dwordx4 v[100:103], v5, s[12:15], s41 offen offset:0
  buffer_load_dwordx4 v[104:107], v5, s[12:15], s40 offen offset:1024
  buffer_load_dwordx4 v[108:111], v5, s[12:15], s41 offen offset:1024
  buffer_load_dwordx4 v[112:115], v5, s[12:15], s40 offen offset:2048
  buffer_load_dwordx4 v[116:119], v5, s[12:15], s41 offen offset:2048
  buffer_load_dwordx4 v[120:123], v5, s[12:15], s40 offen offset:3072
  s_add_u32 s40, s40, 4096
  buffer_load_dwordx4 v[124:127], v5, s[12:15], s41 offen offset:3072
  s_add_u32 s41, s41, 4096
  buffer_load_dwordx4 v[128:131], v5, s[12:15], s40 offen offset:0
  buffer_load_dwordx4 v[132:135], v5, s[12:15], s41 offen offset:0
  buffer_load_dwordx4 v[136:139], v5, s[12:15], s40 offen offset:1024
  buffer_load_dwordx4 v[140:143], v5, s[12:15], s41 offen offset:1024
  buffer_load_dwordx4 v[144:147], v5, s[12:15], s40 offen offset:2048
  buffer_load_dwordx4 v[148:151], v5, s[12:15], s41 offen offset:2048
  buffer_load_dwordx4 v[152:155], v5, s[12:15], s40 offen offset:3072
  s_add_u32 s40, s40, 4096
  buffer_load_dwordx4 v[156:159], v5, s[12:15], s41 offen offset:3072
  s_add_u32 s41, s41, 4096
  buffer_load_dwordx2 v[240:241], v20, s[12:15], s35 offen offset:0
  buffer_load_dwordx2 v[242:243], v20, s[12:15], s35 offen offset:256
  buffer_load_dwordx2 v[244:245], v20, s[12:15], s35 offen offset:512
  buffer_load_dwordx2 v[246:247], v20, s[12:15], s35 offen offset:768
  buffer_load_dwordx2 v[248:249], v20, s[12:15], s35 offen offset:128
  buffer_load_dwordx2 v[250:251], v20, s[12:15], s35 offen offset:384
  buffer_load_dwordx2 v[252:253], v20, s[12:15], s35 offen offset:640
  buffer_load_dwordx2 v[254:255], v20, s[12:15], s35 offen offset:896
  s_waitcnt vmcnt(23)
  s_waitcnt lgkmcnt(14)
  v_mfma_f32_16x16x32_bf16 v[160:163], v[32:35], v[96:99], 0
  ds_read_b64_tr_b16 v[64:65], v8 offset:40960
  s_waitcnt vmcnt(22)
  v_mfma_f32_16x16x32_bf16 v[164:167], v[32:35], v[100:103], 0
  ds_read_b64_tr_b16 v[66:67], v8 offset:43008
  s_waitcnt lgkmcnt(14)
  v_mfma_f32_16x16x32_bf16 v[168:171], v[36:39], v[96:99], 0
  ds_read_b64_tr_b16 v[68:69], v9 offset:40960
  v_mfma_f32_16x16x32_bf16 v[172:175], v[36:39], v[100:103], 0
  ds_read_b64_tr_b16 v[70:71], v9 offset:43008
  s_waitcnt lgkmcnt(14)
  v_mfma_f32_16x16x32_bf16 v[176:179], v[40:43], v[96:99], 0
  ds_read_b64_tr_b16 v[72:73], v10 offset:40960
  v_mfma_f32_16x16x32_bf16 v[180:183], v[40:43], v[100:103], 0
  ds_read_b64_tr_b16 v[74:75], v10 offset:43008
  s_waitcnt lgkmcnt(14)
  v_mfma_f32_16x16x32_bf16 v[184:187], v[44:47], v[96:99], 0
  ds_read_b64_tr_b16 v[76:77], v11 offset:40960
  v_mfma_f32_16x16x32_bf16 v[188:191], v[44:47], v[100:103], 0
  ds_read_b64_tr_b16 v[78:79], v11 offset:43008
  s_waitcnt lgkmcnt(14)
  v_mfma_f32_16x16x32_bf16 v[192:195], v[48:51], v[96:99], 0
  ds_read_b64_tr_b16 v[80:81], v8 offset:45056
  v_mfma_f32_16x16x32_bf16 v[196:199], v[48:51], v[100:103], 0
  ds_read_b64_tr_b16 v[82:83], v8 offset:47104
  s_waitcnt lgkmcnt(14)
  v_mfma_f32_16x16x32_bf16 v[200:203], v[52:55], v[96:99], 0
  ds_read_b64_tr_b16 v[84:85], v9 offset:45056
  v_mfma_f32_16x16x32_bf16 v[204:207], v[52:55], v[100:103], 0
  ds_read_b64_tr_b16 v[86:87], v9 offset:47104
  s_waitcnt lgkmcnt(14)
  v_mfma_f32_16x16x32_bf16 v[208:211], v[56:59], v[96:99], 0
  ds_read_b64_tr_b16 v[88:89], v10 offset:45056
  v_mfma_f32_16x16x32_bf16 v[212:215], v[56:59], v[100:103], 0
  ds_read_b64_tr_b16 v[90:91], v10 offset:47104
  s_waitcnt lgkmcnt(14)
  v_mfma_f32_16x16x32_bf16 v[216:219], v[60:63], v[96:99], 0
  ds_read_b64_tr_b16 v[92:93], v11 offset:45056
  buffer_load_dwordx4 v[96:99], v5, s[12:15], s40 offen offset:0
  v_mfma_f32_16x16x32_bf16 v[220:223], v[60:63], v[100:103], 0
  ds_read_b64_tr_b16 v[94:95], v11 offset:47104
  buffer_load_dwordx4 v[100:103], v5, s[12:15], s41 offen offset:0
  s_waitcnt vmcnt(23)
  s_waitcnt lgkmcnt(14)
  v_mfma_f32_16x16x32_bf16 v[160:163], v[64:67], v[104:107], v[160:163]
  ds_read_b64_tr_b16 v[32:33], v8 offset:49152
  s_waitcnt vmcnt(22)
  v_mfma_f32_16x16x32_bf16 v[164:167], v[64:67], v[108:111], v[164:167]
  ds_read_b64_tr_b16 v[34:35], v8 offset:51200
  s_waitcnt lgkmcnt(14)
  v_mfma_f32_16x16x32_bf16 v[168:171], v[68:71], v[104:107], v[168:171]
  ds_read_b64_tr_b16 v[36:37], v9 offset:49152
  v_mfma_f32_16x16x32_bf16 v[172:175], v[68:71], v[108:111], v[172:175]
  ds_read_b64_tr_b16 v[38:39], v9 offset:51200
  s_waitcnt lgkmcnt(14)
  v_mfma_f32_16x16x32_bf16 v[176:179], v[72:75], v[104:107], v[176:179]
  ds_read_b64_tr_b16 v[40:41], v10 offset:49152
  v_mfma_f32_16x16x32_bf16 v[180:183], v[72:75], v[108:111], v[180:183]
  ds_read_b64_tr_b16 v[42:43], v10 offset:51200
  s_waitcnt lgkmcnt(14)
  v_mfma_f32_16x16x32_bf16 v[184:187], v[76:79], v[104:107], v[184:187]
  ds_read_b64_tr_b16 v[44:45], v11 offset:49152
  v_mfma_f32_16x16x32_bf16 v[188:191], v[76:79], v[108:111], v[188:191]
  ds_read_b64_tr_b16 v[46:47], v11 offset:51200
  s_waitcnt lgkmcnt(14)
  v_mfma_f32_16x16x32_bf16 v[192:195], v[80:83], v[104:107], v[192:195]
  ds_read_b64_tr_b16 v[48:49], v8 offset:53248
  v_mfma_f32_16x16x32_bf16 v[196:199], v[80:83], v[108:111], v[196:199]
  ds_read_b64_tr_b16 v[50:51], v8 offset:55296
  s_waitcnt lgkmcnt(14)
  v_mfma_f32_16x16x32_bf16 v[200:203], v[84:87], v[104:107], v[200:203]
  ds_read_b64_tr_b16 v[52:53], v9 offset:53248
  v_mfma_f32_16x16x32_bf16 v[204:207], v[84:87], v[108:111], v[204:207]
  ds_read_b64_tr_b16 v[54:55], v9 offset:55296
  s_waitcnt lgkmcnt(14)
  v_mfma_f32_16x16x32_bf16 v[208:211], v[88:91], v[104:107], v[208:211]
  ds_read_b64_tr_b16 v[56:57], v10 offset:53248
  v_mfma_f32_16x16x32_bf16 v[212:215], v[88:91], v[108:111], v[212:215]
  ds_read_b64_tr_b16 v[58:59], v10 offset:55296
  s_waitcnt lgkmcnt(14)
  v_mfma_f32_16x16x32_bf16 v[216:219], v[92:95], v[104:107], v[216:219]
  ds_read_b64_tr_b16 v[60:61], v11 offset:53248
  buffer_load_dwordx4 v[104:107], v5, s[12:15], s40 offen offset:1024
  v_mfma_f32_16x16x32_bf16 v[220:223], v[92:95], v[108:111], v[220:223]
  ds_read_b64_tr_b16 v[62:63], v11 offset:55296
  buffer_load_dwordx4 v[108:111], v5, s[12:15], s41 offen offset:1024
  s_waitcnt vmcnt(23)
  s_waitcnt lgkmcnt(14)
  v_mfma_f32_16x16x32_bf16 v[160:163], v[32:35], v[112:115], v[160:163]
  ds_read_b64_tr_b16 v[64:65], v8 offset:57344
  s_waitcnt vmcnt(22)
  v_mfma_f32_16x16x32_bf16 v[164:167], v[32:35], v[116:119], v[164:167]
  ds_read_b64_tr_b16 v[66:67], v8 offset:59392
  s_waitcnt lgkmcnt(14)
  v_mfma_f32_16x16x32_bf16 v[168:171], v[36:39], v[112:115], v[168:171]
  ds_read_b64_tr_b16 v[68:69], v9 offset:57344
  v_mfma_f32_16x16x32_bf16 v[172:175], v[36:39], v[116:119], v[172:175]
  ds_read_b64_tr_b16 v[70:71], v9 offset:59392
  s_waitcnt lgkmcnt(14)
  v_mfma_f32_16x16x32_bf16 v[176:179], v[40:43], v[112:115], v[176:179]
  ds_read_b64_tr_b16 v[72:73], v10 offset:57344
  v_mfma_f32_16x16x32_bf16 v[180:183], v[40:43], v[116:119], v[180:183]
  ds_read_b64_tr_b16 v[74:75], v10 offset:59392
  s_waitcnt lgkmcnt(14)
  v_mfma_f32_16x16x32_bf16 v[184:187], v[44:47], v[112:115], v[184:187]
  ds_read_b64_tr_b16 v[76:77], v11 offset:57344
  v_mfma_f32_16x16x32_bf16 v[188:191], v[44:47], v[116:119], v[188:191]
  ds_read_b64_tr_b16 v[78:79], v11 offset:59392
  s_waitcnt lgkmcnt(14)
  v_mfma_f32_16x16x32_bf16 v[192:195], v[48:51], v[112:115], v[192:195]
  ds_read_b64_tr_b16 v[80:81], v8 offset:61440
  v_mfma_f32_16x16x32_bf16 v[196:199], v[48:51], v[116:119], v[196:199]
  ds_read_b64_tr_b16 v[82:83], v8 offset:63488
  s_waitcnt lgkmcnt(14)
  v_mfma_f32_16x16x32_bf16 v[200:203], v[52:55], v[112:115], v[200:203]
  ds_read_b64_tr_b16 v[84:85], v9 offset:61440
  v_mfma_f32_16x16x32_bf16 v[204:207], v[52:55], v[116:119], v[204:207]
  ds_read_b64_tr_b16 v[86:87], v9 offset:63488
  s_waitcnt lgkmcnt(14)
  v_mfma_f32_16x16x32_bf16 v[208:211], v[56:59], v[112:115], v[208:211]
  ds_read_b64_tr_b16 v[88:89], v10 offset:61440
  v_mfma_f32_16x16x32_bf16 v[212:215], v[56:59], v[116:119], v[212:215]
  ds_read_b64_tr_b16 v[90:91], v10 offset:63488
  s_waitcnt lgkmcnt(14)
  v_mfma_f32_16x16x32_bf16 v[216:219], v[60:63], v[112:115], v[216:219]
  ds_read_b64_tr_b16 v[92:93], v11 offset:61440
  buffer_load_dwordx4 v[112:115], v5, s[12:15], s40 offen offset:2048
  v_mfma_f32_16x16x32_bf16 v[220:223], v[60:63], v[116:119], v[220:223]
  ds_read_b64_tr_b16 v[94:95], v11 offset:63488
  buffer_load_dwordx4 v[116:119], v5, s[12:15], s41 offen offset:2048
  s_waitcnt vmcnt(23)
  s_waitcnt lgkmcnt(14)
  v_mfma_f32_16x16x32_bf16 v[160:163], v[64:67], v[120:123], v[160:163]
  ds_read_b64_tr_b16 v[32:33], v12 offset:0
  s_waitcnt vmcnt(22)
  v_mfma_f32_16x16x32_bf16 v[164:167], v[64:67], v[124:127], v[164:167]
  ds_read_b64_tr_b16 v[34:35], v12 offset:2048
  s_waitcnt lgkmcnt(14)
  v_mfma_f32_16x16x32_bf16 v[168:171], v[68:71], v[120:123], v[168:171]
  ds_read_b64_tr_b16 v[36:37], v13 offset:0
  v_mfma_f32_16x16x32_bf16 v[172:175], v[68:71], v[124:127], v[172:175]
  ds_read_b64_tr_b16 v[38:39], v13 offset:2048
  s_waitcnt lgkmcnt(14)
  v_mfma_f32_16x16x32_bf16 v[176:179], v[72:75], v[120:123], v[176:179]
  ds_read_b64_tr_b16 v[40:41], v14 offset:0
  v_mfma_f32_16x16x32_bf16 v[180:183], v[72:75], v[124:127], v[180:183]
  ds_read_b64_tr_b16 v[42:43], v14 offset:2048
  s_waitcnt lgkmcnt(14)
  v_mfma_f32_16x16x32_bf16 v[184:187], v[76:79], v[120:123], v[184:187]
  ds_read_b64_tr_b16 v[44:45], v15 offset:0
  v_mfma_f32_16x16x32_bf16 v[188:191], v[76:79], v[124:127], v[188:191]
  ds_read_b64_tr_b16 v[46:47], v15 offset:2048
  s_waitcnt lgkmcnt(14)
  v_mfma_f32_16x16x32_bf16 v[192:195], v[80:83], v[120:123], v[192:195]
  ds_read_b64_tr_b16 v[48:49], v12 offset:4096
  v_mfma_f32_16x16x32_bf16 v[196:199], v[80:83], v[124:127], v[196:199]
  ds_read_b64_tr_b16 v[50:51], v12 offset:6144
  s_waitcnt lgkmcnt(14)
  v_mfma_f32_16x16x32_bf16 v[200:203], v[84:87], v[120:123], v[200:203]
  ds_read_b64_tr_b16 v[52:53], v13 offset:4096
  v_mfma_f32_16x16x32_bf16 v[204:207], v[84:87], v[124:127], v[204:207]
  ds_read_b64_tr_b16 v[54:55], v13 offset:6144
  s_waitcnt lgkmcnt(14)
  v_mfma_f32_16x16x32_bf16 v[208:211], v[88:91], v[120:123], v[208:211]
  ds_read_b64_tr_b16 v[56:57], v14 offset:4096
  v_mfma_f32_16x16x32_bf16 v[212:215], v[88:91], v[124:127], v[212:215]
  ds_read_b64_tr_b16 v[58:59], v14 offset:6144
  s_waitcnt lgkmcnt(14)
  v_mfma_f32_16x16x32_bf16 v[216:219], v[92:95], v[120:123], v[216:219]
  ds_read_b64_tr_b16 v[60:61], v15 offset:4096
  buffer_load_dwordx4 v[120:123], v5, s[12:15], s40 offen offset:3072
  s_add_u32 s40, s40, 4096
  v_mfma_f32_16x16x32_bf16 v[220:223], v[92:95], v[124:127], v[220:223]
  ds_read_b64_tr_b16 v[62:63], v15 offset:6144
  buffer_load_dwordx4 v[124:127], v5, s[12:15], s41 offen offset:3072
  s_add_u32 s41, s41, 4096
  s_waitcnt vmcnt(23)
  s_waitcnt lgkmcnt(14)
  v_mfma_f32_16x16x32_bf16 v[160:163], v[32:35], v[128:131], v[160:163]
  ds_read_b64_tr_b16 v[64:65], v12 offset:8192
  s_waitcnt vmcnt(22)
  v_mfma_f32_16x16x32_bf16 v[164:167], v[32:35], v[132:135], v[164:167]
  ds_read_b64_tr_b16 v[66:67], v12 offset:10240
  s_waitcnt lgkmcnt(14)
  v_mfma_f32_16x16x32_bf16 v[168:171], v[36:39], v[128:131], v[168:171]
  ds_read_b64_tr_b16 v[68:69], v13 offset:8192
  v_mfma_f32_16x16x32_bf16 v[172:175], v[36:39], v[132:135], v[172:175]
  ds_read_b64_tr_b16 v[70:71], v13 offset:10240
  s_waitcnt lgkmcnt(14)
  v_mfma_f32_16x16x32_bf16 v[176:179], v[40:43], v[128:131], v[176:179]
  ds_read_b64_tr_b16 v[72:73], v14 offset:8192
  v_mfma_f32_16x16x32_bf16 v[180:183], v[40:43], v[132:135], v[180:183]
  ds_read_b64_tr_b16 v[74:75], v14 offset:10240
  s_waitcnt lgkmcnt(14)
  v_mfma_f32_16x16x32_bf16 v[184:187], v[44:47], v[128:131], v[184:187]
  ds_read_b64_tr_b16 v[76:77], v15 offset:8192
  v_mfma_f32_16x16x32_bf16 v[188:191], v[44:47], v[132:135], v[188:191]
  ds_read_b64_tr_b16 v[78:79], v15 offset:10240
  s_waitcnt lgkmcnt(14)
  v_mfma_f32_16x16x32_bf16 v[192:195], v[48:51], v[128:131], v[192:195]
  ds_read_b64_tr_b16 v[80:81], v12 offset:12288
  v_mfma_f32_16x16x32_bf16 v[196:199], v[48:51], v[132:135], v[196:199]
  ds_read_b64_tr_b16 v[82:83], v12 offset:14336
  s_waitcnt lgkmcnt(14)
  v_mfma_f32_16x16x32_bf16 v[200:203], v[52:55], v[128:131], v[200:203]
  ds_read_b64_tr_b16 v[84:85], v13 offset:12288
  v_mfma_f32_16x16x32_bf16 v[204:207], v[52:55], v[132:135], v[204:207]
  ds_read_b64_tr_b16 v[86:87], v13 offset:14336
  s_waitcnt lgkmcnt(14)
  v_mfma_f32_16x16x32_bf16 v[208:211], v[56:59], v[128:131], v[208:211]
  ds_read_b64_tr_b16 v[88:89], v14 offset:12288
  v_mfma_f32_16x16x32_bf16 v[212:215], v[56:59], v[132:135], v[212:215]
  ds_read_b64_tr_b16 v[90:91], v14 offset:14336
  s_waitcnt lgkmcnt(14)
  v_mfma_f32_16x16x32_bf16 v[216:219], v[60:63], v[128:131], v[216:219]
  ds_read_b64_tr_b16 v[92:93], v15 offset:12288
  buffer_load_dwordx4 v[128:131], v5, s[12:15], s40 offen offset:0
  v_mfma_f32_16x16x32_bf16 v[220:223], v[60:63], v[132:135], v[220:223]
  ds_read_b64_tr_b16 v[94:95], v15 offset:14336
  buffer_load_dwordx4 v[132:135], v5, s[12:15], s41 offen offset:0
  s_waitcnt vmcnt(23)
  s_waitcnt lgkmcnt(14)
  v_mfma_f32_16x16x32_bf16 v[160:163], v[64:67], v[136:139], v[160:163]
  ds_read_b64_tr_b16 v[32:33], v12 offset:16384
  s_waitcnt vmcnt(22)
  v_mfma_f32_16x16x32_bf16 v[164:167], v[64:67], v[140:143], v[164:167]
  ds_read_b64_tr_b16 v[34:35], v12 offset:18432
  s_waitcnt lgkmcnt(14)
  v_mfma_f32_16x16x32_bf16 v[168:171], v[68:71], v[136:139], v[168:171]
  ds_read_b64_tr_b16 v[36:37], v13 offset:16384
  v_mfma_f32_16x16x32_bf16 v[172:175], v[68:71], v[140:143], v[172:175]
  ds_read_b64_tr_b16 v[38:39], v13 offset:18432
  s_waitcnt lgkmcnt(14)
  v_mfma_f32_16x16x32_bf16 v[176:179], v[72:75], v[136:139], v[176:179]
  ds_read_b64_tr_b16 v[40:41], v14 offset:16384
  v_mfma_f32_16x16x32_bf16 v[180:183], v[72:75], v[140:143], v[180:183]
  ds_read_b64_tr_b16 v[42:43], v14 offset:18432
  s_waitcnt lgkmcnt(14)
  v_mfma_f32_16x16x32_bf16 v[184:187], v[76:79], v[136:139], v[184:187]
  ds_read_b64_tr_b16 v[44:45], v15 offset:16384
  v_mfma_f32_16x16x32_bf16 v[188:191], v[76:79], v[140:143], v[188:191]
  ds_read_b64_tr_b16 v[46:47], v15 offset:18432
  s_waitcnt lgkmcnt(14)
  v_mfma_f32_16x16x32_bf16 v[192:195], v[80:83], v[136:139], v[192:195]
  ds_read_b64_tr_b16 v[48:49], v12 offset:20480
  v_mfma_f32_16x16x32_bf16 v[196:199], v[80:83], v[140:143], v[196:199]
  ds_read_b64_tr_b16 v[50:51], v12 offset:22528
  s_waitcnt lgkmcnt(14)
  v_mfma_f32_16x16x32_bf16 v[200:203], v[84:87], v[136:139], v[200:203]
  ds_read_b64_tr_b16 v[52:53], v13 offset:20480
  v_mfma_f32_16x16x32_bf16 v[204:207], v[84:87], v[140:143], v[204:207]
  ds_read_b64_tr_b16 v[54:55], v13 offset:22528
  s_waitcnt lgkmcnt(14)
  v_mfma_f32_16x16x32_bf16 v[208:211], v[88:91], v[136:139], v[208:211]
  ds_read_b64_tr_b16 v[56:57], v14 offset:20480
  v_mfma_f32_16x16x32_bf16 v[212:215], v[88:91], v[140:143], v[212:215]
  ds_read_b64_tr_b16 v[58:59], v14 offset:22528
  s_waitcnt lgkmcnt(14)
  v_mfma_f32_16x16x32_bf16 v[216:219], v[92:95], v[136:139], v[216:219]
  ds_read_b64_tr_b16 v[60:61], v15 offset:20480
  buffer_load_dwordx4 v[136:139], v5, s[12:15], s40 offen offset:1024
  v_mfma_f32_16x16x32_bf16 v[220:223], v[92:95], v[140:143], v[220:223]
  ds_read_b64_tr_b16 v[62:63], v15 offset:22528
  buffer_load_dwordx4 v[140:143], v5, s[12:15], s41 offen offset:1024
  s_waitcnt vmcnt(23)
  s_waitcnt lgkmcnt(14)
  v_mfma_f32_16x16x32_bf16 v[160:163], v[32:35], v[144:147], v[160:163]
  ds_read_b64_tr_b16 v[64:65], v12 offset:24576
  s_waitcnt vmcnt(22)
  v_mfma_f32_16x16x32_bf16 v[164:167], v[32:35], v[148:151], v[164:167]
  ds_read_b64_tr_b16 v[66:67], v12 offset:26624
  s_waitcnt lgkmcnt(14)
  v_mfma_f32_16x16x32_bf16 v[168:171], v[36:39], v[144:147], v[168:171]
  ds_read_b64_tr_b16 v[68:69], v13 offset:24576
  v_mfma_f32_16x16x32_bf16 v[172:175], v[36:39], v[148:151], v[172:175]
  ds_read_b64_tr_b16 v[70:71], v13 offset:26624
  s_waitcnt lgkmcnt(14)
  v_mfma_f32_16x16x32_bf16 v[176:179], v[40:43], v[144:147], v[176:179]
  ds_read_b64_tr_b16 v[72:73], v14 offset:24576
  v_mfma_f32_16x16x32_bf16 v[180:183], v[40:43], v[148:151], v[180:183]
  ds_read_b64_tr_b16 v[74:75], v14 offset:26624
  s_waitcnt lgkmcnt(14)
  v_mfma_f32_16x16x32_bf16 v[184:187], v[44:47], v[144:147], v[184:187]
  ds_read_b64_tr_b16 v[76:77], v15 offset:24576
  v_mfma_f32_16x16x32_bf16 v[188:191], v[44:47], v[148:151], v[188:191]
  ds_read_b64_tr_b16 v[78:79], v15 offset:26624
  s_waitcnt lgkmcnt(14)
  v_mfma_f32_16x16x32_bf16 v[192:195], v[48:51], v[144:147], v[192:195]
  ds_read_b64_tr_b16 v[80:81], v12 offset:28672
  v_mfma_f32_16x16x32_bf16 v[196:199], v[48:51], v[148:151], v[196:199]
  ds_read_b64_tr_b16 v[82:83], v12 offset:30720
  s_waitcnt lgkmcnt(14)
  v_mfma_f32_16x16x32_bf16 v[200:203], v[52:55], v[144:147], v[200:203]
  ds_read_b64_tr_b16 v[84:85], v13 offset:28672
  v_mfma_f32_16x16x32_bf16 v[204:207], v[52:55], v[148:151], v[204:207]
  ds_read_b64_tr_b16 v[86:87], v13 offset:30720
  s_waitcnt lgkmcnt(14)
  v_mfma_f32_16x16x32_bf16 v[208:211], v[56:59], v[144:147], v[208:211]
  ds_read_b64_tr_b16 v[88:89], v14 offset:28672
  v_mfma_f32_16x16x32_bf16 v[212:215], v[56:59], v[148:151], v[212:215]
  ds_read_b64_tr_b16 v[90:91], v14 offset:30720
  s_waitcnt lgkmcnt(14)
  v_mfma_f32_16x16x32_bf16 v[216:219], v[60:63], v[144:147], v[216:219]
  ds_read_b64_tr_b16 v[92:93], v15 offset:28672
  buffer_load_dwordx4 v[144:147], v5, s[12:15], s40 offen offset:2048
  v_mfma_f32_16x16x32_bf16 v[220:223], v[60:63], v[148:151], v[220:223]
  ds_read_b64_tr_b16 v[94:95], v15 offset:30720
  buffer_load_dwordx4 v[148:151], v5, s[12:15], s41 offen offset:2048
  s_waitcnt vmcnt(23)
  s_waitcnt lgkmcnt(14)
  v_mfma_f32_16x16x32_bf16 v[160:163], v[64:67], v[152:155], v[160:163]
  ds_read_b64_tr_b16 v[32:33], v12 offset:32768
  s_waitcnt vmcnt(22)
  v_mfma_f32_16x16x32_bf16 v[164:167], v[64:67], v[156:159], v[164:167]
  ds_read_b64_tr_b16 v[34:35], v12 offset:34816
  s_waitcnt lgkmcnt(14)
  v_mfma_f32_16x16x32_bf16 v[168:171], v[68:71], v[152:155], v[168:171]
  ds_read_b64_tr_b16 v[36:37], v13 offset:32768
  v_mfma_f32_16x16x32_bf16 v[172:175], v[68:71], v[156:159], v[172:175]
  ds_read_b64_tr_b16 v[38:39], v13 offset:34816
  s_waitcnt lgkmcnt(14)
  v_mfma_f32_16x16x32_bf16 v[176:179], v[72:75], v[152:155], v[176:179]
  ds_read_b64_tr_b16 v[40:41], v14 offset:32768
  v_mfma_f32_16x16x32_bf16 v[180:183], v[72:75], v[156:159], v[180:183]
  ds_read_b64_tr_b16 v[42:43], v14 offset:34816
  s_waitcnt lgkmcnt(14)
  v_mfma_f32_16x16x32_bf16 v[184:187], v[76:79], v[152:155], v[184:187]
  ds_read_b64_tr_b16 v[44:45], v15 offset:32768
  v_mfma_f32_16x16x32_bf16 v[188:191], v[76:79], v[156:159], v[188:191]
  ds_read_b64_tr_b16 v[46:47], v15 offset:34816
  s_waitcnt lgkmcnt(14)
  v_mfma_f32_16x16x32_bf16 v[192:195], v[80:83], v[152:155], v[192:195]
  ds_read_b64_tr_b16 v[48:49], v12 offset:36864
  v_mfma_f32_16x16x32_bf16 v[196:199], v[80:83], v[156:159], v[196:199]
  ds_read_b64_tr_b16 v[50:51], v12 offset:38912
  s_waitcnt lgkmcnt(14)
  v_mfma_f32_16x16x32_bf16 v[200:203], v[84:87], v[152:155], v[200:203]
  ds_read_b64_tr_b16 v[52:53], v13 offset:36864
  v_mfma_f32_16x16x32_bf16 v[204:207], v[84:87], v[156:159], v[204:207]
  ds_read_b64_tr_b16 v[54:55], v13 offset:38912
  s_waitcnt lgkmcnt(14)
  v_mfma_f32_16x16x32_bf16 v[208:211], v[88:91], v[152:155], v[208:211]
  ds_read_b64_tr_b16 v[56:57], v14 offset:36864
  v_mfma_f32_16x16x32_bf16 v[212:215], v[88:91], v[156:159], v[212:215]
  ds_read_b64_tr_b16 v[58:59], v14 offset:38912
  s_waitcnt lgkmcnt(14)
  v_mfma_f32_16x16x32_bf16 v[216:219], v[92:95], v[152:155], v[216:219]
  ds_read_b64_tr_b16 v[60:61], v15 offset:36864
  buffer_load_dwordx4 v[152:155], v5, s[12:15], s40 offen offset:3072
  v_mfma_f32_16x16x32_bf16 v[220:223], v[92:95], v[156:159], v[220:223]
  ds_read_b64_tr_b16 v[62:63], v15 offset:38912
  buffer_load_dwordx4 v[156:159], v5, s[12:15], s41 offen offset:3072
  s_waitcnt lgkmcnt(0)
  s_barrier
  s_waitcnt vmcnt(15)
  s_waitcnt lgkmcnt(14)
  v_mfma_f32_16x16x32_bf16 v[160:163], v[32:35], v[96:99], v[160:163]
  ds_read_b64_tr_b16 v[64:65], v12 offset:40960
  s_waitcnt vmcnt(14)
  v_mfma_f32_16x16x32_bf16 v[164:167], v[32:35], v[100:103], v[164:167]
  ds_read_b64_tr_b16 v[66:67], v12 offset:43008
  s_waitcnt lgkmcnt(14)
  v_mfma_f32_16x16x32_bf16 v[168:171], v[36:39], v[96:99], v[168:171]
  ds_read_b64_tr_b16 v[68:69], v13 offset:40960
  v_mfma_f32_16x16x32_bf16 v[172:175], v[36:39], v[100:103], v[172:175]
  ds_read_b64_tr_b16 v[70:71], v13 offset:43008
  s_waitcnt lgkmcnt(14)
  v_mfma_f32_16x16x32_bf16 v[176:179], v[40:43], v[96:99], v[176:179]
  ds_read_b64_tr_b16 v[72:73], v14 offset:40960
  v_mfma_f32_16x16x32_bf16 v[180:183], v[40:43], v[100:103], v[180:183]
  ds_read_b64_tr_b16 v[74:75], v14 offset:43008
  s_waitcnt lgkmcnt(14)
  v_mfma_f32_16x16x32_bf16 v[184:187], v[44:47], v[96:99], v[184:187]
  ds_read_b64_tr_b16 v[76:77], v15 offset:40960
  v_mfma_f32_16x16x32_bf16 v[188:191], v[44:47], v[100:103], v[188:191]
  ds_read_b64_tr_b16 v[78:79], v15 offset:43008
  s_waitcnt lgkmcnt(14)
  v_mfma_f32_16x16x32_bf16 v[192:195], v[48:51], v[96:99], v[192:195]
  ds_read_b64_tr_b16 v[80:81], v12 offset:45056
  v_mfma_f32_16x16x32_bf16 v[196:199], v[48:51], v[100:103], v[196:199]
  ds_read_b64_tr_b16 v[82:83], v12 offset:47104
  s_waitcnt lgkmcnt(14)
  v_mfma_f32_16x16x32_bf16 v[200:203], v[52:55], v[96:99], v[200:203]
  ds_read_b64_tr_b16 v[84:85], v13 offset:45056
  v_mfma_f32_16x16x32_bf16 v[204:207], v[52:55], v[100:103], v[204:207]
  ds_read_b64_tr_b16 v[86:87], v13 offset:47104
  s_waitcnt lgkmcnt(14)
  v_mfma_f32_16x16x32_bf16 v[208:211], v[56:59], v[96:99], v[208:211]
  ds_read_b64_tr_b16 v[88:89], v14 offset:45056
  v_mfma_f32_16x16x32_bf16 v[212:215], v[56:59], v[100:103], v[212:215]
  ds_read_b64_tr_b16 v[90:91], v14 offset:47104
  s_waitcnt lgkmcnt(14)
  v_mfma_f32_16x16x32_bf16 v[216:219], v[60:63], v[96:99], v[216:219]
  ds_read_b64_tr_b16 v[92:93], v15 offset:45056
  v_mfma_f32_16x16x32_bf16 v[220:223], v[60:63], v[100:103], v[220:223]
  ds_read_b64_tr_b16 v[94:95], v15 offset:47104
  s_waitcnt vmcnt(13)
  s_waitcnt lgkmcnt(14)
  v_mfma_f32_16x16x32_bf16 v[160:163], v[64:67], v[104:107], v[160:163]
  ds_read_b64_tr_b16 v[32:33], v12 offset:49152
  s_waitcnt vmcnt(12)
  v_mfma_f32_16x16x32_bf16 v[164:167], v[64:67], v[108:111], v[164:167]
  ds_read_b64_tr_b16 v[34:35], v12 offset:51200
  s_waitcnt lgkmcnt(14)
  v_mfma_f32_16x16x32_bf16 v[168:171], v[68:71], v[104:107], v[168:171]
  ds_read_b64_tr_b16 v[36:37], v13 offset:49152
  v_mfma_f32_16x16x32_bf16 v[172:175], v[68:71], v[108:111], v[172:175]
  ds_read_b64_tr_b16 v[38:39], v13 offset:51200
  s_waitcnt lgkmcnt(14)
  v_mfma_f32_16x16x32_bf16 v[176:179], v[72:75], v[104:107], v[176:179]
  ds_read_b64_tr_b16 v[40:41], v14 offset:49152
  v_mfma_f32_16x16x32_bf16 v[180:183], v[72:75], v[108:111], v[180:183]
  ds_read_b64_tr_b16 v[42:43], v14 offset:51200
  s_waitcnt lgkmcnt(14)
  v_mfma_f32_16x16x32_bf16 v[184:187], v[76:79], v[104:107], v[184:187]
  ds_read_b64_tr_b16 v[44:45], v15 offset:49152
  v_mfma_f32_16x16x32_bf16 v[188:191], v[76:79], v[108:111], v[188:191]
  ds_read_b64_tr_b16 v[46:47], v15 offset:51200
  s_waitcnt lgkmcnt(14)
  v_mfma_f32_16x16x32_bf16 v[192:195], v[80:83], v[104:107], v[192:195]
  ds_read_b64_tr_b16 v[48:49], v12 offset:53248
  v_mfma_f32_16x16x32_bf16 v[196:199], v[80:83], v[108:111], v[196:199]
  ds_read_b64_tr_b16 v[50:51], v12 offset:55296
  s_waitcnt lgkmcnt(14)
  v_mfma_f32_16x16x32_bf16 v[200:203], v[84:87], v[104:107], v[200:203]
  ds_read_b64_tr_b16 v[52:53], v13 offset:53248
  v_mfma_f32_16x16x32_bf16 v[204:207], v[84:87], v[108:111], v[204:207]
  ds_read_b64_tr_b16 v[54:55], v13 offset:55296
  s_waitcnt lgkmcnt(14)
  v_mfma_f32_16x16x32_bf16 v[208:211], v[88:91], v[104:107], v[208:211]
  ds_read_b64_tr_b16 v[56:57], v14 offset:53248
  v_mfma_f32_16x16x32_bf16 v[212:215], v[88:91], v[108:111], v[212:215]
  ds_read_b64_tr_b16 v[58:59], v14 offset:55296
  s_waitcnt lgkmcnt(14)
  v_mfma_f32_16x16x32_bf16 v[216:219], v[92:95], v[104:107], v[216:219]
  ds_read_b64_tr_b16 v[60:61], v15 offset:53248
  v_mfma_f32_16x16x32_bf16 v[220:223], v[92:95], v[108:111], v[220:223]
  ds_read_b64_tr_b16 v[62:63], v15 offset:55296
  s_waitcnt vmcnt(11)
  s_waitcnt lgkmcnt(14)
  v_mfma_f32_16x16x32_bf16 v[160:163], v[32:35], v[112:115], v[160:163]
  ds_read_b64_tr_b16 v[64:65], v12 offset:57344
  s_waitcnt vmcnt(10)
  v_mfma_f32_16x16x32_bf16 v[164:167], v[32:35], v[116:119], v[164:167]
  ds_read_b64_tr_b16 v[66:67], v12 offset:59392
  s_waitcnt lgkmcnt(14)
  v_mfma_f32_16x16x32_bf16 v[168:171], v[36:39], v[112:115], v[168:171]
  ds_read_b64_tr_b16 v[68:69], v13 offset:57344
  v_mfma_f32_16x16x32_bf16 v[172:175], v[36:39], v[116:119], v[172:175]
  ds_read_b64_tr_b16 v[70:71], v13 offset:59392
  s_waitcnt lgkmcnt(14)
  v_mfma_f32_16x16x32_bf16 v[176:179], v[40:43], v[112:115], v[176:179]
  ds_read_b64_tr_b16 v[72:73], v14 offset:57344
  v_mfma_f32_16x16x32_bf16 v[180:183], v[40:43], v[116:119], v[180:183]
  ds_read_b64_tr_b16 v[74:75], v14 offset:59392
  s_waitcnt lgkmcnt(14)
  v_mfma_f32_16x16x32_bf16 v[184:187], v[44:47], v[112:115], v[184:187]
  ds_read_b64_tr_b16 v[76:77], v15 offset:57344
  v_mfma_f32_16x16x32_bf16 v[188:191], v[44:47], v[116:119], v[188:191]
  ds_read_b64_tr_b16 v[78:79], v15 offset:59392
  s_waitcnt lgkmcnt(14)
  v_mfma_f32_16x16x32_bf16 v[192:195], v[48:51], v[112:115], v[192:195]
  ds_read_b64_tr_b16 v[80:81], v12 offset:61440
  v_mfma_f32_16x16x32_bf16 v[196:199], v[48:51], v[116:119], v[196:199]
  ds_read_b64_tr_b16 v[82:83], v12 offset:63488
  s_waitcnt lgkmcnt(14)
  v_mfma_f32_16x16x32_bf16 v[200:203], v[52:55], v[112:115], v[200:203]
  ds_read_b64_tr_b16 v[84:85], v13 offset:61440
  v_mfma_f32_16x16x32_bf16 v[204:207], v[52:55], v[116:119], v[204:207]
  ds_read_b64_tr_b16 v[86:87], v13 offset:63488
  s_waitcnt lgkmcnt(14)
  v_mfma_f32_16x16x32_bf16 v[208:211], v[56:59], v[112:115], v[208:211]
  ds_read_b64_tr_b16 v[88:89], v14 offset:61440
  v_mfma_f32_16x16x32_bf16 v[212:215], v[56:59], v[116:119], v[212:215]
  ds_read_b64_tr_b16 v[90:91], v14 offset:63488
  s_waitcnt lgkmcnt(14)
  v_mfma_f32_16x16x32_bf16 v[216:219], v[60:63], v[112:115], v[216:219]
  ds_read_b64_tr_b16 v[92:93], v15 offset:61440
  v_mfma_f32_16x16x32_bf16 v[220:223], v[60:63], v[116:119], v[220:223]
  ds_read_b64_tr_b16 v[94:95], v15 offset:63488
  s_waitcnt vmcnt(9)
  s_waitcnt lgkmcnt(14)
  v_mfma_f32_16x16x32_bf16 v[160:163], v[64:67], v[120:123], v[160:163]
  ds_read_b64_tr_b16 v[32:33], v16 offset:0
  s_waitcnt vmcnt(8)
  v_mfma_f32_16x16x32_bf16 v[164:167], v[64:67], v[124:127], v[164:167]
  ds_read_b64_tr_b16 v[34:35], v16 offset:2048
  s_waitcnt lgkmcnt(14)
  v_mfma_f32_16x16x32_bf16 v[168:171], v[68:71], v[120:123], v[168:171]
  ds_read_b64_tr_b16 v[36:37], v17 offset:0
  v_mfma_f32_16x16x32_bf16 v[172:175], v[68:71], v[124:127], v[172:175]
  ds_read_b64_tr_b16 v[38:39], v17 offset:2048
  s_waitcnt lgkmcnt(14)
  v_mfma_f32_16x16x32_bf16 v[176:179], v[72:75], v[120:123], v[176:179]
  ds_read_b64_tr_b16 v[40:41], v18 offset:0
  v_mfma_f32_16x16x32_bf16 v[180:183], v[72:75], v[124:127], v[180:183]
  ds_read_b64_tr_b16 v[42:43], v18 offset:2048
  s_waitcnt lgkmcnt(14)
  v_mfma_f32_16x16x32_bf16 v[184:187], v[76:79], v[120:123], v[184:187]
  ds_read_b64_tr_b16 v[44:45], v19 offset:0
  v_mfma_f32_16x16x32_bf16 v[188:191], v[76:79], v[124:127], v[188:191]
  ds_read_b64_tr_b16 v[46:47], v19 offset:2048
  s_waitcnt lgkmcnt(14)
  v_mfma_f32_16x16x32_bf16 v[192:195], v[80:83], v[120:123], v[192:195]
  ds_read_b64_tr_b16 v[48:49], v16 offset:4096
  v_mfma_f32_16x16x32_bf16 v[196:199], v[80:83], v[124:127], v[196:199]
  ds_read_b64_tr_b16 v[50:51], v16 offset:6144
  s_waitcnt lgkmcnt(14)
  v_mfma_f32_16x16x32_bf16 v[200:203], v[84:87], v[120:123], v[200:203]
  ds_read_b64_tr_b16 v[52:53], v17 offset:4096
  v_mfma_f32_16x16x32_bf16 v[204:207], v[84:87], v[124:127], v[204:207]
  ds_read_b64_tr_b16 v[54:55], v17 offset:6144
  s_waitcnt lgkmcnt(14)
  v_mfma_f32_16x16x32_bf16 v[208:211], v[88:91], v[120:123], v[208:211]
  ds_read_b64_tr_b16 v[56:57], v18 offset:4096
  v_mfma_f32_16x16x32_bf16 v[212:215], v[88:91], v[124:127], v[212:215]
  ds_read_b64_tr_b16 v[58:59], v18 offset:6144
  s_waitcnt lgkmcnt(14)
  v_mfma_f32_16x16x32_bf16 v[216:219], v[92:95], v[120:123], v[216:219]
  ds_read_b64_tr_b16 v[60:61], v19 offset:4096
  v_mfma_f32_16x16x32_bf16 v[220:223], v[92:95], v[124:127], v[220:223]
  ds_read_b64_tr_b16 v[62:63], v19 offset:6144
  s_waitcnt vmcnt(7)
  s_waitcnt lgkmcnt(14)
  v_mfma_f32_16x16x32_bf16 v[160:163], v[32:35], v[128:131], v[160:163]
  ds_read_b64_tr_b16 v[64:65], v16 offset:8192
  s_waitcnt vmcnt(6)
  v_mfma_f32_16x16x32_bf16 v[164:167], v[32:35], v[132:135], v[164:167]
  ds_read_b64_tr_b16 v[66:67], v16 offset:10240
  s_waitcnt lgkmcnt(14)
  v_mfma_f32_16x16x32_bf16 v[168:171], v[36:39], v[128:131], v[168:171]
  ds_read_b64_tr_b16 v[68:69], v17 offset:8192
  v_mfma_f32_16x16x32_bf16 v[172:175], v[36:39], v[132:135], v[172:175]
  ds_read_b64_tr_b16 v[70:71], v17 offset:10240
  s_waitcnt lgkmcnt(14)
  v_mfma_f32_16x16x32_bf16 v[176:179], v[40:43], v[128:131], v[176:179]
  ds_read_b64_tr_b16 v[72:73], v18 offset:8192
  v_mfma_f32_16x16x32_bf16 v[180:183], v[40:43], v[132:135], v[180:183]
  ds_read_b64_tr_b16 v[74:75], v18 offset:10240
  s_waitcnt lgkmcnt(14)
  v_mfma_f32_16x16x32_bf16 v[184:187], v[44:47], v[128:131], v[184:187]
  ds_read_b64_tr_b16 v[76:77], v19 offset:8192
  v_mfma_f32_16x16x32_bf16 v[188:191], v[44:47], v[132:135], v[188:191]
  ds_read_b64_tr_b16 v[78:79], v19 offset:10240
  s_waitcnt lgkmcnt(14)
  v_mfma_f32_16x16x32_bf16 v[192:195], v[48:51], v[128:131], v[192:195]
  ds_read_b64_tr_b16 v[80:81], v16 offset:12288
  v_mfma_f32_16x16x32_bf16 v[196:199], v[48:51], v[132:135], v[196:199]
  ds_read_b64_tr_b16 v[82:83], v16 offset:14336
  s_waitcnt lgkmcnt(14)
  v_mfma_f32_16x16x32_bf16 v[200:203], v[52:55], v[128:131], v[200:203]
  ds_read_b64_tr_b16 v[84:85], v17 offset:12288
  v_mfma_f32_16x16x32_bf16 v[204:207], v[52:55], v[132:135], v[204:207]
  ds_read_b64_tr_b16 v[86:87], v17 offset:14336
  s_waitcnt lgkmcnt(14)
  v_mfma_f32_16x16x32_bf16 v[208:211], v[56:59], v[128:131], v[208:211]
  ds_read_b64_tr_b16 v[88:89], v18 offset:12288
  v_mfma_f32_16x16x32_bf16 v[212:215], v[56:59], v[132:135], v[212:215]
  ds_read_b64_tr_b16 v[90:91], v18 offset:14336
  s_waitcnt lgkmcnt(14)
  v_mfma_f32_16x16x32_bf16 v[216:219], v[60:63], v[128:131], v[216:219]
  ds_read_b64_tr_b16 v[92:93], v19 offset:12288
  v_mfma_f32_16x16x32_bf16 v[220:223], v[60:63], v[132:135], v[220:223]
  ds_read_b64_tr_b16 v[94:95], v19 offset:14336
  s_waitcnt vmcnt(5)
  s_waitcnt lgkmcnt(14)
  v_mfma_f32_16x16x32_bf16 v[160:163], v[64:67], v[136:139], v[160:163]
  ds_read_b64_tr_b16 v[32:33], v16 offset:16384
  s_waitcnt vmcnt(4)
  v_mfma_f32_16x16x32_bf16 v[164:167], v[64:67], v[140:143], v[164:167]
  ds_read_b64_tr_b16 v[34:35], v16 offset:18432
  s_waitcnt lgkmcnt(14)
  v_mfma_f32_16x16x32_bf16 v[168:171], v[68:71], v[136:139], v[168:171]
  ds_read_b64_tr_b16 v[36:37], v17 offset:16384
  v_mfma_f32_16x16x32_bf16 v[172:175], v[68:71], v[140:143], v[172:175]
  ds_read_b64_tr_b16 v[38:39], v17 offset:18432
  s_waitcnt lgkmcnt(14)
  v_mfma_f32_16x16x32_bf16 v[176:179], v[72:75], v[136:139], v[176:179]
  ds_read_b64_tr_b16 v[40:41], v18 offset:16384
  v_mfma_f32_16x16x32_bf16 v[180:183], v[72:75], v[140:143], v[180:183]
  ds_read_b64_tr_b16 v[42:43], v18 offset:18432
  s_waitcnt lgkmcnt(14)
  v_mfma_f32_16x16x32_bf16 v[184:187], v[76:79], v[136:139], v[184:187]
  ds_read_b64_tr_b16 v[44:45], v19 offset:16384
  v_mfma_f32_16x16x32_bf16 v[188:191], v[76:79], v[140:143], v[188:191]
  ds_read_b64_tr_b16 v[46:47], v19 offset:18432
  s_waitcnt lgkmcnt(14)
  v_mfma_f32_16x16x32_bf16 v[192:195], v[80:83], v[136:139], v[192:195]
  ds_read_b64_tr_b16 v[48:49], v16 offset:20480
  v_mfma_f32_16x16x32_bf16 v[196:199], v[80:83], v[140:143], v[196:199]
  ds_read_b64_tr_b16 v[50:51], v16 offset:22528
  s_waitcnt lgkmcnt(14)
  v_mfma_f32_16x16x32_bf16 v[200:203], v[84:87], v[136:139], v[200:203]
  ds_read_b64_tr_b16 v[52:53], v17 offset:20480
  v_mfma_f32_16x16x32_bf16 v[204:207], v[84:87], v[140:143], v[204:207]
  ds_read_b64_tr_b16 v[54:55], v17 offset:22528
  s_waitcnt lgkmcnt(14)
  v_mfma_f32_16x16x32_bf16 v[208:211], v[88:91], v[136:139], v[208:211]
  ds_read_b64_tr_b16 v[56:57], v18 offset:20480
  v_mfma_f32_16x16x32_bf16 v[212:215], v[88:91], v[140:143], v[212:215]
  ds_read_b64_tr_b16 v[58:59], v18 offset:22528
  s_waitcnt lgkmcnt(14)
  v_mfma_f32_16x16x32_bf16 v[216:219], v[92:95], v[136:139], v[216:219]
  ds_read_b64_tr_b16 v[60:61], v19 offset:20480
  v_mfma_f32_16x16x32_bf16 v[220:223], v[92:95], v[140:143], v[220:223]
  ds_read_b64_tr_b16 v[62:63], v19 offset:22528
  s_waitcnt vmcnt(3)
  s_waitcnt lgkmcnt(14)
  v_mfma_f32_16x16x32_bf16 v[160:163], v[32:35], v[144:147], v[160:163]
  ds_read_b64_tr_b16 v[64:65], v16 offset:24576
  s_waitcnt vmcnt(2)
  v_mfma_f32_16x16x32_bf16 v[164:167], v[32:35], v[148:151], v[164:167]
  ds_read_b64_tr_b16 v[66:67], v16 offset:26624
  s_waitcnt lgkmcnt(14)
  v_mfma_f32_16x16x32_bf16 v[168:171], v[36:39], v[144:147], v[168:171]
  ds_read_b64_tr_b16 v[68:69], v17 offset:24576
  v_mfma_f32_16x16x32_bf16 v[172:175], v[36:39], v[148:151], v[172:175]
  ds_read_b64_tr_b16 v[70:71], v17 offset:26624
  s_waitcnt lgkmcnt(14)
  v_mfma_f32_16x16x32_bf16 v[176:179], v[40:43], v[144:147], v[176:179]
  ds_read_b64_tr_b16 v[72:73], v18 offset:24576
  v_mfma_f32_16x16x32_bf16 v[180:183], v[40:43], v[148:151], v[180:183]
  ds_read_b64_tr_b16 v[74:75], v18 offset:26624
  s_waitcnt lgkmcnt(14)
  v_mfma_f32_16x16x32_bf16 v[184:187], v[44:47], v[144:147], v[184:187]
  ds_read_b64_tr_b16 v[76:77], v19 offset:24576
  v_mfma_f32_16x16x32_bf16 v[188:191], v[44:47], v[148:151], v[188:191]
  ds_read_b64_tr_b16 v[78:79], v19 offset:26624
  s_waitcnt lgkmcnt(14)
  v_mfma_f32_16x16x32_bf16 v[192:195], v[48:51], v[144:147], v[192:195]
  ds_read_b64_tr_b16 v[80:81], v16 offset:28672
  v_mfma_f32_16x16x32_bf16 v[196:199], v[48:51], v[148:151], v[196:199]
  ds_read_b64_tr_b16 v[82:83], v16 offset:30720
  s_waitcnt lgkmcnt(14)
  v_mfma_f32_16x16x32_bf16 v[200:203], v[52:55], v[144:147], v[200:203]
  ds_read_b64_tr_b16 v[84:85], v17 offset:28672
  v_mfma_f32_16x16x32_bf16 v[204:207], v[52:55], v[148:151], v[204:207]
  ds_read_b64_tr_b16 v[86:87], v17 offset:30720
  s_waitcnt lgkmcnt(14)
  v_mfma_f32_16x16x32_bf16 v[208:211], v[56:59], v[144:147], v[208:211]
  ds_read_b64_tr_b16 v[88:89], v18 offset:28672
  v_mfma_f32_16x16x32_bf16 v[212:215], v[56:59], v[148:151], v[212:215]
  ds_read_b64_tr_b16 v[90:91], v18 offset:30720
  s_waitcnt lgkmcnt(14)
  v_mfma_f32_16x16x32_bf16 v[216:219], v[60:63], v[144:147], v[216:219]
  ds_read_b64_tr_b16 v[92:93], v19 offset:28672
  v_mfma_f32_16x16x32_bf16 v[220:223], v[60:63], v[148:151], v[220:223]
  ds_read_b64_tr_b16 v[94:95], v19 offset:30720
  s_waitcnt vmcnt(1)
  s_waitcnt lgkmcnt(14)
  v_mfma_f32_16x16x32_bf16 v[160:163], v[64:67], v[152:155], v[160:163]
  ds_read_b128 v[32:35], v5 offset:24576
  s_waitcnt vmcnt(0)
  v_mfma_f32_16x16x32_bf16 v[164:167], v[64:67], v[156:159], v[164:167]
  ds_read_b128 v[36:39], v5 offset:25600
  s_waitcnt lgkmcnt(14)
  v_mfma_f32_16x16x32_bf16 v[168:171], v[68:71], v[152:155], v[168:171]
  ds_read_b128 v[40:43], v5 offset:26624
  v_mfma_f32_16x16x32_bf16 v[172:175], v[68:71], v[156:159], v[172:175]
  ds_read_b128 v[44:47], v5 offset:27648
  s_waitcnt lgkmcnt(14)
  v_mfma_f32_16x16x32_bf16 v[176:179], v[72:75], v[152:155], v[176:179]
  ds_read_b128 v[48:51], v5 offset:28672
  v_mfma_f32_16x16x32_bf16 v[180:183], v[72:75], v[156:159], v[180:183]
  ds_read_b128 v[52:55], v5 offset:29696
  s_waitcnt lgkmcnt(14)
  v_mfma_f32_16x16x32_bf16 v[184:187], v[76:79], v[152:155], v[184:187]
  ds_read_b128 v[56:59], v5 offset:30720
  v_mfma_f32_16x16x32_bf16 v[188:191], v[76:79], v[156:159], v[188:191]
  ds_read_b128 v[60:63], v5 offset:31744
  s_waitcnt lgkmcnt(14)
  v_mfma_f32_16x16x32_bf16 v[192:195], v[80:83], v[152:155], v[192:195]
  v_mfma_f32_16x16x32_bf16 v[196:199], v[80:83], v[156:159], v[196:199]
  s_waitcnt lgkmcnt(12)
  v_mfma_f32_16x16x32_bf16 v[200:203], v[84:87], v[152:155], v[200:203]
  v_mfma_f32_16x16x32_bf16 v[204:207], v[84:87], v[156:159], v[204:207]
  s_waitcnt lgkmcnt(10)
  v_mfma_f32_16x16x32_bf16 v[208:211], v[88:91], v[152:155], v[208:211]
  v_mfma_f32_16x16x32_bf16 v[212:215], v[88:91], v[156:159], v[212:215]
  s_waitcnt lgkmcnt(8)
  v_mfma_f32_16x16x32_bf16 v[216:219], v[92:95], v[152:155], v[216:219]
  v_mfma_f32_16x16x32_bf16 v[220:223], v[92:95], v[156:159], v[220:223]
  s_waitcnt lgkmcnt(0)
  s_barrier
  s_mul_i32 s24, s32, 114688
  s_lshl_b32 s27, s33, 12
  s_add_u32 s24, s24, s27
  s_add_u32 s24, s24, 6291456
  v_pk_add_f32 v[240:241], v[240:241], v[242:243]
  v_pk_add_f32 v[244:245], v[244:245], v[246:247]
  v_pk_add_f32 v[240:241], v[240:241], v[244:245]
  v_pk_add_f32 v[248:249], v[248:249], v[250:251]
  v_pk_add_f32 v[252:253], v[252:253], v[254:255]
  v_pk_add_f32 v[244:245], v[248:249], v[252:253]
  v_mov_b32 v242, v240
  v_mov_b32 v243, v241
  v_mov_b32 v246, v244
  v_mov_b32 v247, v245
  v_permlane32_swap_b32 v240, v242
  v_permlane32_swap_b32 v241, v243
  v_permlane32_swap_b32 v244, v246
  v_permlane32_swap_b32 v245, v247
  v_pk_add_f32 v[240:241], v[240:241], v[242:243]
  v_pk_add_f32 v[244:245], v[244:245], v[246:247]
  v_mov_b32 v242, v240
  v_mov_b32 v243, v241
  v_mov_b32 v246, v244
  v_mov_b32 v247, v245
  v_permlane16_swap_b32 v240, v242
  v_permlane16_swap_b32 v241, v243
  v_permlane16_swap_b32 v244, v246
  v_permlane16_swap_b32 v245, v247
  v_pk_add_f32 v[240:241], v[240:241], v[242:243]
  v_pk_add_f32 v[244:245], v[244:245], v[246:247]
  v_mul_f32 v240, 0x3b000000, v240
  v_mul_f32 v248, v240, v240
  v_fma_f32 v241, v241, s90, -v248
  v_max_f32 v241, 0, v241
  v_cvt_pk_bf16_f32 v242, v240, v240
  v_and_b32 v242, 0xffff0000, v242
  v_cvt_pk_bf16_f32 v248, v241, v241
  v_and_b32 v248, 0xffff0000, v248
  v_add_f32 v248, 0x3727c5ac, v248
  v_cvt_pk_bf16_f32 v248, v248, v248
  v_and_b32 v248, 0xffff0000, v248
  v_sqrt_f32 v248, v248
  s_nop 0
  v_cvt_pk_bf16_f32 v248, v248, v248
  v_and_b32 v248, 0xffff0000, v248
  v_rcp_f32 v243, v248
  s_nop 0
  v_mul_f32 v242, -1.0, v242
  v_mul_f32 v244, 0x3b000000, v244
  v_mul_f32 v249, v244, v244
  v_fma_f32 v245, v245, s90, -v249
  v_max_f32 v245, 0, v245
  v_cvt_pk_bf16_f32 v246, v244, v244
  v_and_b32 v246, 0xffff0000, v246
  v_cvt_pk_bf16_f32 v249, v245, v245
  v_and_b32 v249, 0xffff0000, v249
  v_add_f32 v249, 0x3727c5ac, v249
  v_cvt_pk_bf16_f32 v249, v249, v249
  v_and_b32 v249, 0xffff0000, v249
  v_sqrt_f32 v249, v249
  s_nop 0
  v_cvt_pk_bf16_f32 v249, v249, v249
  v_and_b32 v249, 0xffff0000, v249
  v_rcp_f32 v247, v249
  s_nop 0
  v_mul_f32 v246, -1.0, v246
  v_pk_fma_f32 v[160:161], v[32:33], v[242:243], v[160:161] op_sel:[0,0,0] op_sel_hi:[1,0,1]
  v_pk_fma_f32 v[162:163], v[34:35], v[242:243], v[162:163] op_sel:[0,0,0] op_sel_hi:[1,0,1]
  v_pk_fma_f32 v[168:169], v[36:37], v[242:243], v[168:169] op_sel:[0,0,0] op_sel_hi:[1,0,1]
  v_pk_fma_f32 v[170:171], v[38:39], v[242:243], v[170:171] op_sel:[0,0,0] op_sel_hi:[1,0,1]
  v_pk_mul_f32 v[160:161], v[160:161], v[242:243] op_sel:[0,1] op_sel_hi:[1,1]
  v_pk_mul_f32 v[162:163], v[162:163], v[242:243] op_sel:[0,1] op_sel_hi:[1,1]
  v_pk_mul_f32 v[168:169], v[168:169], v[242:243] op_sel:[0,1] op_sel_hi:[1,1]
  v_pk_mul_f32 v[170:171], v[170:171], v[242:243] op_sel:[0,1] op_sel_hi:[1,1]
  v_pk_mul_f32 v[64:65], v[160:161], v[160:161]
  v_pk_mul_f32 v[66:67], v[162:163], v[162:163]
  v_pk_mul_f32 v[68:69], v[168:169], v[168:169]
  v_pk_mul_f32 v[70:71], v[170:171], v[170:171]
  v_pk_fma_f32 v[72:73], v[64:65], s[86:87], s[86:87] op_sel:[0,1,0] op_sel_hi:[1,1,0]
  v_pk_fma_f32 v[74:75], v[66:67], s[86:87], s[86:87] op_sel:[0,1,0] op_sel_hi:[1,1,0]
  v_pk_fma_f32 v[76:77], v[68:69], s[86:87], s[86:87] op_sel:[0,1,0] op_sel_hi:[1,1,0]
  v_pk_fma_f32 v[78:79], v[70:71], s[86:87], s[86:87] op_sel:[0,1,0] op_sel_hi:[1,1,0]
  v_pk_fma_f32 v[72:73], v[72:73], v[64:65], s[84:85] op_sel:[0,0,1] op_sel_hi:[1,1,1]
  v_pk_fma_f32 v[74:75], v[74:75], v[66:67], s[84:85] op_sel:[0,0,1] op_sel_hi:[1,1,1]
  v_pk_fma_f32 v[76:77], v[76:77], v[68:69], s[84:85] op_sel:[0,0,1] op_sel_hi:[1,1,1]
  v_pk_fma_f32 v[78:79], v[78:79], v[70:71], s[84:85] op_sel:[0,0,1] op_sel_hi:[1,1,1]
  v_pk_fma_f32 v[72:73], v[72:73], v[64:65], s[84:85] op_sel:[0,0,0] op_sel_hi:[1,1,0]
  v_pk_fma_f32 v[74:75], v[74:75], v[66:67], s[84:85] op_sel:[0,0,0] op_sel_hi:[1,1,0]
  v_pk_fma_f32 v[76:77], v[76:77], v[68:69], s[84:85] op_sel:[0,0,0] op_sel_hi:[1,1,0]
  v_pk_fma_f32 v[78:79], v[78:79], v[70:71], s[84:85] op_sel:[0,0,0] op_sel_hi:[1,1,0]
  v_pk_fma_f32 v[72:73], v[72:73], v[64:65], s[82:83] op_sel:[0,0,1] op_sel_hi:[1,1,1]
  v_pk_fma_f32 v[74:75], v[74:75], v[66:67], s[82:83] op_sel:[0,0,1] op_sel_hi:[1,1,1]
  v_pk_fma_f32 v[76:77], v[76:77], v[68:69], s[82:83] op_sel:[0,0,1] op_sel_hi:[1,1,1]
  v_pk_fma_f32 v[78:79], v[78:79], v[70:71], s[82:83] op_sel:[0,0,1] op_sel_hi:[1,1,1]
  v_pk_fma_f32 v[72:73], v[72:73], v[64:65], s[82:83] op_sel:[0,0,0] op_sel_hi:[1,1,0]
  v_pk_fma_f32 v[74:75], v[74:75], v[66:67], s[82:83] op_sel:[0,0,0] op_sel_hi:[1,1,0]
  v_pk_fma_f32 v[76:77], v[76:77], v[68:69], s[82:83] op_sel:[0,0,0] op_sel_hi:[1,1,0]
  v_pk_fma_f32 v[78:79], v[78:79], v[70:71], s[82:83] op_sel:[0,0,0] op_sel_hi:[1,1,0]
  v_pk_fma_f32 v[72:73], v[72:73], v[64:65], s[80:81] op_sel:[0,0,1] op_sel_hi:[1,1,1]
  v_pk_fma_f32 v[74:75], v[74:75], v[66:67], s[80:81] op_sel:[0,0,1] op_sel_hi:[1,1,1]
  v_pk_fma_f32 v[76:77], v[76:77], v[68:69], s[80:81] op_sel:[0,0,1] op_sel_hi:[1,1,1]
  v_pk_fma_f32 v[78:79], v[78:79], v[70:71], s[80:81] op_sel:[0,0,1] op_sel_hi:[1,1,1]
  v_pk_fma_f32 v[72:73], v[72:73], v[160:161], s[80:81] op_sel_hi:[1,1,0] clamp
  v_pk_fma_f32 v[74:75], v[74:75], v[162:163], s[80:81] op_sel_hi:[1,1,0] clamp
  v_pk_fma_f32 v[76:77], v[76:77], v[168:169], s[80:81] op_sel_hi:[1,1,0] clamp
  v_pk_fma_f32 v[78:79], v[78:79], v[170:171], s[80:81] op_sel_hi:[1,1,0] clamp
  v_pk_mul_f32 v[64:65], v[72:73], v[160:161]
  v_pk_mul_f32 v[66:67], v[74:75], v[162:163]
  v_pk_mul_f32 v[68:69], v[76:77], v[168:169]
  v_pk_mul_f32 v[70:71], v[78:79], v[170:171]
  v_cvt_pk_bf16_f32 v80, v64, v65
  v_cvt_pk_bf16_f32 v81, v66, v67
  v_cvt_pk_bf16_f32 v82, v68, v69
  v_cvt_pk_bf16_f32 v83, v70, v71
  buffer_store_dwordx4 v[80:83], v5, s[12:15], s24 offen offset:0 sc1
  v_pk_fma_f32 v[176:177], v[40:41], v[242:243], v[176:177] op_sel:[0,0,0] op_sel_hi:[1,0,1]
  v_pk_fma_f32 v[178:179], v[42:43], v[242:243], v[178:179] op_sel:[0,0,0] op_sel_hi:[1,0,1]
  v_pk_fma_f32 v[184:185], v[44:45], v[242:243], v[184:185] op_sel:[0,0,0] op_sel_hi:[1,0,1]
  v_pk_fma_f32 v[186:187], v[46:47], v[242:243], v[186:187] op_sel:[0,0,0] op_sel_hi:[1,0,1]
  v_pk_mul_f32 v[176:177], v[176:177], v[242:243] op_sel:[0,1] op_sel_hi:[1,1]
  v_pk_mul_f32 v[178:179], v[178:179], v[242:243] op_sel:[0,1] op_sel_hi:[1,1]
  v_pk_mul_f32 v[184:185], v[184:185], v[242:243] op_sel:[0,1] op_sel_hi:[1,1]
  v_pk_mul_f32 v[186:187], v[186:187], v[242:243] op_sel:[0,1] op_sel_hi:[1,1]
  v_pk_mul_f32 v[64:65], v[176:177], v[176:177]
  v_pk_mul_f32 v[66:67], v[178:179], v[178:179]
  v_pk_mul_f32 v[68:69], v[184:185], v[184:185]
  v_pk_mul_f32 v[70:71], v[186:187], v[186:187]
  v_pk_fma_f32 v[72:73], v[64:65], s[86:87], s[86:87] op_sel:[0,1,0] op_sel_hi:[1,1,0]
  v_pk_fma_f32 v[74:75], v[66:67], s[86:87], s[86:87] op_sel:[0,1,0] op_sel_hi:[1,1,0]
  v_pk_fma_f32 v[76:77], v[68:69], s[86:87], s[86:87] op_sel:[0,1,0] op_sel_hi:[1,1,0]
  v_pk_fma_f32 v[78:79], v[70:71], s[86:87], s[86:87] op_sel:[0,1,0] op_sel_hi:[1,1,0]
  v_pk_fma_f32 v[72:73], v[72:73], v[64:65], s[84:85] op_sel:[0,0,1] op_sel_hi:[1,1,1]
  v_pk_fma_f32 v[74:75], v[74:75], v[66:67], s[84:85] op_sel:[0,0,1] op_sel_hi:[1,1,1]
  v_pk_fma_f32 v[76:77], v[76:77], v[68:69], s[84:85] op_sel:[0,0,1] op_sel_hi:[1,1,1]
  v_pk_fma_f32 v[78:79], v[78:79], v[70:71], s[84:85] op_sel:[0,0,1] op_sel_hi:[1,1,1]
  v_pk_fma_f32 v[72:73], v[72:73], v[64:65], s[84:85] op_sel:[0,0,0] op_sel_hi:[1,1,0]
  v_pk_fma_f32 v[74:75], v[74:75], v[66:67], s[84:85] op_sel:[0,0,0] op_sel_hi:[1,1,0]
  v_pk_fma_f32 v[76:77], v[76:77], v[68:69], s[84:85] op_sel:[0,0,0] op_sel_hi:[1,1,0]
  v_pk_fma_f32 v[78:79], v[78:79], v[70:71], s[84:85] op_sel:[0,0,0] op_sel_hi:[1,1,0]
  v_pk_fma_f32 v[72:73], v[72:73], v[64:65], s[82:83] op_sel:[0,0,1] op_sel_hi:[1,1,1]
  v_pk_fma_f32 v[74:75], v[74:75], v[66:67], s[82:83] op_sel:[0,0,1] op_sel_hi:[1,1,1]
  v_pk_fma_f32 v[76:77], v[76:77], v[68:69], s[82:83] op_sel:[0,0,1] op_sel_hi:[1,1,1]
  v_pk_fma_f32 v[78:79], v[78:79], v[70:71], s[82:83] op_sel:[0,0,1] op_sel_hi:[1,1,1]
  v_pk_fma_f32 v[72:73], v[72:73], v[64:65], s[82:83] op_sel:[0,0,0] op_sel_hi:[1,1,0]
  v_pk_fma_f32 v[74:75], v[74:75], v[66:67], s[82:83] op_sel:[0,0,0] op_sel_hi:[1,1,0]
  v_pk_fma_f32 v[76:77], v[76:77], v[68:69], s[82:83] op_sel:[0,0,0] op_sel_hi:[1,1,0]
  v_pk_fma_f32 v[78:79], v[78:79], v[70:71], s[82:83] op_sel:[0,0,0] op_sel_hi:[1,1,0]
  v_pk_fma_f32 v[72:73], v[72:73], v[64:65], s[80:81] op_sel:[0,0,1] op_sel_hi:[1,1,1]
  v_pk_fma_f32 v[74:75], v[74:75], v[66:67], s[80:81] op_sel:[0,0,1] op_sel_hi:[1,1,1]
  v_pk_fma_f32 v[76:77], v[76:77], v[68:69], s[80:81] op_sel:[0,0,1] op_sel_hi:[1,1,1]
  v_pk_fma_f32 v[78:79], v[78:79], v[70:71], s[80:81] op_sel:[0,0,1] op_sel_hi:[1,1,1]
  v_pk_fma_f32 v[72:73], v[72:73], v[176:177], s[80:81] op_sel_hi:[1,1,0] clamp
  v_pk_fma_f32 v[74:75], v[74:75], v[178:179], s[80:81] op_sel_hi:[1,1,0] clamp
  v_pk_fma_f32 v[76:77], v[76:77], v[184:185], s[80:81] op_sel_hi:[1,1,0] clamp
  v_pk_fma_f32 v[78:79], v[78:79], v[186:187], s[80:81] op_sel_hi:[1,1,0] clamp
  v_pk_mul_f32 v[64:65], v[72:73], v[176:177]
  v_pk_mul_f32 v[66:67], v[74:75], v[178:179]
  v_pk_mul_f32 v[68:69], v[76:77], v[184:185]
  v_pk_mul_f32 v[70:71], v[78:79], v[186:187]
  v_cvt_pk_bf16_f32 v84, v64, v65
  v_cvt_pk_bf16_f32 v85, v66, v67
  v_cvt_pk_bf16_f32 v86, v68, v69
  v_cvt_pk_bf16_f32 v87, v70, v71
  buffer_store_dwordx4 v[84:87], v5, s[12:15], s24 offen offset:1024 sc1
  v_pk_fma_f32 v[192:193], v[48:49], v[242:243], v[192:193] op_sel:[0,0,0] op_sel_hi:[1,0,1]
  v_pk_fma_f32 v[194:195], v[50:51], v[242:243], v[194:195] op_sel:[0,0,0] op_sel_hi:[1,0,1]
  v_pk_fma_f32 v[200:201], v[52:53], v[242:243], v[200:201] op_sel:[0,0,0] op_sel_hi:[1,0,1]
  v_pk_fma_f32 v[202:203], v[54:55], v[242:243], v[202:203] op_sel:[0,0,0] op_sel_hi:[1,0,1]
  v_pk_mul_f32 v[192:193], v[192:193], v[242:243] op_sel:[0,1] op_sel_hi:[1,1]
  v_pk_mul_f32 v[194:195], v[194:195], v[242:243] op_sel:[0,1] op_sel_hi:[1,1]
  v_pk_mul_f32 v[200:201], v[200:201], v[242:243] op_sel:[0,1] op_sel_hi:[1,1]
  v_pk_mul_f32 v[202:203], v[202:203], v[242:243] op_sel:[0,1] op_sel_hi:[1,1]
  v_pk_mul_f32 v[64:65], v[192:193], v[192:193]
  v_pk_mul_f32 v[66:67], v[194:195], v[194:195]
  v_pk_mul_f32 v[68:69], v[200:201], v[200:201]
  v_pk_mul_f32 v[70:71], v[202:203], v[202:203]
  v_pk_fma_f32 v[72:73], v[64:65], s[86:87], s[86:87] op_sel:[0,1,0] op_sel_hi:[1,1,0]
  v_pk_fma_f32 v[74:75], v[66:67], s[86:87], s[86:87] op_sel:[0,1,0] op_sel_hi:[1,1,0]
  v_pk_fma_f32 v[76:77], v[68:69], s[86:87], s[86:87] op_sel:[0,1,0] op_sel_hi:[1,1,0]
  v_pk_fma_f32 v[78:79], v[70:71], s[86:87], s[86:87] op_sel:[0,1,0] op_sel_hi:[1,1,0]
  v_pk_fma_f32 v[72:73], v[72:73], v[64:65], s[84:85] op_sel:[0,0,1] op_sel_hi:[1,1,1]
  v_pk_fma_f32 v[74:75], v[74:75], v[66:67], s[84:85] op_sel:[0,0,1] op_sel_hi:[1,1,1]
  v_pk_fma_f32 v[76:77], v[76:77], v[68:69], s[84:85] op_sel:[0,0,1] op_sel_hi:[1,1,1]
  v_pk_fma_f32 v[78:79], v[78:79], v[70:71], s[84:85] op_sel:[0,0,1] op_sel_hi:[1,1,1]
  v_pk_fma_f32 v[72:73], v[72:73], v[64:65], s[84:85] op_sel:[0,0,0] op_sel_hi:[1,1,0]
  v_pk_fma_f32 v[74:75], v[74:75], v[66:67], s[84:85] op_sel:[0,0,0] op_sel_hi:[1,1,0]
  v_pk_fma_f32 v[76:77], v[76:77], v[68:69], s[84:85] op_sel:[0,0,0] op_sel_hi:[1,1,0]
  v_pk_fma_f32 v[78:79], v[78:79], v[70:71], s[84:85] op_sel:[0,0,0] op_sel_hi:[1,1,0]
  v_pk_fma_f32 v[72:73], v[72:73], v[64:65], s[82:83] op_sel:[0,0,1] op_sel_hi:[1,1,1]
  v_pk_fma_f32 v[74:75], v[74:75], v[66:67], s[82:83] op_sel:[0,0,1] op_sel_hi:[1,1,1]
  v_pk_fma_f32 v[76:77], v[76:77], v[68:69], s[82:83] op_sel:[0,0,1] op_sel_hi:[1,1,1]
  v_pk_fma_f32 v[78:79], v[78:79], v[70:71], s[82:83] op_sel:[0,0,1] op_sel_hi:[1,1,1]
  v_pk_fma_f32 v[72:73], v[72:73], v[64:65], s[82:83] op_sel:[0,0,0] op_sel_hi:[1,1,0]
  v_pk_fma_f32 v[74:75], v[74:75], v[66:67], s[82:83] op_sel:[0,0,0] op_sel_hi:[1,1,0]
  v_pk_fma_f32 v[76:77], v[76:77], v[68:69], s[82:83] op_sel:[0,0,0] op_sel_hi:[1,1,0]
  v_pk_fma_f32 v[78:79], v[78:79], v[70:71], s[82:83] op_sel:[0,0,0] op_sel_hi:[1,1,0]
  v_pk_fma_f32 v[72:73], v[72:73], v[64:65], s[80:81] op_sel:[0,0,1] op_sel_hi:[1,1,1]
  v_pk_fma_f32 v[74:75], v[74:75], v[66:67], s[80:81] op_sel:[0,0,1] op_sel_hi:[1,1,1]
  v_pk_fma_f32 v[76:77], v[76:77], v[68:69], s[80:81] op_sel:[0,0,1] op_sel_hi:[1,1,1]
  v_pk_fma_f32 v[78:79], v[78:79], v[70:71], s[80:81] op_sel:[0,0,1] op_sel_hi:[1,1,1]
  v_pk_fma_f32 v[72:73], v[72:73], v[192:193], s[80:81] op_sel_hi:[1,1,0] clamp
  v_pk_fma_f32 v[74:75], v[74:75], v[194:195], s[80:81] op_sel_hi:[1,1,0] clamp
  v_pk_fma_f32 v[76:77], v[76:77], v[200:201], s[80:81] op_sel_hi:[1,1,0] clamp
  v_pk_fma_f32 v[78:79], v[78:79], v[202:203], s[80:81] op_sel_hi:[1,1,0] clamp
  v_pk_mul_f32 v[64:65], v[72:73], v[192:193]
  v_pk_mul_f32 v[66:67], v[74:75], v[194:195]
  v_pk_mul_f32 v[68:69], v[76:77], v[200:201]
  v_pk_mul_f32 v[70:71], v[78:79], v[202:203]
  v_cvt_pk_bf16_f32 v88, v64, v65
  v_cvt_pk_bf16_f32 v89, v66, v67
  v_cvt_pk_bf16_f32 v90, v68, v69
  v_cvt_pk_bf16_f32 v91, v70, v71
  buffer_store_dwordx4 v[88:91], v5, s[12:15], s24 offen offset:2048 sc1
  v_pk_fma_f32 v[208:209], v[56:57], v[242:243], v[208:209] op_sel:[0,0,0] op_sel_hi:[1,0,1]
  v_pk_fma_f32 v[210:211], v[58:59], v[242:243], v[210:211] op_sel:[0,0,0] op_sel_hi:[1,0,1]
  v_pk_fma_f32 v[216:217], v[60:61], v[242:243], v[216:217] op_sel:[0,0,0] op_sel_hi:[1,0,1]
  v_pk_fma_f32 v[218:219], v[62:63], v[242:243], v[218:219] op_sel:[0,0,0] op_sel_hi:[1,0,1]
  v_pk_mul_f32 v[208:209], v[208:209], v[242:243] op_sel:[0,1] op_sel_hi:[1,1]
  v_pk_mul_f32 v[210:211], v[210:211], v[242:243] op_sel:[0,1] op_sel_hi:[1,1]
  v_pk_mul_f32 v[216:217], v[216:217], v[242:243] op_sel:[0,1] op_sel_hi:[1,1]
  v_pk_mul_f32 v[218:219], v[218:219], v[242:243] op_sel:[0,1] op_sel_hi:[1,1]
  v_pk_mul_f32 v[64:65], v[208:209], v[208:209]
  v_pk_mul_f32 v[66:67], v[210:211], v[210:211]
  v_pk_mul_f32 v[68:69], v[216:217], v[216:217]
  v_pk_mul_f32 v[70:71], v[218:219], v[218:219]
  v_pk_fma_f32 v[72:73], v[64:65], s[86:87], s[86:87] op_sel:[0,1,0] op_sel_hi:[1,1,0]
  v_pk_fma_f32 v[74:75], v[66:67], s[86:87], s[86:87] op_sel:[0,1,0] op_sel_hi:[1,1,0]
  v_pk_fma_f32 v[76:77], v[68:69], s[86:87], s[86:87] op_sel:[0,1,0] op_sel_hi:[1,1,0]
  v_pk_fma_f32 v[78:79], v[70:71], s[86:87], s[86:87] op_sel:[0,1,0] op_sel_hi:[1,1,0]
  v_pk_fma_f32 v[72:73], v[72:73], v[64:65], s[84:85] op_sel:[0,0,1] op_sel_hi:[1,1,1]
  v_pk_fma_f32 v[74:75], v[74:75], v[66:67], s[84:85] op_sel:[0,0,1] op_sel_hi:[1,1,1]
  v_pk_fma_f32 v[76:77], v[76:77], v[68:69], s[84:85] op_sel:[0,0,1] op_sel_hi:[1,1,1]
  v_pk_fma_f32 v[78:79], v[78:79], v[70:71], s[84:85] op_sel:[0,0,1] op_sel_hi:[1,1,1]
  v_pk_fma_f32 v[72:73], v[72:73], v[64:65], s[84:85] op_sel:[0,0,0] op_sel_hi:[1,1,0]
  v_pk_fma_f32 v[74:75], v[74:75], v[66:67], s[84:85] op_sel:[0,0,0] op_sel_hi:[1,1,0]
  v_pk_fma_f32 v[76:77], v[76:77], v[68:69], s[84:85] op_sel:[0,0,0] op_sel_hi:[1,1,0]
  v_pk_fma_f32 v[78:79], v[78:79], v[70:71], s[84:85] op_sel:[0,0,0] op_sel_hi:[1,1,0]
  v_pk_fma_f32 v[72:73], v[72:73], v[64:65], s[82:83] op_sel:[0,0,1] op_sel_hi:[1,1,1]
  v_pk_fma_f32 v[74:75], v[74:75], v[66:67], s[82:83] op_sel:[0,0,1] op_sel_hi:[1,1,1]
  v_pk_fma_f32 v[76:77], v[76:77], v[68:69], s[82:83] op_sel:[0,0,1] op_sel_hi:[1,1,1]
  v_pk_fma_f32 v[78:79], v[78:79], v[70:71], s[82:83] op_sel:[0,0,1] op_sel_hi:[1,1,1]
  v_pk_fma_f32 v[72:73], v[72:73], v[64:65], s[82:83] op_sel:[0,0,0] op_sel_hi:[1,1,0]
  v_pk_fma_f32 v[74:75], v[74:75], v[66:67], s[82:83] op_sel:[0,0,0] op_sel_hi:[1,1,0]
  v_pk_fma_f32 v[76:77], v[76:77], v[68:69], s[82:83] op_sel:[0,0,0] op_sel_hi:[1,1,0]
  v_pk_fma_f32 v[78:79], v[78:79], v[70:71], s[82:83] op_sel:[0,0,0] op_sel_hi:[1,1,0]
  v_pk_fma_f32 v[72:73], v[72:73], v[64:65], s[80:81] op_sel:[0,0,1] op_sel_hi:[1,1,1]
  v_pk_fma_f32 v[74:75], v[74:75], v[66:67], s[80:81] op_sel:[0,0,1] op_sel_hi:[1,1,1]
  v_pk_fma_f32 v[76:77], v[76:77], v[68:69], s[80:81] op_sel:[0,0,1] op_sel_hi:[1,1,1]
  v_pk_fma_f32 v[78:79], v[78:79], v[70:71], s[80:81] op_sel:[0,0,1] op_sel_hi:[1,1,1]
  v_pk_fma_f32 v[72:73], v[72:73], v[208:209], s[80:81] op_sel_hi:[1,1,0] clamp
  v_pk_fma_f32 v[74:75], v[74:75], v[210:211], s[80:81] op_sel_hi:[1,1,0] clamp
  v_pk_fma_f32 v[76:77], v[76:77], v[216:217], s[80:81] op_sel_hi:[1,1,0] clamp
  v_pk_fma_f32 v[78:79], v[78:79], v[218:219], s[80:81] op_sel_hi:[1,1,0] clamp
  v_pk_mul_f32 v[64:65], v[72:73], v[208:209]
  v_pk_mul_f32 v[66:67], v[74:75], v[210:211]
  v_pk_mul_f32 v[68:69], v[76:77], v[216:217]
  v_pk_mul_f32 v[70:71], v[78:79], v[218:219]
  v_cvt_pk_bf16_f32 v92, v64, v65
  v_cvt_pk_bf16_f32 v93, v66, v67
  v_cvt_pk_bf16_f32 v94, v68, v69
  v_cvt_pk_bf16_f32 v95, v70, v71
  buffer_store_dwordx4 v[92:95], v5, s[12:15], s24 offen offset:3072 sc1
  s_add_u32 s24, s24, 57344
  v_pk_fma_f32 v[164:165], v[32:33], v[246:247], v[164:165] op_sel:[0,0,0] op_sel_hi:[1,0,1]
  v_pk_fma_f32 v[166:167], v[34:35], v[246:247], v[166:167] op_sel:[0,0,0] op_sel_hi:[1,0,1]
  v_pk_fma_f32 v[172:173], v[36:37], v[246:247], v[172:173] op_sel:[0,0,0] op_sel_hi:[1,0,1]
  v_pk_fma_f32 v[174:175], v[38:39], v[246:247], v[174:175] op_sel:[0,0,0] op_sel_hi:[1,0,1]
  v_pk_mul_f32 v[164:165], v[164:165], v[246:247] op_sel:[0,1] op_sel_hi:[1,1]
  v_pk_mul_f32 v[166:167], v[166:167], v[246:247] op_sel:[0,1] op_sel_hi:[1,1]
  v_pk_mul_f32 v[172:173], v[172:173], v[246:247] op_sel:[0,1] op_sel_hi:[1,1]
  v_pk_mul_f32 v[174:175], v[174:175], v[246:247] op_sel:[0,1] op_sel_hi:[1,1]
  v_pk_mul_f32 v[64:65], v[164:165], v[164:165]
  v_pk_mul_f32 v[66:67], v[166:167], v[166:167]
  v_pk_mul_f32 v[68:69], v[172:173], v[172:173]
  v_pk_mul_f32 v[70:71], v[174:175], v[174:175]
  v_pk_fma_f32 v[72:73], v[64:65], s[86:87], s[86:87] op_sel:[0,1,0] op_sel_hi:[1,1,0]
  v_pk_fma_f32 v[74:75], v[66:67], s[86:87], s[86:87] op_sel:[0,1,0] op_sel_hi:[1,1,0]
  v_pk_fma_f32 v[76:77], v[68:69], s[86:87], s[86:87] op_sel:[0,1,0] op_sel_hi:[1,1,0]
  v_pk_fma_f32 v[78:79], v[70:71], s[86:87], s[86:87] op_sel:[0,1,0] op_sel_hi:[1,1,0]
  v_pk_fma_f32 v[72:73], v[72:73], v[64:65], s[84:85] op_sel:[0,0,1] op_sel_hi:[1,1,1]
  v_pk_fma_f32 v[74:75], v[74:75], v[66:67], s[84:85] op_sel:[0,0,1] op_sel_hi:[1,1,1]
  v_pk_fma_f32 v[76:77], v[76:77], v[68:69], s[84:85] op_sel:[0,0,1] op_sel_hi:[1,1,1]
  v_pk_fma_f32 v[78:79], v[78:79], v[70:71], s[84:85] op_sel:[0,0,1] op_sel_hi:[1,1,1]
  v_pk_fma_f32 v[72:73], v[72:73], v[64:65], s[84:85] op_sel:[0,0,0] op_sel_hi:[1,1,0]
  v_pk_fma_f32 v[74:75], v[74:75], v[66:67], s[84:85] op_sel:[0,0,0] op_sel_hi:[1,1,0]
  v_pk_fma_f32 v[76:77], v[76:77], v[68:69], s[84:85] op_sel:[0,0,0] op_sel_hi:[1,1,0]
  v_pk_fma_f32 v[78:79], v[78:79], v[70:71], s[84:85] op_sel:[0,0,0] op_sel_hi:[1,1,0]
  v_pk_fma_f32 v[72:73], v[72:73], v[64:65], s[82:83] op_sel:[0,0,1] op_sel_hi:[1,1,1]
  v_pk_fma_f32 v[74:75], v[74:75], v[66:67], s[82:83] op_sel:[0,0,1] op_sel_hi:[1,1,1]
  v_pk_fma_f32 v[76:77], v[76:77], v[68:69], s[82:83] op_sel:[0,0,1] op_sel_hi:[1,1,1]
  v_pk_fma_f32 v[78:79], v[78:79], v[70:71], s[82:83] op_sel:[0,0,1] op_sel_hi:[1,1,1]
  v_pk_fma_f32 v[72:73], v[72:73], v[64:65], s[82:83] op_sel:[0,0,0] op_sel_hi:[1,1,0]
  v_pk_fma_f32 v[74:75], v[74:75], v[66:67], s[82:83] op_sel:[0,0,0] op_sel_hi:[1,1,0]
  v_pk_fma_f32 v[76:77], v[76:77], v[68:69], s[82:83] op_sel:[0,0,0] op_sel_hi:[1,1,0]
  v_pk_fma_f32 v[78:79], v[78:79], v[70:71], s[82:83] op_sel:[0,0,0] op_sel_hi:[1,1,0]
  v_pk_fma_f32 v[72:73], v[72:73], v[64:65], s[80:81] op_sel:[0,0,1] op_sel_hi:[1,1,1]
  v_pk_fma_f32 v[74:75], v[74:75], v[66:67], s[80:81] op_sel:[0,0,1] op_sel_hi:[1,1,1]
  v_pk_fma_f32 v[76:77], v[76:77], v[68:69], s[80:81] op_sel:[0,0,1] op_sel_hi:[1,1,1]
  v_pk_fma_f32 v[78:79], v[78:79], v[70:71], s[80:81] op_sel:[0,0,1] op_sel_hi:[1,1,1]
  v_pk_fma_f32 v[72:73], v[72:73], v[164:165], s[80:81] op_sel_hi:[1,1,0] clamp
  v_pk_fma_f32 v[74:75], v[74:75], v[166:167], s[80:81] op_sel_hi:[1,1,0] clamp
  v_pk_fma_f32 v[76:77], v[76:77], v[172:173], s[80:81] op_sel_hi:[1,1,0] clamp
  v_pk_fma_f32 v[78:79], v[78:79], v[174:175], s[80:81] op_sel_hi:[1,1,0] clamp
  v_pk_mul_f32 v[64:65], v[72:73], v[164:165]
  v_pk_mul_f32 v[66:67], v[74:75], v[166:167]
  v_pk_mul_f32 v[68:69], v[76:77], v[172:173]
  v_pk_mul_f32 v[70:71], v[78:79], v[174:175]
  v_cvt_pk_bf16_f32 v80, v64, v65
  v_cvt_pk_bf16_f32 v81, v66, v67
  v_cvt_pk_bf16_f32 v82, v68, v69
  v_cvt_pk_bf16_f32 v83, v70, v71
  buffer_store_dwordx4 v[80:83], v5, s[12:15], s24 offen offset:0 sc1
  v_pk_fma_f32 v[180:181], v[40:41], v[246:247], v[180:181] op_sel:[0,0,0] op_sel_hi:[1,0,1]
  v_pk_fma_f32 v[182:183], v[42:43], v[246:247], v[182:183] op_sel:[0,0,0] op_sel_hi:[1,0,1]
  v_pk_fma_f32 v[188:189], v[44:45], v[246:247], v[188:189] op_sel:[0,0,0] op_sel_hi:[1,0,1]
  v_pk_fma_f32 v[190:191], v[46:47], v[246:247], v[190:191] op_sel:[0,0,0] op_sel_hi:[1,0,1]
  v_pk_mul_f32 v[180:181], v[180:181], v[246:247] op_sel:[0,1] op_sel_hi:[1,1]
  v_pk_mul_f32 v[182:183], v[182:183], v[246:247] op_sel:[0,1] op_sel_hi:[1,1]
  v_pk_mul_f32 v[188:189], v[188:189], v[246:247] op_sel:[0,1] op_sel_hi:[1,1]
  v_pk_mul_f32 v[190:191], v[190:191], v[246:247] op_sel:[0,1] op_sel_hi:[1,1]
  v_pk_mul_f32 v[64:65], v[180:181], v[180:181]
  v_pk_mul_f32 v[66:67], v[182:183], v[182:183]
  v_pk_mul_f32 v[68:69], v[188:189], v[188:189]
  v_pk_mul_f32 v[70:71], v[190:191], v[190:191]
  v_pk_fma_f32 v[72:73], v[64:65], s[86:87], s[86:87] op_sel:[0,1,0] op_sel_hi:[1,1,0]
  v_pk_fma_f32 v[74:75], v[66:67], s[86:87], s[86:87] op_sel:[0,1,0] op_sel_hi:[1,1,0]
  v_pk_fma_f32 v[76:77], v[68:69], s[86:87], s[86:87] op_sel:[0,1,0] op_sel_hi:[1,1,0]
  v_pk_fma_f32 v[78:79], v[70:71], s[86:87], s[86:87] op_sel:[0,1,0] op_sel_hi:[1,1,0]
  v_pk_fma_f32 v[72:73], v[72:73], v[64:65], s[84:85] op_sel:[0,0,1] op_sel_hi:[1,1,1]
  v_pk_fma_f32 v[74:75], v[74:75], v[66:67], s[84:85] op_sel:[0,0,1] op_sel_hi:[1,1,1]
  v_pk_fma_f32 v[76:77], v[76:77], v[68:69], s[84:85] op_sel:[0,0,1] op_sel_hi:[1,1,1]
  v_pk_fma_f32 v[78:79], v[78:79], v[70:71], s[84:85] op_sel:[0,0,1] op_sel_hi:[1,1,1]
  v_pk_fma_f32 v[72:73], v[72:73], v[64:65], s[84:85] op_sel:[0,0,0] op_sel_hi:[1,1,0]
  v_pk_fma_f32 v[74:75], v[74:75], v[66:67], s[84:85] op_sel:[0,0,0] op_sel_hi:[1,1,0]
  v_pk_fma_f32 v[76:77], v[76:77], v[68:69], s[84:85] op_sel:[0,0,0] op_sel_hi:[1,1,0]
  v_pk_fma_f32 v[78:79], v[78:79], v[70:71], s[84:85] op_sel:[0,0,0] op_sel_hi:[1,1,0]
  v_pk_fma_f32 v[72:73], v[72:73], v[64:65], s[82:83] op_sel:[0,0,1] op_sel_hi:[1,1,1]
  v_pk_fma_f32 v[74:75], v[74:75], v[66:67], s[82:83] op_sel:[0,0,1] op_sel_hi:[1,1,1]
  v_pk_fma_f32 v[76:77], v[76:77], v[68:69], s[82:83] op_sel:[0,0,1] op_sel_hi:[1,1,1]
  v_pk_fma_f32 v[78:79], v[78:79], v[70:71], s[82:83] op_sel:[0,0,1] op_sel_hi:[1,1,1]
  v_pk_fma_f32 v[72:73], v[72:73], v[64:65], s[82:83] op_sel:[0,0,0] op_sel_hi:[1,1,0]
  v_pk_fma_f32 v[74:75], v[74:75], v[66:67], s[82:83] op_sel:[0,0,0] op_sel_hi:[1,1,0]
  v_pk_fma_f32 v[76:77], v[76:77], v[68:69], s[82:83] op_sel:[0,0,0] op_sel_hi:[1,1,0]
  v_pk_fma_f32 v[78:79], v[78:79], v[70:71], s[82:83] op_sel:[0,0,0] op_sel_hi:[1,1,0]
  v_pk_fma_f32 v[72:73], v[72:73], v[64:65], s[80:81] op_sel:[0,0,1] op_sel_hi:[1,1,1]
  v_pk_fma_f32 v[74:75], v[74:75], v[66:67], s[80:81] op_sel:[0,0,1] op_sel_hi:[1,1,1]
  v_pk_fma_f32 v[76:77], v[76:77], v[68:69], s[80:81] op_sel:[0,0,1] op_sel_hi:[1,1,1]
  v_pk_fma_f32 v[78:79], v[78:79], v[70:71], s[80:81] op_sel:[0,0,1] op_sel_hi:[1,1,1]
  v_pk_fma_f32 v[72:73], v[72:73], v[180:181], s[80:81] op_sel_hi:[1,1,0] clamp
  v_pk_fma_f32 v[74:75], v[74:75], v[182:183], s[80:81] op_sel_hi:[1,1,0] clamp
  v_pk_fma_f32 v[76:77], v[76:77], v[188:189], s[80:81] op_sel_hi:[1,1,0] clamp
  v_pk_fma_f32 v[78:79], v[78:79], v[190:191], s[80:81] op_sel_hi:[1,1,0] clamp
  v_pk_mul_f32 v[64:65], v[72:73], v[180:181]
  v_pk_mul_f32 v[66:67], v[74:75], v[182:183]
  v_pk_mul_f32 v[68:69], v[76:77], v[188:189]
  v_pk_mul_f32 v[70:71], v[78:79], v[190:191]
  v_cvt_pk_bf16_f32 v84, v64, v65
  v_cvt_pk_bf16_f32 v85, v66, v67
  v_cvt_pk_bf16_f32 v86, v68, v69
  v_cvt_pk_bf16_f32 v87, v70, v71
  buffer_store_dwordx4 v[84:87], v5, s[12:15], s24 offen offset:1024 sc1
  v_pk_fma_f32 v[196:197], v[48:49], v[246:247], v[196:197] op_sel:[0,0,0] op_sel_hi:[1,0,1]
  v_pk_fma_f32 v[198:199], v[50:51], v[246:247], v[198:199] op_sel:[0,0,0] op_sel_hi:[1,0,1]
  v_pk_fma_f32 v[204:205], v[52:53], v[246:247], v[204:205] op_sel:[0,0,0] op_sel_hi:[1,0,1]
  v_pk_fma_f32 v[206:207], v[54:55], v[246:247], v[206:207] op_sel:[0,0,0] op_sel_hi:[1,0,1]
  v_pk_mul_f32 v[196:197], v[196:197], v[246:247] op_sel:[0,1] op_sel_hi:[1,1]
  v_pk_mul_f32 v[198:199], v[198:199], v[246:247] op_sel:[0,1] op_sel_hi:[1,1]
  v_pk_mul_f32 v[204:205], v[204:205], v[246:247] op_sel:[0,1] op_sel_hi:[1,1]
  v_pk_mul_f32 v[206:207], v[206:207], v[246:247] op_sel:[0,1] op_sel_hi:[1,1]
  v_pk_mul_f32 v[64:65], v[196:197], v[196:197]
  v_pk_mul_f32 v[66:67], v[198:199], v[198:199]
  v_pk_mul_f32 v[68:69], v[204:205], v[204:205]
  v_pk_mul_f32 v[70:71], v[206:207], v[206:207]
  v_pk_fma_f32 v[72:73], v[64:65], s[86:87], s[86:87] op_sel:[0,1,0] op_sel_hi:[1,1,0]
  v_pk_fma_f32 v[74:75], v[66:67], s[86:87], s[86:87] op_sel:[0,1,0] op_sel_hi:[1,1,0]
  v_pk_fma_f32 v[76:77], v[68:69], s[86:87], s[86:87] op_sel:[0,1,0] op_sel_hi:[1,1,0]
  v_pk_fma_f32 v[78:79], v[70:71], s[86:87], s[86:87] op_sel:[0,1,0] op_sel_hi:[1,1,0]
  v_pk_fma_f32 v[72:73], v[72:73], v[64:65], s[84:85] op_sel:[0,0,1] op_sel_hi:[1,1,1]
  v_pk_fma_f32 v[74:75], v[74:75], v[66:67], s[84:85] op_sel:[0,0,1] op_sel_hi:[1,1,1]
  v_pk_fma_f32 v[76:77], v[76:77], v[68:69], s[84:85] op_sel:[0,0,1] op_sel_hi:[1,1,1]
  v_pk_fma_f32 v[78:79], v[78:79], v[70:71], s[84:85] op_sel:[0,0,1] op_sel_hi:[1,1,1]
  v_pk_fma_f32 v[72:73], v[72:73], v[64:65], s[84:85] op_sel:[0,0,0] op_sel_hi:[1,1,0]
  v_pk_fma_f32 v[74:75], v[74:75], v[66:67], s[84:85] op_sel:[0,0,0] op_sel_hi:[1,1,0]
  v_pk_fma_f32 v[76:77], v[76:77], v[68:69], s[84:85] op_sel:[0,0,0] op_sel_hi:[1,1,0]
  v_pk_fma_f32 v[78:79], v[78:79], v[70:71], s[84:85] op_sel:[0,0,0] op_sel_hi:[1,1,0]
  v_pk_fma_f32 v[72:73], v[72:73], v[64:65], s[82:83] op_sel:[0,0,1] op_sel_hi:[1,1,1]
  v_pk_fma_f32 v[74:75], v[74:75], v[66:67], s[82:83] op_sel:[0,0,1] op_sel_hi:[1,1,1]
  v_pk_fma_f32 v[76:77], v[76:77], v[68:69], s[82:83] op_sel:[0,0,1] op_sel_hi:[1,1,1]
  v_pk_fma_f32 v[78:79], v[78:79], v[70:71], s[82:83] op_sel:[0,0,1] op_sel_hi:[1,1,1]
  v_pk_fma_f32 v[72:73], v[72:73], v[64:65], s[82:83] op_sel:[0,0,0] op_sel_hi:[1,1,0]
  v_pk_fma_f32 v[74:75], v[74:75], v[66:67], s[82:83] op_sel:[0,0,0] op_sel_hi:[1,1,0]
  v_pk_fma_f32 v[76:77], v[76:77], v[68:69], s[82:83] op_sel:[0,0,0] op_sel_hi:[1,1,0]
  v_pk_fma_f32 v[78:79], v[78:79], v[70:71], s[82:83] op_sel:[0,0,0] op_sel_hi:[1,1,0]
  v_pk_fma_f32 v[72:73], v[72:73], v[64:65], s[80:81] op_sel:[0,0,1] op_sel_hi:[1,1,1]
  v_pk_fma_f32 v[74:75], v[74:75], v[66:67], s[80:81] op_sel:[0,0,1] op_sel_hi:[1,1,1]
  v_pk_fma_f32 v[76:77], v[76:77], v[68:69], s[80:81] op_sel:[0,0,1] op_sel_hi:[1,1,1]
  v_pk_fma_f32 v[78:79], v[78:79], v[70:71], s[80:81] op_sel:[0,0,1] op_sel_hi:[1,1,1]
  v_pk_fma_f32 v[72:73], v[72:73], v[196:197], s[80:81] op_sel_hi:[1,1,0] clamp
  v_pk_fma_f32 v[74:75], v[74:75], v[198:199], s[80:81] op_sel_hi:[1,1,0] clamp
  v_pk_fma_f32 v[76:77], v[76:77], v[204:205], s[80:81] op_sel_hi:[1,1,0] clamp
  v_pk_fma_f32 v[78:79], v[78:79], v[206:207], s[80:81] op_sel_hi:[1,1,0] clamp
  v_pk_mul_f32 v[64:65], v[72:73], v[196:197]
  v_pk_mul_f32 v[66:67], v[74:75], v[198:199]
  v_pk_mul_f32 v[68:69], v[76:77], v[204:205]
  v_pk_mul_f32 v[70:71], v[78:79], v[206:207]
  v_cvt_pk_bf16_f32 v88, v64, v65
  v_cvt_pk_bf16_f32 v89, v66, v67
  v_cvt_pk_bf16_f32 v90, v68, v69
  v_cvt_pk_bf16_f32 v91, v70, v71
  buffer_store_dwordx4 v[88:91], v5, s[12:15], s24 offen offset:2048 sc1
  v_pk_fma_f32 v[212:213], v[56:57], v[246:247], v[212:213] op_sel:[0,0,0] op_sel_hi:[1,0,1]
  v_pk_fma_f32 v[214:215], v[58:59], v[246:247], v[214:215] op_sel:[0,0,0] op_sel_hi:[1,0,1]
  v_pk_fma_f32 v[220:221], v[60:61], v[246:247], v[220:221] op_sel:[0,0,0] op_sel_hi:[1,0,1]
  v_pk_fma_f32 v[222:223], v[62:63], v[246:247], v[222:223] op_sel:[0,0,0] op_sel_hi:[1,0,1]
  v_pk_mul_f32 v[212:213], v[212:213], v[246:247] op_sel:[0,1] op_sel_hi:[1,1]
  v_pk_mul_f32 v[214:215], v[214:215], v[246:247] op_sel:[0,1] op_sel_hi:[1,1]
  v_pk_mul_f32 v[220:221], v[220:221], v[246:247] op_sel:[0,1] op_sel_hi:[1,1]
  v_pk_mul_f32 v[222:223], v[222:223], v[246:247] op_sel:[0,1] op_sel_hi:[1,1]
  v_pk_mul_f32 v[64:65], v[212:213], v[212:213]
  v_pk_mul_f32 v[66:67], v[214:215], v[214:215]
  v_pk_mul_f32 v[68:69], v[220:221], v[220:221]
  v_pk_mul_f32 v[70:71], v[222:223], v[222:223]
  v_pk_fma_f32 v[72:73], v[64:65], s[86:87], s[86:87] op_sel:[0,1,0] op_sel_hi:[1,1,0]
  v_pk_fma_f32 v[74:75], v[66:67], s[86:87], s[86:87] op_sel:[0,1,0] op_sel_hi:[1,1,0]
  v_pk_fma_f32 v[76:77], v[68:69], s[86:87], s[86:87] op_sel:[0,1,0] op_sel_hi:[1,1,0]
  v_pk_fma_f32 v[78:79], v[70:71], s[86:87], s[86:87] op_sel:[0,1,0] op_sel_hi:[1,1,0]
  v_pk_fma_f32 v[72:73], v[72:73], v[64:65], s[84:85] op_sel:[0,0,1] op_sel_hi:[1,1,1]
  v_pk_fma_f32 v[74:75], v[74:75], v[66:67], s[84:85] op_sel:[0,0,1] op_sel_hi:[1,1,1]
  v_pk_fma_f32 v[76:77], v[76:77], v[68:69], s[84:85] op_sel:[0,0,1] op_sel_hi:[1,1,1]
  v_pk_fma_f32 v[78:79], v[78:79], v[70:71], s[84:85] op_sel:[0,0,1] op_sel_hi:[1,1,1]
  v_pk_fma_f32 v[72:73], v[72:73], v[64:65], s[84:85] op_sel:[0,0,0] op_sel_hi:[1,1,0]
  v_pk_fma_f32 v[74:75], v[74:75], v[66:67], s[84:85] op_sel:[0,0,0] op_sel_hi:[1,1,0]
  v_pk_fma_f32 v[76:77], v[76:77], v[68:69], s[84:85] op_sel:[0,0,0] op_sel_hi:[1,1,0]
  v_pk_fma_f32 v[78:79], v[78:79], v[70:71], s[84:85] op_sel:[0,0,0] op_sel_hi:[1,1,0]
  v_pk_fma_f32 v[72:73], v[72:73], v[64:65], s[82:83] op_sel:[0,0,1] op_sel_hi:[1,1,1]
  v_pk_fma_f32 v[74:75], v[74:75], v[66:67], s[82:83] op_sel:[0,0,1] op_sel_hi:[1,1,1]
  v_pk_fma_f32 v[76:77], v[76:77], v[68:69], s[82:83] op_sel:[0,0,1] op_sel_hi:[1,1,1]
  v_pk_fma_f32 v[78:79], v[78:79], v[70:71], s[82:83] op_sel:[0,0,1] op_sel_hi:[1,1,1]
  v_pk_fma_f32 v[72:73], v[72:73], v[64:65], s[82:83] op_sel:[0,0,0] op_sel_hi:[1,1,0]
  v_pk_fma_f32 v[74:75], v[74:75], v[66:67], s[82:83] op_sel:[0,0,0] op_sel_hi:[1,1,0]
  v_pk_fma_f32 v[76:77], v[76:77], v[68:69], s[82:83] op_sel:[0,0,0] op_sel_hi:[1,1,0]
  v_pk_fma_f32 v[78:79], v[78:79], v[70:71], s[82:83] op_sel:[0,0,0] op_sel_hi:[1,1,0]
  v_pk_fma_f32 v[72:73], v[72:73], v[64:65], s[80:81] op_sel:[0,0,1] op_sel_hi:[1,1,1]
  v_pk_fma_f32 v[74:75], v[74:75], v[66:67], s[80:81] op_sel:[0,0,1] op_sel_hi:[1,1,1]
  v_pk_fma_f32 v[76:77], v[76:77], v[68:69], s[80:81] op_sel:[0,0,1] op_sel_hi:[1,1,1]
  v_pk_fma_f32 v[78:79], v[78:79], v[70:71], s[80:81] op_sel:[0,0,1] op_sel_hi:[1,1,1]
  v_pk_fma_f32 v[72:73], v[72:73], v[212:213], s[80:81] op_sel_hi:[1,1,0] clamp
  v_pk_fma_f32 v[74:75], v[74:75], v[214:215], s[80:81] op_sel_hi:[1,1,0] clamp
  v_pk_fma_f32 v[76:77], v[76:77], v[220:221], s[80:81] op_sel_hi:[1,1,0] clamp
  v_pk_fma_f32 v[78:79], v[78:79], v[222:223], s[80:81] op_sel_hi:[1,1,0] clamp
  v_pk_mul_f32 v[64:65], v[72:73], v[212:213]
  v_pk_mul_f32 v[66:67], v[74:75], v[214:215]
  v_pk_mul_f32 v[68:69], v[76:77], v[220:221]
  v_pk_mul_f32 v[70:71], v[78:79], v[222:223]
  v_cvt_pk_bf16_f32 v92, v64, v65
  v_cvt_pk_bf16_f32 v93, v66, v67
  v_cvt_pk_bf16_f32 v94, v68, v69
  v_cvt_pk_bf16_f32 v95, v70, v71
  buffer_store_dwordx4 v[92:95], v5, s[12:15], s24 offen offset:3072 sc1
  s_lshl_b32 s18, s32, 4
  s_add_u32 s18, s18, s33
  s_lshl_b32 s18, s18, 2
  s_lshl_b32 s31, s18, 2
  v_mov_b32 v1, 14049280
  v_mov_b32 v3, 14090240
  v_mov_b32 v2, s93
  s_mov_b64 exec, 1
  s_waitcnt vmcnt(0)
  buffer_store_dword v2, v1, s[12:15], s18 offen
  buffer_store_dword v2, v3, s[12:15], s31 offen sc1
  s_mov_b64 exec, -1
L_c_g4:
  s_xor_b32 s18, s5, 0
  s_mul_i32 s18, s18, 40960
  v_add_u32 v12, s18, v5
  s_mov_b32 s27, s18
  s_xor_b32 s18, s5, 1
  s_mul_i32 s18, s18, 40960
  v_add_u32 v13, s18, v5
  s_xor_b32 s18, s5, 2
  s_mul_i32 s18, s18, 40960
  v_add_u32 v14, s18, v5
  s_xor_b32 s18, s5, 3
  s_mul_i32 s18, s18, 40960
  v_add_u32 v15, s18, v5
  s_lshl_b32 s24, s21, 1
  v_lshrrev_b32 v1, 2, v0
  v_lshlrev_b32 v1, 7, v1
  v_and_b32 v2, 3, v0
  v_lshl_add_u32 v1, v2, 3, v1
  v_bfe_u32 v2, v0, 3, 2
  v_xor_b32 v2, s24, v2
  v_add_u32 v1, s27, v1
  v_lshl_add_u32 v8, v2, 5, v1
  v_xor_b32 v9, 32, v8
  v_xor_b32 v10, 64, v8
  v_xor_b32 v11, 96, v8
  s_lshl_b32 s18, s19, 2
  s_lshl_b32 s24, s22, 1
  s_add_u32 s18, s18, s24
  s_mul_i32 s40, s18, 57344
  s_xor_b32 s18, s18, 2
  s_mul_i32 s42, s18, 57344
  s_mul_i32 s18, s5, 14336
  s_add_u32 s18, s18, 6291456
  s_add_u32 s40, s40, s18
  s_add_u32 s42, s42, s18
  s_add_u32 s41, s40, 57344
  s_add_u32 s43, s42, 57344
  s_barrier
  ds_read_b64_tr_b16 v[32:33], v8 offset:0
  ds_read_b64_tr_b16 v[34:35], v8 offset:2048
  ds_read_b64_tr_b16 v[36:37], v9 offset:0
  ds_read_b64_tr_b16 v[38:39], v9 offset:2048
  ds_read_b64_tr_b16 v[40:41], v10 offset:0
  ds_read_b64_tr_b16 v[42:43], v10 offset:2048
  ds_read_b64_tr_b16 v[44:45], v11 offset:0
  ds_read_b64_tr_b16 v[46:47], v11 offset:2048
  s_lshl_b32 s18, s19, 5
  s_mul_i32 s24, s5, 7
  s_lshr_b32 s24, s24, 1
  s_add_u32 s18, s18, s24
  v_lshrrev_b32 v1, 2, v0
  v_and_b32 v2, 3, v0
  v_lshl_add_u32 v1, v1, 4, v2
  v_add_u32 v1, s18, v1
  v_lshlrev_b32 v2, 4, v1
  v_add_u32 v2, 14090240, v2
  v_lshlrev_b32 v1, 2, v1
  v_add_u32 v1, 14049280, v1
  s_cmp_eq_u32 s1, 0
  s_cselect_b64 vcc, 0, -1
  v_cndmask_b32 v1, v1, v2, vcc
  s_mov_b32 exec_lo, 0xff
  s_mov_b32 exec_hi, 0
  s_mov_b32 s30, 0
L_poll_25:
  buffer_load_dword v100, v1, s[12:15], 0 offen sc1
  s_add_u32 s30, s30, 1
  s_waitcnt vmcnt(0)
  v_cmp_ne_u32 vcc, s93, v100
  s_cbranch_vccz L_polld_26
  s_cmp_lt_u32 s30, 100000
  s_cbranch_scc1 L_poll_25
L_polld_26:
  s_mov_b64 exec, -1
  buffer_load_dwordx4 v[64:67], v5, s[12:15], s40 offen offset:0
  buffer_load_dwordx4 v[68:71], v5, s[12:15], s41 offen offset:0
  buffer_load_dwordx4 v[72:75], v5, s[12:15], s42 offen offset:0
  buffer_load_dwordx4 v[76:79], v5, s[12:15], s43 offen offset:0
  buffer_load_dwordx4 v[80:83], v5, s[12:15], s40 offen offset:1024
  buffer_load_dwordx4 v[84:87], v5, s[12:15], s41 offen offset:1024
  buffer_load_dwordx4 v[88:91], v5, s[12:15], s42 offen offset:1024
  buffer_load_dwordx4 v[92:95], v5, s[12:15], s43 offen offset:1024
  buffer_load_dwordx4 v[96:99], v5, s[12:15], s40 offen offset:2048
  buffer_load_dwordx4 v[100:103], v5, s[12:15], s41 offen offset:2048
  buffer_load_dwordx4 v[104:107], v5, s[12:15], s42 offen offset:2048
  buffer_load_dwordx4 v[108:111], v5, s[12:15], s43 offen offset:2048
  buffer_load_dwordx4 v[112:115], v5, s[12:15], s40 offen offset:3072
  s_add_u32 s40, s40, 4096
  buffer_load_dwordx4 v[116:119], v5, s[12:15], s41 offen offset:3072
  s_add_u32 s41, s41, 4096
  buffer_load_dwordx4 v[120:123], v5, s[12:15], s42 offen offset:3072
  s_add_u32 s42, s42, 4096
  buffer_load_dwordx4 v[124:127], v5, s[12:15], s43 offen offset:3072
  s_add_u32 s43, s43, 4096
  buffer_load_dwordx4 v[128:131], v5, s[12:15], s40 offen offset:0
  buffer_load_dwordx4 v[132:135], v5, s[12:15], s41 offen offset:0
  buffer_load_dwordx4 v[136:139], v5, s[12:15], s42 offen offset:0
  buffer_load_dwordx4 v[140:143], v5, s[12:15], s43 offen offset:0
  buffer_load_dwordx4 v[144:147], v5, s[12:15], s40 offen offset:1024
  buffer_load_dwordx4 v[148:151], v5, s[12:15], s41 offen offset:1024
  buffer_load_dwordx4 v[152:155], v5, s[12:15], s42 offen offset:1024
  buffer_load_dwordx4 v[156:159], v5, s[12:15], s43 offen offset:1024
  s_waitcnt lgkmcnt(0)
  s_waitcnt vmcnt(23)
  v_mfma_f32_16x16x32_bf16 v[160:163], v[32:35], v[64:67], v[224:227]
  ds_read_b64_tr_b16 v[48:49], v8 offset:4096
  v_mfma_f32_16x16x32_bf16 v[168:171], v[36:39], v[64:67], v[232:235]
  ds_read_b64_tr_b16 v[50:51], v8 offset:6144
  v_mfma_f32_16x16x32_bf16 v[176:179], v[40:43], v[64:67], 0
  ds_read_b64_tr_b16 v[52:53], v9 offset:4096
  v_mfma_f32_16x16x32_bf16 v[184:187], v[44:47], v[64:67], 0
  ds_read_b64_tr_b16 v[54:55], v9 offset:6144
  buffer_load_dwordx4 v[64:67], v5, s[12:15], s40 offen offset:2048
  s_waitcnt vmcnt(23)
  v_mfma_f32_16x16x32_bf16 v[164:167], v[32:35], v[68:71], v[228:231]
  ds_read_b64_tr_b16 v[56:57], v10 offset:4096
  v_mfma_f32_16x16x32_bf16 v[172:175], v[36:39], v[68:71], v[236:239]
  ds_read_b64_tr_b16 v[58:59], v10 offset:6144
  v_mfma_f32_16x16x32_bf16 v[180:183], v[40:43], v[68:71], 0
  ds_read_b64_tr_b16 v[60:61], v11 offset:4096
  v_mfma_f32_16x16x32_bf16 v[188:191], v[44:47], v[68:71], 0
  ds_read_b64_tr_b16 v[62:63], v11 offset:6144
  buffer_load_dwordx4 v[68:71], v5, s[12:15], s41 offen offset:2048
  s_waitcnt vmcnt(23)
  v_mfma_f32_16x16x32_bf16 v[192:195], v[32:35], v[72:75], 0
  v_mfma_f32_16x16x32_bf16 v[200:203], v[36:39], v[72:75], 0
  v_mfma_f32_16x16x32_bf16 v[208:211], v[40:43], v[72:75], 0
  v_mfma_f32_16x16x32_bf16 v[216:219], v[44:47], v[72:75], 0
  buffer_load_dwordx4 v[72:75], v5, s[12:15], s42 offen offset:2048
  s_waitcnt vmcnt(23)
  v_mfma_f32_16x16x32_bf16 v[196:199], v[32:35], v[76:79], 0
  v_mfma_f32_16x16x32_bf16 v[204:207], v[36:39], v[76:79], 0
  v_mfma_f32_16x16x32_bf16 v[212:215], v[40:43], v[76:79], 0
  v_mfma_f32_16x16x32_bf16 v[220:223], v[44:47], v[76:79], 0
  buffer_load_dwordx4 v[76:79], v5, s[12:15], s43 offen offset:2048
  s_waitcnt lgkmcnt(0)
  s_waitcnt vmcnt(23)
  v_mfma_f32_16x16x32_bf16 v[160:163], v[48:51], v[80:83], v[160:163]
  ds_read_b64_tr_b16 v[32:33], v8 offset:8192
  v_mfma_f32_16x16x32_bf16 v[168:171], v[52:55], v[80:83], v[168:171]
  ds_read_b64_tr_b16 v[34:35], v8 offset:10240
  v_mfma_f32_16x16x32_bf16 v[176:179], v[56:59], v[80:83], v[176:179]
  ds_read_b64_tr_b16 v[36:37], v9 offset:8192
  v_mfma_f32_16x16x32_bf16 v[184:187], v[60:63], v[80:83], v[184:187]
  ds_read_b64_tr_b16 v[38:39], v9 offset:10240
  buffer_load_dwordx4 v[80:83], v5, s[12:15], s40 offen offset:3072
  s_add_u32 s40, s40, 4096
  s_waitcnt vmcnt(23)
  v_mfma_f32_16x16x32_bf16 v[164:167], v[48:51], v[84:87], v[164:167]
  ds_read_b64_tr_b16 v[40:41], v10 offset:8192
  v_mfma_f32_16x16x32_bf16 v[172:175], v[52:55], v[84:87], v[172:175]
  ds_read_b64_tr_b16 v[42:43], v10 offset:10240
  v_mfma_f32_16x16x32_bf16 v[180:183], v[56:59], v[84:87], v[180:183]
  ds_read_b64_tr_b16 v[44:45], v11 offset:8192
  v_mfma_f32_16x16x32_bf16 v[188:191], v[60:63], v[84:87], v[188:191]
  ds_read_b64_tr_b16 v[46:47], v11 offset:10240
  buffer_load_dwordx4 v[84:87], v5, s[12:15], s41 offen offset:3072
  s_add_u32 s41, s41, 4096
  s_waitcnt vmcnt(23)
  v_mfma_f32_16x16x32_bf16 v[192:195], v[48:51], v[88:91], v[192:195]
  v_mfma_f32_16x16x32_bf16 v[200:203], v[52:55], v[88:91], v[200:203]
  v_mfma_f32_16x16x32_bf16 v[208:211], v[56:59], v[88:91], v[208:211]
  v_mfma_f32_16x16x32_bf16 v[216:219], v[60:63], v[88:91], v[216:219]
  buffer_load_dwordx4 v[88:91], v5, s[12:15], s42 offen offset:3072
  s_add_u32 s42, s42, 4096
  s_waitcnt vmcnt(23)
  v_mfma_f32_16x16x32_bf16 v[196:199], v[48:51], v[92:95], v[196:199]
  v_mfma_f32_16x16x32_bf16 v[204:207], v[52:55], v[92:95], v[204:207]
  v_mfma_f32_16x16x32_bf16 v[212:215], v[56:59], v[92:95], v[212:215]
  v_mfma_f32_16x16x32_bf16 v[220:223], v[60:63], v[92:95], v[220:223]
  buffer_load_dwordx4 v[92:95], v5, s[12:15], s43 offen offset:3072
  s_add_u32 s43, s43, 4096
  s_waitcnt lgkmcnt(0)
  s_waitcnt vmcnt(23)
  v_mfma_f32_16x16x32_bf16 v[160:163], v[32:35], v[96:99], v[160:163]
  ds_read_b64_tr_b16 v[48:49], v8 offset:12288
  v_mfma_f32_16x16x32_bf16 v[168:171], v[36:39], v[96:99], v[168:171]
  ds_read_b64_tr_b16 v[50:51], v8 offset:14336
  v_mfma_f32_16x16x32_bf16 v[176:179], v[40:43], v[96:99], v[176:179]
  ds_read_b64_tr_b16 v[52:53], v9 offset:12288
  v_mfma_f32_16x16x32_bf16 v[184:187], v[44:47], v[96:99], v[184:187]
  ds_read_b64_tr_b16 v[54:55], v9 offset:14336
  buffer_load_dwordx4 v[96:99], v5, s[12:15], s40 offen offset:0
  s_waitcnt vmcnt(23)
  v_mfma_f32_16x16x32_bf16 v[164:167], v[32:35], v[100:103], v[164:167]
  ds_read_b64_tr_b16 v[56:57], v10 offset:12288
  v_mfma_f32_16x16x32_bf16 v[172:175], v[36:39], v[100:103], v[172:175]
  ds_read_b64_tr_b16 v[58:59], v10 offset:14336
  v_mfma_f32_16x16x32_bf16 v[180:183], v[40:43], v[100:103], v[180:183]
  ds_read_b64_tr_b16 v[60:61], v11 offset:12288
  v_mfma_f32_16x16x32_bf16 v[188:191], v[44:47], v[100:103], v[188:191]
  ds_read_b64_tr_b16 v[62:63], v11 offset:14336
  buffer_load_dwordx4 v[100:103], v5, s[12:15], s41 offen offset:0
  s_waitcnt vmcnt(23)
  v_mfma_f32_16x16x32_bf16 v[192:195], v[32:35], v[104:107], v[192:195]
  v_mfma_f32_16x16x32_bf16 v[200:203], v[36:39], v[104:107], v[200:203]
  v_mfma_f32_16x16x32_bf16 v[208:211], v[40:43], v[104:107], v[208:211]
  v_mfma_f32_16x16x32_bf16 v[216:219], v[44:47], v[104:107], v[216:219]
  buffer_load_dwordx4 v[104:107], v5, s[12:15], s42 offen offset:0
  s_waitcnt vmcnt(23)
  v_mfma_f32_16x16x32_bf16 v[196:199], v[32:35], v[108:111], v[196:199]
  v_mfma_f32_16x16x32_bf16 v[204:207], v[36:39], v[108:111], v[204:207]
  v_mfma_f32_16x16x32_bf16 v[212:215], v[40:43], v[108:111], v[212:215]
  v_mfma_f32_16x16x32_bf16 v[220:223], v[44:47], v[108:111], v[220:223]
  buffer_load_dwordx4 v[108:111], v5, s[12:15], s43 offen offset:0
  s_waitcnt lgkmcnt(0)
  s_waitcnt vmcnt(23)
  v_mfma_f32_16x16x32_bf16 v[160:163], v[48:51], v[112:115], v[160:163]
  ds_read_b64_tr_b16 v[32:33], v8 offset:16384
  v_mfma_f32_16x16x32_bf16 v[168:171], v[52:55], v[112:115], v[168:171]
  ds_read_b64_tr_b16 v[34:35], v8 offset:18432
  v_mfma_f32_16x16x32_bf16 v[176:179], v[56:59], v[112:115], v[176:179]
  ds_read_b64_tr_b16 v[36:37], v9 offset:16384
  v_mfma_f32_16x16x32_bf16 v[184:187], v[60:63], v[112:115], v[184:187]
  ds_read_b64_tr_b16 v[38:39], v9 offset:18432
  buffer_load_dwordx4 v[112:115], v5, s[12:15], s40 offen offset:1024
  s_waitcnt vmcnt(23)
  v_mfma_f32_16x16x32_bf16 v[164:167], v[48:51], v[116:119], v[164:167]
  ds_read_b64_tr_b16 v[40:41], v10 offset:16384
  v_mfma_f32_16x16x32_bf16 v[172:175], v[52:55], v[116:119], v[172:175]
  ds_read_b64_tr_b16 v[42:43], v10 offset:18432
  v_mfma_f32_16x16x32_bf16 v[180:183], v[56:59], v[116:119], v[180:183]
  ds_read_b64_tr_b16 v[44:45], v11 offset:16384
  v_mfma_f32_16x16x32_bf16 v[188:191], v[60:63], v[116:119], v[188:191]
  ds_read_b64_tr_b16 v[46:47], v11 offset:18432
  buffer_load_dwordx4 v[116:119], v5, s[12:15], s41 offen offset:1024
  s_waitcnt vmcnt(23)
  v_mfma_f32_16x16x32_bf16 v[192:195], v[48:51], v[120:123], v[192:195]
  v_mfma_f32_16x16x32_bf16 v[200:203], v[52:55], v[120:123], v[200:203]
  v_mfma_f32_16x16x32_bf16 v[208:211], v[56:59], v[120:123], v[208:211]
  v_mfma_f32_16x16x32_bf16 v[216:219], v[60:63], v[120:123], v[216:219]
  buffer_load_dwordx4 v[120:123], v5, s[12:15], s42 offen offset:1024
  s_waitcnt vmcnt(23)
  v_mfma_f32_16x16x32_bf16 v[196:199], v[48:51], v[124:127], v[196:199]
  v_mfma_f32_16x16x32_bf16 v[204:207], v[52:55], v[124:127], v[204:207]
  v_mfma_f32_16x16x32_bf16 v[212:215], v[56:59], v[124:127], v[212:215]
  v_mfma_f32_16x16x32_bf16 v[220:223], v[60:63], v[124:127], v[220:223]
  buffer_load_dwordx4 v[124:127], v5, s[12:15], s43 offen offset:1024
  s_waitcnt lgkmcnt(0)
  s_waitcnt lgkmcnt(0)
  s_barrier
  s_waitcnt vmcnt(23)
  v_mfma_f32_16x16x32_bf16 v[160:163], v[32:35], v[128:131], v[160:163]
  ds_read_b64_tr_b16 v[48:49], v8 offset:20480
  v_mfma_f32_16x16x32_bf16 v[168:171], v[36:39], v[128:131], v[168:171]
  ds_read_b64_tr_b16 v[50:51], v8 offset:22528
  v_mfma_f32_16x16x32_bf16 v[176:179], v[40:43], v[128:131], v[176:179]
  ds_read_b64_tr_b16 v[52:53], v9 offset:20480
  v_mfma_f32_16x16x32_bf16 v[184:187], v[44:47], v[128:131], v[184:187]
  ds_read_b64_tr_b16 v[54:55], v9 offset:22528
  buffer_load_dwordx4 v[128:131], v5, s[12:15], s40 offen offset:2048
  s_waitcnt vmcnt(23)
  v_mfma_f32_16x16x32_bf16 v[164:167], v[32:35], v[132:135], v[164:167]
  ds_read_b64_tr_b16 v[56:57], v10 offset:20480
  v_mfma_f32_16x16x32_bf16 v[172:175], v[36:39], v[132:135], v[172:175]
  ds_read_b64_tr_b16 v[58:59], v10 offset:22528
  v_mfma_f32_16x16x32_bf16 v[180:183], v[40:43], v[132:135], v[180:183]
  ds_read_b64_tr_b16 v[60:61], v11 offset:20480
  v_mfma_f32_16x16x32_bf16 v[188:191], v[44:47], v[132:135], v[188:191]
  ds_read_b64_tr_b16 v[62:63], v11 offset:22528
  buffer_load_dwordx4 v[132:135], v5, s[12:15], s41 offen offset:2048
  s_waitcnt vmcnt(23)
  v_mfma_f32_16x16x32_bf16 v[192:195], v[32:35], v[136:139], v[192:195]
  v_mfma_f32_16x16x32_bf16 v[200:203], v[36:39], v[136:139], v[200:203]
  v_mfma_f32_16x16x32_bf16 v[208:211], v[40:43], v[136:139], v[208:211]
  v_mfma_f32_16x16x32_bf16 v[216:219], v[44:47], v[136:139], v[216:219]
  buffer_load_dwordx4 v[136:139], v5, s[12:15], s42 offen offset:2048
  s_waitcnt vmcnt(23)
  v_mfma_f32_16x16x32_bf16 v[196:199], v[32:35], v[140:143], v[196:199]
  v_mfma_f32_16x16x32_bf16 v[204:207], v[36:39], v[140:143], v[204:207]
  v_mfma_f32_16x16x32_bf16 v[212:215], v[40:43], v[140:143], v[212:215]
  v_mfma_f32_16x16x32_bf16 v[220:223], v[44:47], v[140:143], v[220:223]
  buffer_load_dwordx4 v[140:143], v5, s[12:15], s43 offen offset:2048
  s_waitcnt lgkmcnt(0)
  s_waitcnt vmcnt(23)
  v_mfma_f32_16x16x32_bf16 v[160:163], v[48:51], v[144:147], v[160:163]
  ds_read_b64_tr_b16 v[32:33], v8 offset:24576
  v_mfma_f32_16x16x32_bf16 v[168:171], v[52:55], v[144:147], v[168:171]
  ds_read_b64_tr_b16 v[34:35], v8 offset:26624
  v_mfma_f32_16x16x32_bf16 v[176:179], v[56:59], v[144:147], v[176:179]
  ds_read_b64_tr_b16 v[36:37], v9 offset:24576
  v_mfma_f32_16x16x32_bf16 v[184:187], v[60:63], v[144:147], v[184:187]
  ds_read_b64_tr_b16 v[38:39], v9 offset:26624
  buffer_load_dwordx4 v[144:147], v5, s[12:15], s40 offen offset:3072
  s_add_u32 s40, s40, 4096
  s_waitcnt vmcnt(23)
  v_mfma_f32_16x16x32_bf16 v[164:167], v[48:51], v[148:151], v[164:167]
  ds_read_b64_tr_b16 v[40:41], v10 offset:24576
  v_mfma_f32_16x16x32_bf16 v[172:175], v[52:55], v[148:151], v[172:175]
  ds_read_b64_tr_b16 v[42:43], v10 offset:26624
  v_mfma_f32_16x16x32_bf16 v[180:183], v[56:59], v[148:151], v[180:183]
  ds_read_b64_tr_b16 v[44:45], v11 offset:24576
  v_mfma_f32_16x16x32_bf16 v[188:191], v[60:63], v[148:151], v[188:191]
  ds_read_b64_tr_b16 v[46:47], v11 offset:26624
  buffer_load_dwordx4 v[148:151], v5, s[12:15], s41 offen offset:3072
  s_add_u32 s41, s41, 4096
  s_waitcnt vmcnt(23)
  v_mfma_f32_16x16x32_bf16 v[192:195], v[48:51], v[152:155], v[192:195]
  v_mfma_f32_16x16x32_bf16 v[200:203], v[52:55], v[152:155], v[200:203]
  v_mfma_f32_16x16x32_bf16 v[208:211], v[56:59], v[152:155], v[208:211]
  v_mfma_f32_16x16x32_bf16 v[216:219], v[60:63], v[152:155], v[216:219]
  buffer_load_dwordx4 v[152:155], v5, s[12:15], s42 offen offset:3072
  s_add_u32 s42, s42, 4096
  s_waitcnt vmcnt(23)
  v_mfma_f32_16x16x32_bf16 v[196:199], v[48:51], v[156:159], v[196:199]
  v_mfma_f32_16x16x32_bf16 v[204:207], v[52:55], v[156:159], v[204:207]
  v_mfma_f32_16x16x32_bf16 v[212:215], v[56:59], v[156:159], v[212:215]
  v_mfma_f32_16x16x32_bf16 v[220:223], v[60:63], v[156:159], v[220:223]
  buffer_load_dwordx4 v[156:159], v5, s[12:15], s43 offen offset:3072
  s_add_u32 s43, s43, 4096
  s_waitcnt lgkmcnt(0)
  s_waitcnt vmcnt(23)
  v_mfma_f32_16x16x32_bf16 v[160:163], v[32:35], v[64:67], v[160:163]
  ds_read_b64_tr_b16 v[48:49], v8 offset:28672
  v_mfma_f32_16x16x32_bf16 v[168:171], v[36:39], v[64:67], v[168:171]
  ds_read_b64_tr_b16 v[50:51], v8 offset:30720
  v_mfma_f32_16x16x32_bf16 v[176:179], v[40:43], v[64:67], v[176:179]
  ds_read_b64_tr_b16 v[52:53], v9 offset:28672
  v_mfma_f32_16x16x32_bf16 v[184:187], v[44:47], v[64:67], v[184:187]
  ds_read_b64_tr_b16 v[54:55], v9 offset:30720
  buffer_load_dwordx4 v[64:67], v5, s[12:15], s40 offen offset:0
  s_waitcnt vmcnt(23)
  v_mfma_f32_16x16x32_bf16 v[164:167], v[32:35], v[68:71], v[164:167]
  ds_read_b64_tr_b16 v[56:57], v10 offset:28672
  v_mfma_f32_16x16x32_bf16 v[172:175], v[36:39], v[68:71], v[172:175]
  ds_read_b64_tr_b16 v[58:59], v10 offset:30720
  v_mfma_f32_16x16x32_bf16 v[180:183], v[40:43], v[68:71], v[180:183]
  ds_read_b64_tr_b16 v[60:61], v11 offset:28672
  v_mfma_f32_16x16x32_bf16 v[188:191], v[44:47], v[68:71], v[188:191]
  ds_read_b64_tr_b16 v[62:63], v11 offset:30720
  buffer_load_dwordx4 v[68:71], v5, s[12:15], s41 offen offset:0
  s_waitcnt vmcnt(23)
  v_mfma_f32_16x16x32_bf16 v[192:195], v[32:35], v[72:75], v[192:195]
  v_mfma_f32_16x16x32_bf16 v[200:203], v[36:39], v[72:75], v[200:203]
  v_mfma_f32_16x16x32_bf16 v[208:211], v[40:43], v[72:75], v[208:211]
  v_mfma_f32_16x16x32_bf16 v[216:219], v[44:47], v[72:75], v[216:219]
  buffer_load_dwordx4 v[72:75], v5, s[12:15], s42 offen offset:0
  s_waitcnt vmcnt(23)
  v_mfma_f32_16x16x32_bf16 v[196:199], v[32:35], v[76:79], v[196:199]
  v_mfma_f32_16x16x32_bf16 v[204:207], v[36:39], v[76:79], v[204:207]
  v_mfma_f32_16x16x32_bf16 v[212:215], v[40:43], v[76:79], v[212:215]
  v_mfma_f32_16x16x32_bf16 v[220:223], v[44:47], v[76:79], v[220:223]
  buffer_load_dwordx4 v[76:79], v5, s[12:15], s43 offen offset:0
  s_waitcnt lgkmcnt(0)
  s_waitcnt vmcnt(23)
  v_mfma_f32_16x16x32_bf16 v[160:163], v[48:51], v[80:83], v[160:163]
  ds_read_b64_tr_b16 v[32:33], v8 offset:32768
  v_mfma_f32_16x16x32_bf16 v[168:171], v[52:55], v[80:83], v[168:171]
  ds_read_b64_tr_b16 v[34:35], v8 offset:34816
  v_mfma_f32_16x16x32_bf16 v[176:179], v[56:59], v[80:83], v[176:179]
  ds_read_b64_tr_b16 v[36:37], v9 offset:32768
  v_mfma_f32_16x16x32_bf16 v[184:187], v[60:63], v[80:83], v[184:187]
  ds_read_b64_tr_b16 v[38:39], v9 offset:34816
  buffer_load_dwordx4 v[80:83], v5, s[12:15], s40 offen offset:1024
  s_waitcnt vmcnt(23)
  v_mfma_f32_16x16x32_bf16 v[164:167], v[48:51], v[84:87], v[164:167]
  ds_read_b64_tr_b16 v[40:41], v10 offset:32768
  v_mfma_f32_16x16x32_bf16 v[172:175], v[52:55], v[84:87], v[172:175]
  ds_read_b64_tr_b16 v[42:43], v10 offset:34816
  v_mfma_f32_16x16x32_bf16 v[180:183], v[56:59], v[84:87], v[180:183]
  ds_read_b64_tr_b16 v[44:45], v11 offset:32768
  v_mfma_f32_16x16x32_bf16 v[188:191], v[60:63], v[84:87], v[188:191]
  ds_read_b64_tr_b16 v[46:47], v11 offset:34816
  buffer_load_dwordx4 v[84:87], v5, s[12:15], s41 offen offset:1024
  s_waitcnt vmcnt(23)
  v_mfma_f32_16x16x32_bf16 v[192:195], v[48:51], v[88:91], v[192:195]
  v_mfma_f32_16x16x32_bf16 v[200:203], v[52:55], v[88:91], v[200:203]
  v_mfma_f32_16x16x32_bf16 v[208:211], v[56:59], v[88:91], v[208:211]
  v_mfma_f32_16x16x32_bf16 v[216:219], v[60:63], v[88:91], v[216:219]
  buffer_load_dwordx4 v[88:91], v5, s[12:15], s42 offen offset:1024
  s_waitcnt vmcnt(23)
  v_mfma_f32_16x16x32_bf16 v[196:199], v[48:51], v[92:95], v[196:199]
  v_mfma_f32_16x16x32_bf16 v[204:207], v[52:55], v[92:95], v[204:207]
  v_mfma_f32_16x16x32_bf16 v[212:215], v[56:59], v[92:95], v[212:215]
  v_mfma_f32_16x16x32_bf16 v[220:223], v[60:63], v[92:95], v[220:223]
  buffer_load_dwordx4 v[92:95], v5, s[12:15], s43 offen offset:1024
  s_waitcnt lgkmcnt(0)
  s_waitcnt vmcnt(23)
  v_mfma_f32_16x16x32_bf16 v[160:163], v[32:35], v[96:99], v[160:163]
  ds_read_b64_tr_b16 v[48:49], v8 offset:36864
  v_mfma_f32_16x16x32_bf16 v[168:171], v[36:39], v[96:99], v[168:171]
  ds_read_b64_tr_b16 v[50:51], v8 offset:38912
  v_mfma_f32_16x16x32_bf16 v[176:179], v[40:43], v[96:99], v[176:179]
  ds_read_b64_tr_b16 v[52:53], v9 offset:36864
  v_mfma_f32_16x16x32_bf16 v[184:187], v[44:47], v[96:99], v[184:187]
  ds_read_b64_tr_b16 v[54:55], v9 offset:38912
  s_waitcnt vmcnt(22)
  v_mfma_f32_16x16x32_bf16 v[164:167], v[32:35], v[100:103], v[164:167]
  ds_read_b64_tr_b16 v[56:57], v10 offset:36864
  v_mfma_f32_16x16x32_bf16 v[172:175], v[36:39], v[100:103], v[172:175]
  ds_read_b64_tr_b16 v[58:59], v10 offset:38912
  v_mfma_f32_16x16x32_bf16 v[180:183], v[40:43], v[100:103], v[180:183]
  ds_read_b64_tr_b16 v[60:61], v11 offset:36864
  v_mfma_f32_16x16x32_bf16 v[188:191], v[44:47], v[100:103], v[188:191]
  ds_read_b64_tr_b16 v[62:63], v11 offset:38912
  s_waitcnt vmcnt(21)
  v_mfma_f32_16x16x32_bf16 v[192:195], v[32:35], v[104:107], v[192:195]
  v_mfma_f32_16x16x32_bf16 v[200:203], v[36:39], v[104:107], v[200:203]
  v_mfma_f32_16x16x32_bf16 v[208:211], v[40:43], v[104:107], v[208:211]
  v_mfma_f32_16x16x32_bf16 v[216:219], v[44:47], v[104:107], v[216:219]
  s_waitcnt vmcnt(20)
  v_mfma_f32_16x16x32_bf16 v[196:199], v[32:35], v[108:111], v[196:199]
  v_mfma_f32_16x16x32_bf16 v[204:207], v[36:39], v[108:111], v[204:207]
  v_mfma_f32_16x16x32_bf16 v[212:215], v[40:43], v[108:111], v[212:215]
  v_mfma_f32_16x16x32_bf16 v[220:223], v[44:47], v[108:111], v[220:223]
  s_waitcnt lgkmcnt(0)
  s_waitcnt lgkmcnt(0)
  s_barrier
  s_waitcnt vmcnt(19)
  v_mfma_f32_16x16x32_bf16 v[160:163], v[48:51], v[112:115], v[160:163]
  ds_read_b64_tr_b16 v[32:33], v8 offset:0
  v_mfma_f32_16x16x32_bf16 v[168:171], v[52:55], v[112:115], v[168:171]
  ds_read_b64_tr_b16 v[34:35], v8 offset:2048
  v_mfma_f32_16x16x32_bf16 v[176:179], v[56:59], v[112:115], v[176:179]
  ds_read_b64_tr_b16 v[36:37], v9 offset:0
  v_mfma_f32_16x16x32_bf16 v[184:187], v[60:63], v[112:115], v[184:187]
  ds_read_b64_tr_b16 v[38:39], v9 offset:2048
  s_waitcnt vmcnt(18)
  v_mfma_f32_16x16x32_bf16 v[164:167], v[48:51], v[116:119], v[164:167]
  ds_read_b64_tr_b16 v[40:41], v10 offset:0
  v_mfma_f32_16x16x32_bf16 v[172:175], v[52:55], v[116:119], v[172:175]
  ds_read_b64_tr_b16 v[42:43], v10 offset:2048
  v_mfma_f32_16x16x32_bf16 v[180:183], v[56:59], v[116:119], v[180:183]
  ds_read_b64_tr_b16 v[44:45], v11 offset:0
  v_mfma_f32_16x16x32_bf16 v[188:191], v[60:63], v[116:119], v[188:191]
  ds_read_b64_tr_b16 v[46:47], v11 offset:2048
  s_waitcnt vmcnt(17)
  v_mfma_f32_16x16x32_bf16 v[192:195], v[48:51], v[120:123], v[192:195]
  v_mfma_f32_16x16x32_bf16 v[200:203], v[52:55], v[120:123], v[200:203]
  v_mfma_f32_16x16x32_bf16 v[208:211], v[56:59], v[120:123], v[208:211]
  v_mfma_f32_16x16x32_bf16 v[216:219], v[60:63], v[120:123], v[216:219]
  s_waitcnt vmcnt(16)
  v_mfma_f32_16x16x32_bf16 v[196:199], v[48:51], v[124:127], v[196:199]
  v_mfma_f32_16x16x32_bf16 v[204:207], v[52:55], v[124:127], v[204:207]
  v_mfma_f32_16x16x32_bf16 v[212:215], v[56:59], v[124:127], v[212:215]
  v_mfma_f32_16x16x32_bf16 v[220:223], v[60:63], v[124:127], v[220:223]
  s_waitcnt lgkmcnt(0)
  s_waitcnt vmcnt(15)
  v_mfma_f32_16x16x32_bf16 v[160:163], v[32:35], v[128:131], v[160:163]
  ds_read_b64_tr_b16 v[48:49], v8 offset:4096
  v_mfma_f32_16x16x32_bf16 v[168:171], v[36:39], v[128:131], v[168:171]
  ds_read_b64_tr_b16 v[50:51], v8 offset:6144
  v_mfma_f32_16x16x32_bf16 v[176:179], v[40:43], v[128:131], v[176:179]
  ds_read_b64_tr_b16 v[52:53], v9 offset:4096
  v_mfma_f32_16x16x32_bf16 v[184:187], v[44:47], v[128:131], v[184:187]
  ds_read_b64_tr_b16 v[54:55], v9 offset:6144
  s_waitcnt vmcnt(14)
  v_mfma_f32_16x16x32_bf16 v[164:167], v[32:35], v[132:135], v[164:167]
  ds_read_b64_tr_b16 v[56:57], v10 offset:4096
  v_mfma_f32_16x16x32_bf16 v[172:175], v[36:39], v[132:135], v[172:175]
  ds_read_b64_tr_b16 v[58:59], v10 offset:6144
  v_mfma_f32_16x16x32_bf16 v[180:183], v[40:43], v[132:135], v[180:183]
  ds_read_b64_tr_b16 v[60:61], v11 offset:4096
  v_mfma_f32_16x16x32_bf16 v[188:191], v[44:47], v[132:135], v[188:191]
  ds_read_b64_tr_b16 v[62:63], v11 offset:6144
  s_waitcnt vmcnt(13)
  v_mfma_f32_16x16x32_bf16 v[192:195], v[32:35], v[136:139], v[192:195]
  v_mfma_f32_16x16x32_bf16 v[200:203], v[36:39], v[136:139], v[200:203]
  v_mfma_f32_16x16x32_bf16 v[208:211], v[40:43], v[136:139], v[208:211]
  v_mfma_f32_16x16x32_bf16 v[216:219], v[44:47], v[136:139], v[216:219]
  s_waitcnt vmcnt(12)
  v_mfma_f32_16x16x32_bf16 v[196:199], v[32:35], v[140:143], v[196:199]
  v_mfma_f32_16x16x32_bf16 v[204:207], v[36:39], v[140:143], v[204:207]
  v_mfma_f32_16x16x32_bf16 v[212:215], v[40:43], v[140:143], v[212:215]
  v_mfma_f32_16x16x32_bf16 v[220:223], v[44:47], v[140:143], v[220:223]
  s_waitcnt lgkmcnt(0)
  s_waitcnt vmcnt(11)
  v_mfma_f32_16x16x32_bf16 v[160:163], v[48:51], v[144:147], v[160:163]
  ds_read_b64_tr_b16 v[32:33], v8 offset:8192
  v_mfma_f32_16x16x32_bf16 v[168:171], v[52:55], v[144:147], v[168:171]
  ds_read_b64_tr_b16 v[34:35], v8 offset:10240
  v_mfma_f32_16x16x32_bf16 v[176:179], v[56:59], v[144:147], v[176:179]
  ds_read_b64_tr_b16 v[36:37], v9 offset:8192
  v_mfma_f32_16x16x32_bf16 v[184:187], v[60:63], v[144:147], v[184:187]
  ds_read_b64_tr_b16 v[38:39], v9 offset:10240
  s_waitcnt vmcnt(10)
  v_mfma_f32_16x16x32_bf16 v[164:167], v[48:51], v[148:151], v[164:167]
  ds_read_b64_tr_b16 v[40:41], v10 offset:8192
  v_mfma_f32_16x16x32_bf16 v[172:175], v[52:55], v[148:151], v[172:175]
  ds_read_b64_tr_b16 v[42:43], v10 offset:10240
  v_mfma_f32_16x16x32_bf16 v[180:183], v[56:59], v[148:151], v[180:183]
  ds_read_b64_tr_b16 v[44:45], v11 offset:8192
  v_mfma_f32_16x16x32_bf16 v[188:191], v[60:63], v[148:151], v[188:191]
  ds_read_b64_tr_b16 v[46:47], v11 offset:10240
  s_waitcnt vmcnt(9)
  v_mfma_f32_16x16x32_bf16 v[192:195], v[48:51], v[152:155], v[192:195]
  v_mfma_f32_16x16x32_bf16 v[200:203], v[52:55], v[152:155], v[200:203]
  v_mfma_f32_16x16x32_bf16 v[208:211], v[56:59], v[152:155], v[208:211]
  v_mfma_f32_16x16x32_bf16 v[216:219], v[60:63], v[152:155], v[216:219]
  s_waitcnt vmcnt(8)
  v_mfma_f32_16x16x32_bf16 v[196:199], v[48:51], v[156:159], v[196:199]
  v_mfma_f32_16x16x32_bf16 v[204:207], v[52:55], v[156:159], v[204:207]
  v_mfma_f32_16x16x32_bf16 v[212:215], v[56:59], v[156:159], v[212:215]
  v_mfma_f32_16x16x32_bf16 v[220:223], v[60:63], v[156:159], v[220:223]
  s_waitcnt lgkmcnt(0)
  s_waitcnt vmcnt(7)
  v_mfma_f32_16x16x32_bf16 v[160:163], v[32:35], v[64:67], v[160:163]
  ds_read_b64_tr_b16 v[48:49], v8 offset:12288
  v_mfma_f32_16x16x32_bf16 v[168:171], v[36:39], v[64:67], v[168:171]
  ds_read_b64_tr_b16 v[50:51], v8 offset:14336
  v_mfma_f32_16x16x32_bf16 v[176:179], v[40:43], v[64:67], v[176:179]
  ds_read_b64_tr_b16 v[52:53], v9 offset:12288
  v_mfma_f32_16x16x32_bf16 v[184:187], v[44:47], v[64:67], v[184:187]
  ds_read_b64_tr_b16 v[54:55], v9 offset:14336
  s_waitcnt vmcnt(6)
  v_mfma_f32_16x16x32_bf16 v[164:167], v[32:35], v[68:71], v[164:167]
  ds_read_b64_tr_b16 v[56:57], v10 offset:12288
  v_mfma_f32_16x16x32_bf16 v[172:175], v[36:39], v[68:71], v[172:175]
  ds_read_b64_tr_b16 v[58:59], v10 offset:14336
  v_mfma_f32_16x16x32_bf16 v[180:183], v[40:43], v[68:71], v[180:183]
  ds_read_b64_tr_b16 v[60:61], v11 offset:12288
  v_mfma_f32_16x16x32_bf16 v[188:191], v[44:47], v[68:71], v[188:191]
  ds_read_b64_tr_b16 v[62:63], v11 offset:14336
  s_waitcnt vmcnt(5)
  v_mfma_f32_16x16x32_bf16 v[192:195], v[32:35], v[72:75], v[192:195]
  v_mfma_f32_16x16x32_bf16 v[200:203], v[36:39], v[72:75], v[200:203]
  v_mfma_f32_16x16x32_bf16 v[208:211], v[40:43], v[72:75], v[208:211]
  v_mfma_f32_16x16x32_bf16 v[216:219], v[44:47], v[72:75], v[216:219]
  s_waitcnt vmcnt(4)
  v_mfma_f32_16x16x32_bf16 v[196:199], v[32:35], v[76:79], v[196:199]
  v_mfma_f32_16x16x32_bf16 v[204:207], v[36:39], v[76:79], v[204:207]
  v_mfma_f32_16x16x32_bf16 v[212:215], v[40:43], v[76:79], v[212:215]
  v_mfma_f32_16x16x32_bf16 v[220:223], v[44:47], v[76:79], v[220:223]
  s_waitcnt lgkmcnt(0)
  s_waitcnt vmcnt(3)
  v_mfma_f32_16x16x32_bf16 v[160:163], v[48:51], v[80:83], v[160:163]
  v_mfma_f32_16x16x32_bf16 v[168:171], v[52:55], v[80:83], v[168:171]
  v_mfma_f32_16x16x32_bf16 v[176:179], v[56:59], v[80:83], v[176:179]
  v_mfma_f32_16x16x32_bf16 v[184:187], v[60:63], v[80:83], v[184:187]
  s_waitcnt vmcnt(2)
  v_mfma_f32_16x16x32_bf16 v[164:167], v[48:51], v[84:87], v[164:167]
  v_mfma_f32_16x16x32_bf16 v[172:175], v[52:55], v[84:87], v[172:175]
  v_mfma_f32_16x16x32_bf16 v[180:183], v[56:59], v[84:87], v[180:183]
  v_mfma_f32_16x16x32_bf16 v[188:191], v[60:63], v[84:87], v[188:191]
  s_waitcnt vmcnt(1)
  v_mfma_f32_16x16x32_bf16 v[192:195], v[48:51], v[88:91], v[192:195]
  v_mfma_f32_16x16x32_bf16 v[200:203], v[52:55], v[88:91], v[200:203]
  v_mfma_f32_16x16x32_bf16 v[208:211], v[56:59], v[88:91], v[208:211]
  v_mfma_f32_16x16x32_bf16 v[216:219], v[60:63], v[88:91], v[216:219]
  s_waitcnt vmcnt(0)
  v_mfma_f32_16x16x32_bf16 v[196:199], v[48:51], v[92:95], v[196:199]
  v_mfma_f32_16x16x32_bf16 v[204:207], v[52:55], v[92:95], v[204:207]
  v_mfma_f32_16x16x32_bf16 v[212:215], v[56:59], v[92:95], v[212:215]
  v_mfma_f32_16x16x32_bf16 v[220:223], v[60:63], v[92:95], v[220:223]
  ds_write_b128 v12, v[176:179] offset:0
  ds_write_b128 v12, v[180:183] offset:1024
  ds_write_b128 v12, v[184:187] offset:2048
  ds_write_b128 v12, v[188:191] offset:3072
  ds_write_b128 v12, v[192:195] offset:4096
  ds_write_b128 v12, v[196:199] offset:5120
  ds_write_b128 v12, v[200:203] offset:6144
  ds_write_b128 v12, v[204:207] offset:7168
  ds_write_b128 v12, v[208:211] offset:8192
  ds_write_b128 v12, v[212:215] offset:9216
  ds_write_b128 v12, v[216:219] offset:10240
  ds_write_b128 v12, v[220:223] offset:11264
  s_waitcnt lgkmcnt(0)
  s_barrier
  ds_read_b128 v[64:67], v13 offset:0
  ds_read_b128 v[68:71], v13 offset:1024
  ds_read_b128 v[72:75], v13 offset:2048
  ds_read_b128 v[76:79], v13 offset:3072
  ds_read_b128 v[80:83], v14 offset:4096
  ds_read_b128 v[84:87], v14 offset:5120
  ds_read_b128 v[88:91], v14 offset:6144
  ds_read_b128 v[92:95], v14 offset:7168
  ds_read_b128 v[96:99], v15 offset:8192
  ds_read_b128 v[100:103], v15 offset:9216
  ds_read_b128 v[104:107], v15 offset:10240
  ds_read_b128 v[108:111], v15 offset:11264
  s_waitcnt lgkmcnt(11)
  v_pk_add_f32 v[160:161], v[160:161], v[64:65]
  v_pk_add_f32 v[162:163], v[162:163], v[66:67]
  s_waitcnt lgkmcnt(10)
  v_pk_add_f32 v[164:165], v[164:165], v[68:69]
  v_pk_add_f32 v[166:167], v[166:167], v[70:71]
  s_waitcnt lgkmcnt(9)
  v_pk_add_f32 v[168:169], v[168:169], v[72:73]
  v_pk_add_f32 v[170:171], v[170:171], v[74:75]
  s_waitcnt lgkmcnt(8)
  v_pk_add_f32 v[172:173], v[172:173], v[76:77]
  v_pk_add_f32 v[174:175], v[174:175], v[78:79]
  s_waitcnt lgkmcnt(7)
  v_pk_add_f32 v[160:161], v[160:161], v[80:81]
  v_pk_add_f32 v[162:163], v[162:163], v[82:83]
  s_waitcnt lgkmcnt(6)
  v_pk_add_f32 v[164:165], v[164:165], v[84:85]
  v_pk_add_f32 v[166:167], v[166:167], v[86:87]
  s_waitcnt lgkmcnt(5)
  v_pk_add_f32 v[168:169], v[168:169], v[88:89]
  v_pk_add_f32 v[170:171], v[170:171], v[90:91]
  s_waitcnt lgkmcnt(4)
  v_pk_add_f32 v[172:173], v[172:173], v[92:93]
  v_pk_add_f32 v[174:175], v[174:175], v[94:95]
  s_waitcnt lgkmcnt(3)
  v_pk_add_f32 v[160:161], v[160:161], v[96:97]
  v_pk_add_f32 v[162:163], v[162:163], v[98:99]
  s_waitcnt lgkmcnt(2)
  v_pk_add_f32 v[164:165], v[164:165], v[100:101]
  v_pk_add_f32 v[166:167], v[166:167], v[102:103]
  s_waitcnt lgkmcnt(1)
  v_pk_add_f32 v[168:169], v[168:169], v[104:105]
  v_pk_add_f32 v[170:171], v[170:171], v[106:107]
  s_waitcnt lgkmcnt(0)
  v_pk_add_f32 v[172:173], v[172:173], v[108:109]
  v_pk_add_f32 v[174:175], v[174:175], v[110:111]
  s_mov_b32 s8, s50
  s_and_b32 s9, s51, 0xffff
  s_mov_b32 s10, 0x200000
  s_mov_b32 s11, 0x20000
  v_lshlrev_b32 v1, 10, v7
  v_and_b32 v2, 1, v4
  v_lshl_add_u32 v1, v2, 5, v1
  v_lshrrev_b32 v2, 1, v4
  v_lshl_add_u32 v1, v2, 4, v1
  s_lshl_b32 s24, s29, 10
  s_lshl_b32 s27, s17, 6
  s_add_u32 s24, s24, s27
  s_add_u32 s27, s24, 16384
  v_cvt_pk_bf16_f32 v32, v160, v161
  v_cvt_pk_bf16_f32 v33, v162, v163
  v_cvt_pk_bf16_f32 v34, v168, v169
  v_cvt_pk_bf16_f32 v35, v170, v171
  s_nop 0
  v_permlane16_swap_b32 v32, v34
  v_permlane16_swap_b32 v33, v35
  buffer_store_dwordx4 v[32:35], v1, s[8:11], s24 offen
  v_cvt_pk_bf16_f32 v36, v164, v165
  v_cvt_pk_bf16_f32 v37, v166, v167
  v_cvt_pk_bf16_f32 v38, v172, v173
  v_cvt_pk_bf16_f32 v39, v174, v175
  s_nop 0
  v_permlane16_swap_b32 v36, v38
  v_permlane16_swap_b32 v37, v39
  buffer_store_dwordx4 v[36:39], v1, s[8:11], s27 offen
L_end:
  s_endpgm
L_codeend:
.section .rodata,"a"
.p2align 6
.amdhsa_kernel sequential_preLN__ssm_conv_s4d__mixer_s_mlp__prompt_kernel
  .amdhsa_next_free_vgpr 256
  .amdhsa_next_free_sgpr 96
  .amdhsa_accum_offset 256
  .amdhsa_group_segment_fixed_size 0
  .amdhsa_kernarg_size 120
  .amdhsa_user_sgpr_count 2
  .amdhsa_user_sgpr_kernarg_segment_ptr 1
  .amdhsa_system_sgpr_workgroup_id_x 1
.end_amdhsa_kernel
```
